```python
import torch

def _softmax(x, axis=-1):
    return torch.softmax(x, dim=axis)

def _gelu(x):
    return torch.nn.functional.gelu(x, approximate='tanh')

def _silu(x):
    return torch.nn.functional.silu(x)

def _sigmoid(x):
    return torch.sigmoid(x)

def _layernorm(x, axis=-1, eps=1e-05):
    m = x.mean(dim=axis, keepdim=True)
    v = x.var(dim=axis, keepdim=True, unbiased=False)
    return (x - m) / torch.sqrt(v + eps)

def _scatter_add(tgt, idx, src, axis=0):
    return tgt.clone().index_add_(axis, idx, src)

def _segment_sum(src, seg, n):
    out = torch.zeros((n,) + src.shape[1:], dtype=src.dtype)
    return out.index_add_(0, seg, src)

def _pad(x, pw):
    flat = tuple((v for pair in reversed(pw) for v in pair))
    return torch.nn.functional.pad(x, flat)
kernel_name = 'adaLN_cond__compressed_kv_cla__dense_activation_relu__prompt'

def setup_inputs():

    _w = lambda a: (lambda t: t.to(torch.bfloat16) if t.is_floating_point() else t)(torch.as_tensor(a))

    def _A_setup():
        B, H, Sq, Sk, D, M = (1, 32, 2048, 2048, 128, 512)
        Dc = 4 * D
        return {'x': _w((lambda *s: torch.randn(*s, dtype=torch.bfloat16) * 0.05)(B, Sq, M)), 'c_kv': _w((lambda *s: torch.randn(*s, dtype=torch.bfloat16) * 1.6)(B, Sk, Dc)), 'w_q': _w((lambda *s: torch.randn(*s, dtype=torch.bfloat16) * 0.8)(M, H, D) * M ** (-0.5)), 'w_uk': _w((lambda *s: torch.randn(*s, dtype=torch.bfloat16) * 0.8)(Dc, H, D) * Dc ** (-0.5)), 'w_uv': _w((lambda *s: torch.randn(*s, dtype=torch.bfloat16) * 1.6)(Dc, H, D) * Dc ** (-0.5)), 'w_o': _w((lambda *s: torch.randn(*s, dtype=torch.bfloat16) * 1.6)(H, D, M) * (H * D) ** (-0.5))}
    _A_in = _A_setup()

    def _B_setup():
        B, S, D, Dff = (1, 2048, 512, 1792)
        return {'x': _w((lambda *s: torch.randn(*s, dtype=torch.bfloat16) * 0.05)(B, S, D)), 'w1': _w((lambda *s: torch.randn(*s, dtype=torch.bfloat16) * 0.05)(D, Dff)), 'w2': _w((lambda *s: torch.randn(*s, dtype=torch.bfloat16) * 0.05)(Dff, D))}
    _B_in = _B_setup()
    return {'A_x': _A_in['x'], 'A_c_kv': _A_in['c_kv'], 'A_w_q': _A_in['w_q'], 'A_w_uk': _A_in['w_uk'], 'A_w_uv': _A_in['w_uv'], 'A_w_o': _A_in['w_o'], 'B_x': _B_in['x'], 'B_w1': _B_in['w1'], 'B_w2': _B_in['w2'], 'c': _w((lambda *s: torch.randn(*s, dtype=torch.bfloat16) * 0.1)(1, 512) * 8.0), 'w_mod': _w((lambda *s: torch.randn(*s, dtype=torch.bfloat16) * 0.1)(512, 6 * 512) * 512 ** (-0.5) * 8.0)}

def reference(A_x, A_c_kv, A_w_q, A_w_uk, A_w_uv, A_w_o, B_x, B_w1, B_w2, c, w_mod):

    def _A_ref(x, c_kv, w_q, w_uk, w_uv, w_o):
        B, Sq, M = (x.shape[0], x.shape[1], x.shape[2])
        Sk = c_kv.shape[1]
        H, D = (w_q.shape[1], w_q.shape[2])
        q = torch.einsum('bqm,mhd->bhqd', x, w_q)
        k = torch.einsum('bkc,chd->bhkd', c_kv, w_uk)
        v = torch.einsum('bkc,chd->bhkd', c_kv, w_uv)
        scores = torch.einsum('bhqd,bhkd->bhqk', q, k) * D ** (-0.5)
        off = Sk - Sq
        qi = torch.arange(Sq)[:, None]
        kj = torch.arange(Sk)[None, :]
        cmask = kj <= qi + off
        scores = torch.where(cmask[None, None], scores, -1000000000.0)
        p = _softmax(scores, axis=-1)
        ctx = torch.einsum('bhqk,bhkd->bhqd', p, v)
        return torch.einsum('bhqd,hdm->bqm', ctx, w_o)

    def _B_ref(x, w1, w2):
        h = torch.einsum('bsd,df->bsf', x, w1)
        zero = torch.zeros_like(h)
        h = torch.maximum(h, zero)
        return torch.einsum('bsf,fd->bsd', h, w2)
    x = A_x
    mod = (_silu(c) @ w_mod).reshape(c.shape[0], 6, 1, -1)
    sa, ca, ga, sb, cb, gb = (mod[:, 0].clone(), mod[:, 1].clone(), mod[:, 2].clone(), mod[:, 3].clone(), mod[:, 4].clone(), mod[:, 5].clone())
    h = _layernorm(x, axis=-1) * (1 + ca) + sa
    x = x + ga * _A_ref(h, A_c_kv, A_w_q, A_w_uk, A_w_uv, A_w_o)
    h = _layernorm(x, axis=-1) * (1 + cb) + sb
    x = x + gb * _B_ref(h, B_w1, B_w2)
    return x
```

```asm
; @launch kernel=mod_kernel grid=(96,1,1) block=(256,1,1) lds=2048
; @launch kernel=ln1_kernel grid=(512,1,1) block=(256,1,1) lds=0
; @launch kernel=qkv_kernel grid=(512,1,1) block=(512,1,1) lds=131072
; @launch kernel=attn_kernel grid=(256,1,1) block=(512,1,1) lds=131072
; @launch kernel=oproj_kernel grid=(256,1,1) block=(256,1,1) lds=163840
; @launch kernel=ln2_kernel grid=(512,1,1) block=(256,1,1) lds=0
; @launch kernel=ffn1_kernel grid=(224,1,1) block=(256,1,1) lds=163840
; @launch kernel=ffn2_kernel grid=(256,1,1) block=(256,1,1) lds=147456
.amdgcn_target "amdgcn-amd-amdhsa--gfx950"
.text
.globl mod_kernel
.p2align 8
.type mod_kernel,@function
mod_kernel:
    s_cmp_ge_u32 s2, 96
    s_cbranch_scc1 mod_done
    s_load_dwordx2 s[8:9], s[0:1], 72
    s_mov_b32 s10, 1024
    s_mov_b32 s11, 0x00020000
    s_load_dwordx2 s[12:13], s[0:1], 80
    s_mov_b32 s14, 3145728
    s_mov_b32 s15, 0x00020000
    s_load_dwordx2 s[16:17], s[0:1], 104
    s_mov_b32 s18, 12288
    s_mov_b32 s19, 0x00020000
    v_lshrrev_b32 v1, 6, v0
    v_and_b32 v2, 63, v0
    v_lshrrev_b32 v3, 4, v2
    v_and_b32 v4, 15, v2
    v_lshl_add_u32 v5, v1, 7, v3
    v_lshlrev_b32 v6, 1, v5
    s_lshl_b32 s3, s2, 6
    v_lshlrev_b32 v7, 2, v4
    v_add_u32 v7, s3, v7
    s_movk_i32 s4, 6144
    v_mul_lo_u32 v8, v5, s4
    v_add_u32 v7, v7, v8
    v_mov_b32 v20, 0
    v_mov_b32 v21, 0
    s_waitcnt lgkmcnt(0)

    buffer_load_ushort v32, v6, s[8:11], 0 offen offset:0
    buffer_load_ushort v33, v6, s[8:11], 0 offen offset:8
    buffer_load_ushort v34, v6, s[8:11], 0 offen offset:16
    buffer_load_ushort v35, v6, s[8:11], 0 offen offset:24
    buffer_load_ushort v36, v6, s[8:11], 0 offen offset:32
    buffer_load_ushort v37, v6, s[8:11], 0 offen offset:40
    buffer_load_ushort v38, v6, s[8:11], 0 offen offset:48
    buffer_load_ushort v39, v6, s[8:11], 0 offen offset:56
    buffer_load_ushort v40, v6, s[8:11], 0 offen offset:64
    buffer_load_ushort v41, v6, s[8:11], 0 offen offset:72
    buffer_load_ushort v42, v6, s[8:11], 0 offen offset:80
    buffer_load_ushort v43, v6, s[8:11], 0 offen offset:88
    buffer_load_ushort v44, v6, s[8:11], 0 offen offset:96
    buffer_load_ushort v45, v6, s[8:11], 0 offen offset:104
    buffer_load_ushort v46, v6, s[8:11], 0 offen offset:112
    buffer_load_ushort v47, v6, s[8:11], 0 offen offset:120
    buffer_load_ushort v48, v6, s[8:11], 0 offen offset:128
    buffer_load_ushort v49, v6, s[8:11], 0 offen offset:136
    buffer_load_ushort v50, v6, s[8:11], 0 offen offset:144
    buffer_load_ushort v51, v6, s[8:11], 0 offen offset:152
    buffer_load_ushort v52, v6, s[8:11], 0 offen offset:160
    buffer_load_ushort v53, v6, s[8:11], 0 offen offset:168
    buffer_load_ushort v54, v6, s[8:11], 0 offen offset:176
    buffer_load_ushort v55, v6, s[8:11], 0 offen offset:184
    buffer_load_ushort v56, v6, s[8:11], 0 offen offset:192
    buffer_load_ushort v57, v6, s[8:11], 0 offen offset:200
    buffer_load_ushort v58, v6, s[8:11], 0 offen offset:208
    buffer_load_ushort v59, v6, s[8:11], 0 offen offset:216
    buffer_load_ushort v60, v6, s[8:11], 0 offen offset:224
    buffer_load_ushort v61, v6, s[8:11], 0 offen offset:232
    buffer_load_ushort v62, v6, s[8:11], 0 offen offset:240
    buffer_load_ushort v63, v6, s[8:11], 0 offen offset:248
    s_mov_b32 s5, 0
    buffer_load_dword v64, v7, s[12:15], s5 offen
    s_mov_b32 s5, 24576
    buffer_load_dword v65, v7, s[12:15], s5 offen
    s_mov_b32 s5, 49152
    buffer_load_dword v66, v7, s[12:15], s5 offen
    s_mov_b32 s5, 73728
    buffer_load_dword v67, v7, s[12:15], s5 offen
    s_mov_b32 s5, 98304
    buffer_load_dword v68, v7, s[12:15], s5 offen
    s_mov_b32 s5, 122880
    buffer_load_dword v69, v7, s[12:15], s5 offen
    s_mov_b32 s5, 147456
    buffer_load_dword v70, v7, s[12:15], s5 offen
    s_mov_b32 s5, 172032
    buffer_load_dword v71, v7, s[12:15], s5 offen
    s_mov_b32 s5, 196608
    buffer_load_dword v72, v7, s[12:15], s5 offen
    s_mov_b32 s5, 221184
    buffer_load_dword v73, v7, s[12:15], s5 offen
    s_mov_b32 s5, 245760
    buffer_load_dword v74, v7, s[12:15], s5 offen
    s_mov_b32 s5, 270336
    buffer_load_dword v75, v7, s[12:15], s5 offen
    s_mov_b32 s5, 294912
    buffer_load_dword v76, v7, s[12:15], s5 offen
    s_mov_b32 s5, 319488
    buffer_load_dword v77, v7, s[12:15], s5 offen
    s_mov_b32 s5, 344064
    buffer_load_dword v78, v7, s[12:15], s5 offen
    s_mov_b32 s5, 368640
    buffer_load_dword v79, v7, s[12:15], s5 offen
    s_mov_b32 s5, 393216
    buffer_load_dword v80, v7, s[12:15], s5 offen
    s_mov_b32 s5, 417792
    buffer_load_dword v81, v7, s[12:15], s5 offen
    s_mov_b32 s5, 442368
    buffer_load_dword v82, v7, s[12:15], s5 offen
    s_mov_b32 s5, 466944
    buffer_load_dword v83, v7, s[12:15], s5 offen
    s_mov_b32 s5, 491520
    buffer_load_dword v84, v7, s[12:15], s5 offen
    s_mov_b32 s5, 516096
    buffer_load_dword v85, v7, s[12:15], s5 offen
    s_mov_b32 s5, 540672
    buffer_load_dword v86, v7, s[12:15], s5 offen
    s_mov_b32 s5, 565248
    buffer_load_dword v87, v7, s[12:15], s5 offen
    s_mov_b32 s5, 589824
    buffer_load_dword v88, v7, s[12:15], s5 offen
    s_mov_b32 s5, 614400
    buffer_load_dword v89, v7, s[12:15], s5 offen
    s_mov_b32 s5, 638976
    buffer_load_dword v90, v7, s[12:15], s5 offen
    s_mov_b32 s5, 663552
    buffer_load_dword v91, v7, s[12:15], s5 offen
    s_mov_b32 s5, 688128
    buffer_load_dword v92, v7, s[12:15], s5 offen
    s_mov_b32 s5, 712704
    buffer_load_dword v93, v7, s[12:15], s5 offen
    s_mov_b32 s5, 737280
    buffer_load_dword v94, v7, s[12:15], s5 offen
    s_mov_b32 s5, 761856
    buffer_load_dword v95, v7, s[12:15], s5 offen
    s_waitcnt vmcnt(63)
    v_lshlrev_b32 v32, 16, v32
    v_mul_f32 v22, 0xbfb8aa3b, v32
    v_exp_f32 v22, v22
    s_nop 0
    v_add_f32 v22, 1.0, v22
    v_rcp_f32 v22, v22
    s_nop 0
    v_mul_f32 v32, v32, v22
    s_waitcnt vmcnt(62)
    v_lshlrev_b32 v33, 16, v33
    v_mul_f32 v22, 0xbfb8aa3b, v33
    v_exp_f32 v22, v22
    s_nop 0
    v_add_f32 v22, 1.0, v22
    v_rcp_f32 v22, v22
    s_nop 0
    v_mul_f32 v33, v33, v22
    s_waitcnt vmcnt(61)
    v_lshlrev_b32 v34, 16, v34
    v_mul_f32 v22, 0xbfb8aa3b, v34
    v_exp_f32 v22, v22
    s_nop 0
    v_add_f32 v22, 1.0, v22
    v_rcp_f32 v22, v22
    s_nop 0
    v_mul_f32 v34, v34, v22
    s_waitcnt vmcnt(60)
    v_lshlrev_b32 v35, 16, v35
    v_mul_f32 v22, 0xbfb8aa3b, v35
    v_exp_f32 v22, v22
    s_nop 0
    v_add_f32 v22, 1.0, v22
    v_rcp_f32 v22, v22
    s_nop 0
    v_mul_f32 v35, v35, v22
    s_waitcnt vmcnt(59)
    v_lshlrev_b32 v36, 16, v36
    v_mul_f32 v22, 0xbfb8aa3b, v36
    v_exp_f32 v22, v22
    s_nop 0
    v_add_f32 v22, 1.0, v22
    v_rcp_f32 v22, v22
    s_nop 0
    v_mul_f32 v36, v36, v22
    s_waitcnt vmcnt(58)
    v_lshlrev_b32 v37, 16, v37
    v_mul_f32 v22, 0xbfb8aa3b, v37
    v_exp_f32 v22, v22
    s_nop 0
    v_add_f32 v22, 1.0, v22
    v_rcp_f32 v22, v22
    s_nop 0
    v_mul_f32 v37, v37, v22
    s_waitcnt vmcnt(57)
    v_lshlrev_b32 v38, 16, v38
    v_mul_f32 v22, 0xbfb8aa3b, v38
    v_exp_f32 v22, v22
    s_nop 0
    v_add_f32 v22, 1.0, v22
    v_rcp_f32 v22, v22
    s_nop 0
    v_mul_f32 v38, v38, v22
    s_waitcnt vmcnt(56)
    v_lshlrev_b32 v39, 16, v39
    v_mul_f32 v22, 0xbfb8aa3b, v39
    v_exp_f32 v22, v22
    s_nop 0
    v_add_f32 v22, 1.0, v22
    v_rcp_f32 v22, v22
    s_nop 0
    v_mul_f32 v39, v39, v22
    s_waitcnt vmcnt(55)
    v_lshlrev_b32 v40, 16, v40
    v_mul_f32 v22, 0xbfb8aa3b, v40
    v_exp_f32 v22, v22
    s_nop 0
    v_add_f32 v22, 1.0, v22
    v_rcp_f32 v22, v22
    s_nop 0
    v_mul_f32 v40, v40, v22
    s_waitcnt vmcnt(54)
    v_lshlrev_b32 v41, 16, v41
    v_mul_f32 v22, 0xbfb8aa3b, v41
    v_exp_f32 v22, v22
    s_nop 0
    v_add_f32 v22, 1.0, v22
    v_rcp_f32 v22, v22
    s_nop 0
    v_mul_f32 v41, v41, v22
    s_waitcnt vmcnt(53)
    v_lshlrev_b32 v42, 16, v42
    v_mul_f32 v22, 0xbfb8aa3b, v42
    v_exp_f32 v22, v22
    s_nop 0
    v_add_f32 v22, 1.0, v22
    v_rcp_f32 v22, v22
    s_nop 0
    v_mul_f32 v42, v42, v22
    s_waitcnt vmcnt(52)
    v_lshlrev_b32 v43, 16, v43
    v_mul_f32 v22, 0xbfb8aa3b, v43
    v_exp_f32 v22, v22
    s_nop 0
    v_add_f32 v22, 1.0, v22
    v_rcp_f32 v22, v22
    s_nop 0
    v_mul_f32 v43, v43, v22
    s_waitcnt vmcnt(51)
    v_lshlrev_b32 v44, 16, v44
    v_mul_f32 v22, 0xbfb8aa3b, v44
    v_exp_f32 v22, v22
    s_nop 0
    v_add_f32 v22, 1.0, v22
    v_rcp_f32 v22, v22
    s_nop 0
    v_mul_f32 v44, v44, v22
    s_waitcnt vmcnt(50)
    v_lshlrev_b32 v45, 16, v45
    v_mul_f32 v22, 0xbfb8aa3b, v45
    v_exp_f32 v22, v22
    s_nop 0
    v_add_f32 v22, 1.0, v22
    v_rcp_f32 v22, v22
    s_nop 0
    v_mul_f32 v45, v45, v22
    s_waitcnt vmcnt(49)
    v_lshlrev_b32 v46, 16, v46
    v_mul_f32 v22, 0xbfb8aa3b, v46
    v_exp_f32 v22, v22
    s_nop 0
    v_add_f32 v22, 1.0, v22
    v_rcp_f32 v22, v22
    s_nop 0
    v_mul_f32 v46, v46, v22
    s_waitcnt vmcnt(48)
    v_lshlrev_b32 v47, 16, v47
    v_mul_f32 v22, 0xbfb8aa3b, v47
    v_exp_f32 v22, v22
    s_nop 0
    v_add_f32 v22, 1.0, v22
    v_rcp_f32 v22, v22
    s_nop 0
    v_mul_f32 v47, v47, v22
    s_waitcnt vmcnt(47)
    v_lshlrev_b32 v48, 16, v48
    v_mul_f32 v22, 0xbfb8aa3b, v48
    v_exp_f32 v22, v22
    s_nop 0
    v_add_f32 v22, 1.0, v22
    v_rcp_f32 v22, v22
    s_nop 0
    v_mul_f32 v48, v48, v22
    s_waitcnt vmcnt(46)
    v_lshlrev_b32 v49, 16, v49
    v_mul_f32 v22, 0xbfb8aa3b, v49
    v_exp_f32 v22, v22
    s_nop 0
    v_add_f32 v22, 1.0, v22
    v_rcp_f32 v22, v22
    s_nop 0
    v_mul_f32 v49, v49, v22
    s_waitcnt vmcnt(45)
    v_lshlrev_b32 v50, 16, v50
    v_mul_f32 v22, 0xbfb8aa3b, v50
    v_exp_f32 v22, v22
    s_nop 0
    v_add_f32 v22, 1.0, v22
    v_rcp_f32 v22, v22
    s_nop 0
    v_mul_f32 v50, v50, v22
    s_waitcnt vmcnt(44)
    v_lshlrev_b32 v51, 16, v51
    v_mul_f32 v22, 0xbfb8aa3b, v51
    v_exp_f32 v22, v22
    s_nop 0
    v_add_f32 v22, 1.0, v22
    v_rcp_f32 v22, v22
    s_nop 0
    v_mul_f32 v51, v51, v22
    s_waitcnt vmcnt(43)
    v_lshlrev_b32 v52, 16, v52
    v_mul_f32 v22, 0xbfb8aa3b, v52
    v_exp_f32 v22, v22
    s_nop 0
    v_add_f32 v22, 1.0, v22
    v_rcp_f32 v22, v22
    s_nop 0
    v_mul_f32 v52, v52, v22
    s_waitcnt vmcnt(42)
    v_lshlrev_b32 v53, 16, v53
    v_mul_f32 v22, 0xbfb8aa3b, v53
    v_exp_f32 v22, v22
    s_nop 0
    v_add_f32 v22, 1.0, v22
    v_rcp_f32 v22, v22
    s_nop 0
    v_mul_f32 v53, v53, v22
    s_waitcnt vmcnt(41)
    v_lshlrev_b32 v54, 16, v54
    v_mul_f32 v22, 0xbfb8aa3b, v54
    v_exp_f32 v22, v22
    s_nop 0
    v_add_f32 v22, 1.0, v22
    v_rcp_f32 v22, v22
    s_nop 0
    v_mul_f32 v54, v54, v22
    s_waitcnt vmcnt(40)
    v_lshlrev_b32 v55, 16, v55
    v_mul_f32 v22, 0xbfb8aa3b, v55
    v_exp_f32 v22, v22
    s_nop 0
    v_add_f32 v22, 1.0, v22
    v_rcp_f32 v22, v22
    s_nop 0
    v_mul_f32 v55, v55, v22
    s_waitcnt vmcnt(39)
    v_lshlrev_b32 v56, 16, v56
    v_mul_f32 v22, 0xbfb8aa3b, v56
    v_exp_f32 v22, v22
    s_nop 0
    v_add_f32 v22, 1.0, v22
    v_rcp_f32 v22, v22
    s_nop 0
    v_mul_f32 v56, v56, v22
    s_waitcnt vmcnt(38)
    v_lshlrev_b32 v57, 16, v57
    v_mul_f32 v22, 0xbfb8aa3b, v57
    v_exp_f32 v22, v22
    s_nop 0
    v_add_f32 v22, 1.0, v22
    v_rcp_f32 v22, v22
    s_nop 0
    v_mul_f32 v57, v57, v22
    s_waitcnt vmcnt(37)
    v_lshlrev_b32 v58, 16, v58
    v_mul_f32 v22, 0xbfb8aa3b, v58
    v_exp_f32 v22, v22
    s_nop 0
    v_add_f32 v22, 1.0, v22
    v_rcp_f32 v22, v22
    s_nop 0
    v_mul_f32 v58, v58, v22
    s_waitcnt vmcnt(36)
    v_lshlrev_b32 v59, 16, v59
    v_mul_f32 v22, 0xbfb8aa3b, v59
    v_exp_f32 v22, v22
    s_nop 0
    v_add_f32 v22, 1.0, v22
    v_rcp_f32 v22, v22
    s_nop 0
    v_mul_f32 v59, v59, v22
    s_waitcnt vmcnt(35)
    v_lshlrev_b32 v60, 16, v60
    v_mul_f32 v22, 0xbfb8aa3b, v60
    v_exp_f32 v22, v22
    s_nop 0
    v_add_f32 v22, 1.0, v22
    v_rcp_f32 v22, v22
    s_nop 0
    v_mul_f32 v60, v60, v22
    s_waitcnt vmcnt(34)
    v_lshlrev_b32 v61, 16, v61
    v_mul_f32 v22, 0xbfb8aa3b, v61
    v_exp_f32 v22, v22
    s_nop 0
    v_add_f32 v22, 1.0, v22
    v_rcp_f32 v22, v22
    s_nop 0
    v_mul_f32 v61, v61, v22
    s_waitcnt vmcnt(33)
    v_lshlrev_b32 v62, 16, v62
    v_mul_f32 v22, 0xbfb8aa3b, v62
    v_exp_f32 v22, v22
    s_nop 0
    v_add_f32 v22, 1.0, v22
    v_rcp_f32 v22, v22
    s_nop 0
    v_mul_f32 v62, v62, v22
    s_waitcnt vmcnt(32)
    v_lshlrev_b32 v63, 16, v63
    v_mul_f32 v22, 0xbfb8aa3b, v63
    v_exp_f32 v22, v22
    s_nop 0
    v_add_f32 v22, 1.0, v22
    v_rcp_f32 v22, v22
    s_nop 0
    v_mul_f32 v63, v63, v22
    s_waitcnt vmcnt(31)
    v_lshlrev_b32 v22, 16, v64
    v_and_b32 v23, 0xffff0000, v64
    v_fmac_f32 v20, v22, v32
    v_fmac_f32 v21, v23, v32
    s_waitcnt vmcnt(30)
    v_lshlrev_b32 v22, 16, v65
    v_and_b32 v23, 0xffff0000, v65
    v_fmac_f32 v20, v22, v33
    v_fmac_f32 v21, v23, v33
    s_waitcnt vmcnt(29)
    v_lshlrev_b32 v22, 16, v66
    v_and_b32 v23, 0xffff0000, v66
    v_fmac_f32 v20, v22, v34
    v_fmac_f32 v21, v23, v34
    s_waitcnt vmcnt(28)
    v_lshlrev_b32 v22, 16, v67
    v_and_b32 v23, 0xffff0000, v67
    v_fmac_f32 v20, v22, v35
    v_fmac_f32 v21, v23, v35
    s_waitcnt vmcnt(27)
    v_lshlrev_b32 v22, 16, v68
    v_and_b32 v23, 0xffff0000, v68
    v_fmac_f32 v20, v22, v36
    v_fmac_f32 v21, v23, v36
    s_waitcnt vmcnt(26)
    v_lshlrev_b32 v22, 16, v69
    v_and_b32 v23, 0xffff0000, v69
    v_fmac_f32 v20, v22, v37
    v_fmac_f32 v21, v23, v37
    s_waitcnt vmcnt(25)
    v_lshlrev_b32 v22, 16, v70
    v_and_b32 v23, 0xffff0000, v70
    v_fmac_f32 v20, v22, v38
    v_fmac_f32 v21, v23, v38
    s_waitcnt vmcnt(24)
    v_lshlrev_b32 v22, 16, v71
    v_and_b32 v23, 0xffff0000, v71
    v_fmac_f32 v20, v22, v39
    v_fmac_f32 v21, v23, v39
    s_waitcnt vmcnt(23)
    v_lshlrev_b32 v22, 16, v72
    v_and_b32 v23, 0xffff0000, v72
    v_fmac_f32 v20, v22, v40
    v_fmac_f32 v21, v23, v40
    s_waitcnt vmcnt(22)
    v_lshlrev_b32 v22, 16, v73
    v_and_b32 v23, 0xffff0000, v73
    v_fmac_f32 v20, v22, v41
    v_fmac_f32 v21, v23, v41
    s_waitcnt vmcnt(21)
    v_lshlrev_b32 v22, 16, v74
    v_and_b32 v23, 0xffff0000, v74
    v_fmac_f32 v20, v22, v42
    v_fmac_f32 v21, v23, v42
    s_waitcnt vmcnt(20)
    v_lshlrev_b32 v22, 16, v75
    v_and_b32 v23, 0xffff0000, v75
    v_fmac_f32 v20, v22, v43
    v_fmac_f32 v21, v23, v43
    s_waitcnt vmcnt(19)
    v_lshlrev_b32 v22, 16, v76
    v_and_b32 v23, 0xffff0000, v76
    v_fmac_f32 v20, v22, v44
    v_fmac_f32 v21, v23, v44
    s_waitcnt vmcnt(18)
    v_lshlrev_b32 v22, 16, v77
    v_and_b32 v23, 0xffff0000, v77
    v_fmac_f32 v20, v22, v45
    v_fmac_f32 v21, v23, v45
    s_waitcnt vmcnt(17)
    v_lshlrev_b32 v22, 16, v78
    v_and_b32 v23, 0xffff0000, v78
    v_fmac_f32 v20, v22, v46
    v_fmac_f32 v21, v23, v46
    s_waitcnt vmcnt(16)
    v_lshlrev_b32 v22, 16, v79
    v_and_b32 v23, 0xffff0000, v79
    v_fmac_f32 v20, v22, v47
    v_fmac_f32 v21, v23, v47
    s_waitcnt vmcnt(15)
    v_lshlrev_b32 v22, 16, v80
    v_and_b32 v23, 0xffff0000, v80
    v_fmac_f32 v20, v22, v48
    v_fmac_f32 v21, v23, v48
    s_waitcnt vmcnt(14)
    v_lshlrev_b32 v22, 16, v81
    v_and_b32 v23, 0xffff0000, v81
    v_fmac_f32 v20, v22, v49
    v_fmac_f32 v21, v23, v49
    s_waitcnt vmcnt(13)
    v_lshlrev_b32 v22, 16, v82
    v_and_b32 v23, 0xffff0000, v82
    v_fmac_f32 v20, v22, v50
    v_fmac_f32 v21, v23, v50
    s_waitcnt vmcnt(12)
    v_lshlrev_b32 v22, 16, v83
    v_and_b32 v23, 0xffff0000, v83
    v_fmac_f32 v20, v22, v51
    v_fmac_f32 v21, v23, v51
    s_waitcnt vmcnt(11)
    v_lshlrev_b32 v22, 16, v84
    v_and_b32 v23, 0xffff0000, v84
    v_fmac_f32 v20, v22, v52
    v_fmac_f32 v21, v23, v52
    s_waitcnt vmcnt(10)
    v_lshlrev_b32 v22, 16, v85
    v_and_b32 v23, 0xffff0000, v85
    v_fmac_f32 v20, v22, v53
    v_fmac_f32 v21, v23, v53
    s_waitcnt vmcnt(9)
    v_lshlrev_b32 v22, 16, v86
    v_and_b32 v23, 0xffff0000, v86
    v_fmac_f32 v20, v22, v54
    v_fmac_f32 v21, v23, v54
    s_waitcnt vmcnt(8)
    v_lshlrev_b32 v22, 16, v87
    v_and_b32 v23, 0xffff0000, v87
    v_fmac_f32 v20, v22, v55
    v_fmac_f32 v21, v23, v55
    s_waitcnt vmcnt(7)
    v_lshlrev_b32 v22, 16, v88
    v_and_b32 v23, 0xffff0000, v88
    v_fmac_f32 v20, v22, v56
    v_fmac_f32 v21, v23, v56
    s_waitcnt vmcnt(6)
    v_lshlrev_b32 v22, 16, v89
    v_and_b32 v23, 0xffff0000, v89
    v_fmac_f32 v20, v22, v57
    v_fmac_f32 v21, v23, v57
    s_waitcnt vmcnt(5)
    v_lshlrev_b32 v22, 16, v90
    v_and_b32 v23, 0xffff0000, v90
    v_fmac_f32 v20, v22, v58
    v_fmac_f32 v21, v23, v58
    s_waitcnt vmcnt(4)
    v_lshlrev_b32 v22, 16, v91
    v_and_b32 v23, 0xffff0000, v91
    v_fmac_f32 v20, v22, v59
    v_fmac_f32 v21, v23, v59
    s_waitcnt vmcnt(3)
    v_lshlrev_b32 v22, 16, v92
    v_and_b32 v23, 0xffff0000, v92
    v_fmac_f32 v20, v22, v60
    v_fmac_f32 v21, v23, v60
    s_waitcnt vmcnt(2)
    v_lshlrev_b32 v22, 16, v93
    v_and_b32 v23, 0xffff0000, v93
    v_fmac_f32 v20, v22, v61
    v_fmac_f32 v21, v23, v61
    s_waitcnt vmcnt(1)
    v_lshlrev_b32 v22, 16, v94
    v_and_b32 v23, 0xffff0000, v94
    v_fmac_f32 v20, v22, v62
    v_fmac_f32 v21, v23, v62
    s_waitcnt vmcnt(0)
    v_lshlrev_b32 v22, 16, v95
    v_and_b32 v23, 0xffff0000, v95
    v_fmac_f32 v20, v22, v63
    v_fmac_f32 v21, v23, v63
    v_lshlrev_b32 v9, 3, v0
    ds_write_b64 v9, v[20:21]
    s_waitcnt lgkmcnt(0)
    s_barrier
    v_cmp_gt_u32 vcc, 32, v0
    s_and_saveexec_b64 s[20:21], vcc
    s_cbranch_execz mod_done
    v_lshrrev_b32 v10, 1, v0
    v_and_b32 v11, 1, v0
    v_lshlrev_b32 v10, 3, v10
    v_lshl_add_u32 v10, v11, 2, v10
    v_mov_b32 v20, 0

    ds_read_b32 v32, v10 offset:0
    ds_read_b32 v33, v10 offset:128
    ds_read_b32 v34, v10 offset:256
    ds_read_b32 v35, v10 offset:384
    ds_read_b32 v36, v10 offset:512
    ds_read_b32 v37, v10 offset:640
    ds_read_b32 v38, v10 offset:768
    ds_read_b32 v39, v10 offset:896
    ds_read_b32 v40, v10 offset:1024
    ds_read_b32 v41, v10 offset:1152
    ds_read_b32 v42, v10 offset:1280
    ds_read_b32 v43, v10 offset:1408
    ds_read_b32 v44, v10 offset:1536
    ds_read_b32 v45, v10 offset:1664
    ds_read_b32 v46, v10 offset:1792
    ds_read_b32 v47, v10 offset:1920
    s_waitcnt lgkmcnt(0)
    v_add_f32 v20, v20, v32
    v_add_f32 v20, v20, v33
    v_add_f32 v20, v20, v34
    v_add_f32 v20, v20, v35
    v_add_f32 v20, v20, v36
    v_add_f32 v20, v20, v37
    v_add_f32 v20, v20, v38
    v_add_f32 v20, v20, v39
    v_add_f32 v20, v20, v40
    v_add_f32 v20, v20, v41
    v_add_f32 v20, v20, v42
    v_add_f32 v20, v20, v43
    v_add_f32 v20, v20, v44
    v_add_f32 v20, v20, v45
    v_add_f32 v20, v20, v46
    v_add_f32 v20, v20, v47
    s_lshl_b32 s3, s2, 7
    v_lshlrev_b32 v12, 2, v0
    v_add_u32 v12, s3, v12
    buffer_store_dword v20, v12, s[16:19], 0 offen

mod_done:
    s_endpgm
.globl ln1_kernel
.p2align 8
.type ln1_kernel,@function
ln1_kernel:
    s_cmp_ge_u32 s2, 512
    s_cbranch_scc1 ln_done_1
    s_load_dwordx2 s[8:9], s[0:1], 0
    s_mov_b32 s10, 2097152
    s_mov_b32 s11, 0x00020000
    s_load_dwordx2 s[12:13], s[0:1], 104
    s_mov_b32 s14, 12288
    s_mov_b32 s15, 0x00020000
    s_load_dwordx2 s[16:17], s[0:1], 104
    s_mov_b32 s18, 2097152
    s_mov_b32 s19, 0x00020000
    v_lshrrev_b32 v1, 6, v0
    v_and_b32 v2, 63, v0
    s_lshl_b32 s3, s2, 2
    v_add_u32 v1, s3, v1
    v_lshlrev_b32 v3, 10, v1
    v_lshl_add_u32 v3, v2, 4, v3
    v_lshlrev_b32 v4, 5, v2
    v_lshlrev_b32 v5, 10, v1
    v_lshl_add_u32 v5, v2, 4, v5
    v_lshlrev_b32 v6, 2, v2
    s_waitcnt lgkmcnt(0)

    s_add_u32 s16, s16, 1048576
    s_addc_u32 s17, s17, 0
    buffer_load_dwordx4 v[24:27], v3, s[8:11], 0 offen
    s_mov_b32 s4, 2048
    s_mov_b32 s5, 0
    buffer_load_dwordx4 v[32:35], v4, s[12:15], s4 offen
    buffer_load_dwordx4 v[36:39], v4, s[12:15], s4 offen offset:16
    buffer_load_dwordx4 v[40:43], v4, s[12:15], s5 offen
    buffer_load_dwordx4 v[44:47], v4, s[12:15], s5 offen offset:16
    s_waitcnt vmcnt(4)
    v_lshlrev_b32 v8, 16, v24
    v_and_b32 v9, 0xffff0000, v24
    v_lshlrev_b32 v10, 16, v25
    v_and_b32 v11, 0xffff0000, v25
    v_lshlrev_b32 v12, 16, v26
    v_and_b32 v13, 0xffff0000, v26
    v_lshlrev_b32 v14, 16, v27
    v_and_b32 v15, 0xffff0000, v27
    v_add_f32 v16, v8, v9
    v_add_f32 v16, v16, v10
    v_add_f32 v16, v16, v11
    v_add_f32 v16, v16, v12
    v_add_f32 v16, v16, v13
    v_add_f32 v16, v16, v14
    v_add_f32 v16, v16, v15
    v_xor_b32 v17, 4, v6
    ds_bpermute_b32 v17, v17, v16
    s_waitcnt lgkmcnt(0)
    v_add_f32 v16, v16, v17
    v_xor_b32 v17, 8, v6
    ds_bpermute_b32 v17, v17, v16
    s_waitcnt lgkmcnt(0)
    v_add_f32 v16, v16, v17
    v_xor_b32 v17, 16, v6
    ds_bpermute_b32 v17, v17, v16
    s_waitcnt lgkmcnt(0)
    v_add_f32 v16, v16, v17
    v_xor_b32 v17, 32, v6
    ds_bpermute_b32 v17, v17, v16
    s_waitcnt lgkmcnt(0)
    v_add_f32 v16, v16, v17
    v_xor_b32 v17, 64, v6
    ds_bpermute_b32 v17, v17, v16
    s_waitcnt lgkmcnt(0)
    v_add_f32 v16, v16, v17
    v_xor_b32 v17, 128, v6
    ds_bpermute_b32 v17, v17, v16
    s_waitcnt lgkmcnt(0)
    v_add_f32 v16, v16, v17
    v_mul_f32 v16, 0x3b000000, v16
    v_sub_f32 v8, v8, v16
    v_sub_f32 v9, v9, v16
    v_sub_f32 v10, v10, v16
    v_sub_f32 v11, v11, v16
    v_sub_f32 v12, v12, v16
    v_sub_f32 v13, v13, v16
    v_sub_f32 v14, v14, v16
    v_sub_f32 v15, v15, v16
    v_mul_f32 v18, v8, v8
    v_fmac_f32 v18, v9, v9
    v_fmac_f32 v18, v10, v10
    v_fmac_f32 v18, v11, v11
    v_fmac_f32 v18, v12, v12
    v_fmac_f32 v18, v13, v13
    v_fmac_f32 v18, v14, v14
    v_fmac_f32 v18, v15, v15
    v_xor_b32 v17, 4, v6
    ds_bpermute_b32 v17, v17, v18
    s_waitcnt lgkmcnt(0)
    v_add_f32 v18, v18, v17
    v_xor_b32 v17, 8, v6
    ds_bpermute_b32 v17, v17, v18
    s_waitcnt lgkmcnt(0)
    v_add_f32 v18, v18, v17
    v_xor_b32 v17, 16, v6
    ds_bpermute_b32 v17, v17, v18
    s_waitcnt lgkmcnt(0)
    v_add_f32 v18, v18, v17
    v_xor_b32 v17, 32, v6
    ds_bpermute_b32 v17, v17, v18
    s_waitcnt lgkmcnt(0)
    v_add_f32 v18, v18, v17
    v_xor_b32 v17, 64, v6
    ds_bpermute_b32 v17, v17, v18
    s_waitcnt lgkmcnt(0)
    v_add_f32 v18, v18, v17
    v_xor_b32 v17, 128, v6
    ds_bpermute_b32 v17, v17, v18
    s_waitcnt lgkmcnt(0)
    v_add_f32 v18, v18, v17
    v_mov_b32 v19, 0x3727c5ac
    v_fmac_f32 v19, 0x3b000000, v18
    v_rsq_f32 v19, v19
    s_waitcnt vmcnt(0)

    v_add_f32 v32, 1.0, v32
    v_mul_f32 v8, v8, v19
    v_fma_f32 v8, v8, v32, v40
    v_add_f32 v33, 1.0, v33
    v_mul_f32 v9, v9, v19
    v_fma_f32 v9, v9, v33, v41
    v_add_f32 v34, 1.0, v34
    v_mul_f32 v10, v10, v19
    v_fma_f32 v10, v10, v34, v42
    v_add_f32 v35, 1.0, v35
    v_mul_f32 v11, v11, v19
    v_fma_f32 v11, v11, v35, v43
    v_add_f32 v36, 1.0, v36
    v_mul_f32 v12, v12, v19
    v_fma_f32 v12, v12, v36, v44
    v_add_f32 v37, 1.0, v37
    v_mul_f32 v13, v13, v19
    v_fma_f32 v13, v13, v37, v45
    v_add_f32 v38, 1.0, v38
    v_mul_f32 v14, v14, v19
    v_fma_f32 v14, v14, v38, v46
    v_add_f32 v39, 1.0, v39
    v_mul_f32 v15, v15, v19
    v_fma_f32 v15, v15, v39, v47
    v_cvt_pk_bf16_f32 v20, v8, v9
    v_cvt_pk_bf16_f32 v21, v10, v11
    v_cvt_pk_bf16_f32 v22, v12, v13
    v_cvt_pk_bf16_f32 v23, v14, v15
    buffer_store_dwordx4 v[20:23], v5, s[16:19], 0 offen
ln_done_1:
    s_endpgm
.globl qkv_kernel
.p2align 8
.type qkv_kernel,@function
qkv_kernel:
    s_cmp_ge_u32 s2, 512
    s_cbranch_scc1 qkv_done
    s_and_b32 s4, s2, 7
    s_bfe_u32 s5, s2, 0x50003
    s_and_b32 s33, s5, 7
    s_lshl_b32 s33, s33, 8
    s_lshr_b32 s5, s5, 3
    s_mov_b32 s31, 0
    s_mov_b32 s32, 0
    s_cmp_ge_u32 s2, 256
    s_cbranch_scc1 qkv_q
    s_lshr_b32 s6, s5, 1
    s_and_b32 s5, s5, 1
    s_lshl_b32 s37, s4, 2
    s_lshl_b32 s5, s5, 1
    s_add_u32 s37, s37, s5
    s_lshl_b32 s34, s37, 7
    s_cmp_eq_u32 s6, 1
    s_cbranch_scc1 qkv_v

qkv_k:
    v_and_b32 v26, 63, v0
    v_and_b32 v24, 31, v0
    v_bfe_u32 v25, v0, 5, 1
    v_lshrrev_b32 v1, 6, v0
    s_nop 0
    v_readfirstlane_b32 s40, v1
    s_nop 3
    s_lshr_b32 s41, s40, 2
    s_and_b32 s42, s40, 3

    s_load_dwordx2 s[8:9], s[0:1], 8
    s_mov_b32 s10, 2097152
    s_mov_b32 s11, 0x00020000
    s_load_dwordx2 s[12:13], s[0:1], 24
    s_mov_b32 s14, 4194304
    s_mov_b32 s15, 0x00020000
    s_load_dwordx2 s[16:17], s[0:1], 104
    s_mov_b32 s18, 16777216
    s_mov_b32 s19, 0x00020000
    s_waitcnt lgkmcnt(0)
    s_add_u32 s16, s16, 33554432
    s_addc_u32 s17, s17, 0
    v_lshrrev_b32 v1, 3, v26
    v_lshrrev_b32 v2, 4, v26
    v_and_b32 v3, 7, v26
    s_mul_i32 s4, s40, 4
    s_mov_b32 s5, 1024

    s_add_u32 s6, s4, 0
    s_lshl_b32 s7, s6, 2
    v_add_u32 v4, s7, v2
    v_and_b32 v4, 7, v4
    v_xor_b32 v4, v4, v3
    s_lshl_b32 s7, s6, 3
    s_add_u32 s7, s7, s33
    v_add_u32 v5, s7, v1
    v_mul_lo_u32 v5, v5, s5
    v_lshl_add_u32 v32, v4, 4, v5

    s_add_u32 s6, s4, 1
    s_lshl_b32 s7, s6, 2
    v_add_u32 v4, s7, v2
    v_and_b32 v4, 7, v4
    v_xor_b32 v4, v4, v3
    s_lshl_b32 s7, s6, 3
    s_add_u32 s7, s7, s33
    v_add_u32 v5, s7, v1
    v_mul_lo_u32 v5, v5, s5
    v_lshl_add_u32 v33, v4, 4, v5

    s_add_u32 s6, s4, 2
    s_lshl_b32 s7, s6, 2
    v_add_u32 v4, s7, v2
    v_and_b32 v4, 7, v4
    v_xor_b32 v4, v4, v3
    s_lshl_b32 s7, s6, 3
    s_add_u32 s7, s7, s33
    v_add_u32 v5, s7, v1
    v_mul_lo_u32 v5, v5, s5
    v_lshl_add_u32 v34, v4, 4, v5

    s_add_u32 s6, s4, 3
    s_lshl_b32 s7, s6, 2
    v_add_u32 v4, s7, v2
    v_and_b32 v4, 7, v4
    v_xor_b32 v4, v4, v3
    s_lshl_b32 s7, s6, 3
    s_add_u32 s7, s7, s33
    v_add_u32 v5, s7, v1
    v_mul_lo_u32 v5, v5, s5
    v_lshl_add_u32 v35, v4, 4, v5

    s_mul_i32 s4, s40, 4
    s_mov_b32 s5, 8192
    s_lshl_b32 s44, s34, 1
    v_lshlrev_b32 v1, 4, v26

    s_add_u32 s6, s4, 0
    s_lshl_b32 s6, s6, 10
    v_add_u32 v2, s6, v1
    v_lshrrev_b32 v3, 9, v2
    v_and_b32 v4, 511, v2

    v_and_b32 v5, 3, v3
    v_lshlrev_b32 v5, 6, v5
    v_xor_b32 v4, v4, v5
    v_mul_lo_u32 v3, v3, s5
    v_add_u32 v3, v3, v4
    v_add_u32 v36, s44, v3
    s_add_u32 s6, s4, 1
    s_lshl_b32 s6, s6, 10
    v_add_u32 v2, s6, v1
    v_lshrrev_b32 v3, 9, v2
    v_and_b32 v4, 511, v2

    v_and_b32 v5, 3, v3
    v_lshlrev_b32 v5, 6, v5
    v_xor_b32 v4, v4, v5
    v_mul_lo_u32 v3, v3, s5
    v_add_u32 v3, v3, v4
    v_add_u32 v37, s44, v3
    s_add_u32 s6, s4, 2
    s_lshl_b32 s6, s6, 10
    v_add_u32 v2, s6, v1
    v_lshrrev_b32 v3, 9, v2
    v_and_b32 v4, 511, v2

    v_and_b32 v5, 3, v3
    v_lshlrev_b32 v5, 6, v5
    v_xor_b32 v4, v4, v5
    v_mul_lo_u32 v3, v3, s5
    v_add_u32 v3, v3, v4
    v_add_u32 v38, s44, v3
    s_add_u32 s6, s4, 3
    s_lshl_b32 s6, s6, 10
    v_add_u32 v2, s6, v1
    v_lshrrev_b32 v3, 9, v2
    v_and_b32 v4, 511, v2

    v_and_b32 v5, 3, v3
    v_lshlrev_b32 v5, 6, v5
    v_xor_b32 v4, v4, v5
    v_mul_lo_u32 v3, v3, s5
    v_add_u32 v3, v3, v4
    v_add_u32 v39, s44, v3
    s_mul_i32 s4, s41, 128
    v_add_u32 v1, s4, v24
    v_bfe_u32 v2, v1, 1, 3
    v_lshlrev_b32 v1, 7, v1

    v_add_u32 v3, 0, v25
    v_xor_b32 v3, v3, v2
    v_lshl_add_u32 v40, v3, 4, v1
    v_add_u32 v3, 2, v25
    v_xor_b32 v3, v3, v2
    v_lshl_add_u32 v41, v3, 4, v1
    v_add_u32 v3, 4, v25
    v_xor_b32 v3, v3, v2
    v_lshl_add_u32 v42, v3, 4, v1
    v_add_u32 v3, 6, v25
    v_xor_b32 v3, v3, v2
    v_lshl_add_u32 v43, v3, 4, v1
    v_bfe_u32 v1, v26, 2, 2
    v_lshrrev_b32 v2, 5, v26
    v_lshlrev_b32 v2, 12, v2
    v_lshl_add_u32 v2, v1, 9, v2
    v_bfe_u32 v3, v26, 4, 1
    v_lshl_add_u32 v2, v3, 5, v2
    v_and_b32 v3, 3, v26
    v_lshl_add_u32 v2, v3, 3, v2
    v_add_u32 v2, 32768, v2
    s_mul_i32 s4, s42, 2

    s_add_u32 s5, s4, 0
    v_xor_b32 v3, s5, v1
    v_lshl_add_u32 v48, v3, 6, v2
    s_add_u32 s5, s4, 1
    v_xor_b32 v3, s5, v1
    v_lshl_add_u32 v49, v3, 6, v2
    v_add_u32 v44, 65536, v40
    v_add_u32 v45, 65536, v41
    v_add_u32 v46, 65536, v42
    v_add_u32 v47, 65536, v43
    v_add_u32 v50, 65536, v48
    v_add_u32 v51, 65536, v49
    v_mov_b32 v116, 0
    v_mov_b32 v117, 0
    v_mov_b32 v118, 0
    v_mov_b32 v119, 0
    v_mov_b32 v120, 0
    v_mov_b32 v121, 0
    v_mov_b32 v122, 0
    v_mov_b32 v123, 0
    v_mov_b32 v124, 0
    v_mov_b32 v125, 0
    v_mov_b32 v126, 0
    v_mov_b32 v127, 0
    v_mov_b32 v128, 0
    v_mov_b32 v129, 0
    v_mov_b32 v130, 0
    v_mov_b32 v131, 0
    v_mov_b32 v132, 0
    v_mov_b32 v133, 0
    v_mov_b32 v134, 0
    v_mov_b32 v135, 0
    v_mov_b32 v136, 0
    v_mov_b32 v137, 0
    v_mov_b32 v138, 0
    v_mov_b32 v139, 0
    v_mov_b32 v140, 0
    v_mov_b32 v141, 0
    v_mov_b32 v142, 0
    v_mov_b32 v143, 0
    v_mov_b32 v144, 0
    v_mov_b32 v145, 0
    v_mov_b32 v146, 0
    v_mov_b32 v147, 0
    v_mov_b32 v148, 0
    v_mov_b32 v149, 0
    v_mov_b32 v150, 0
    v_mov_b32 v151, 0
    v_mov_b32 v152, 0
    v_mov_b32 v153, 0
    v_mov_b32 v154, 0
    v_mov_b32 v155, 0
    v_mov_b32 v156, 0
    v_mov_b32 v157, 0
    v_mov_b32 v158, 0
    v_mov_b32 v159, 0
    v_mov_b32 v160, 0
    v_mov_b32 v161, 0
    v_mov_b32 v162, 0
    v_mov_b32 v163, 0
    v_mov_b32 v164, 0
    v_mov_b32 v165, 0
    v_mov_b32 v166, 0
    v_mov_b32 v167, 0
    v_mov_b32 v168, 0
    v_mov_b32 v169, 0
    v_mov_b32 v170, 0
    v_mov_b32 v171, 0
    v_mov_b32 v172, 0
    v_mov_b32 v173, 0
    v_mov_b32 v174, 0
    v_mov_b32 v175, 0
    v_mov_b32 v176, 0
    v_mov_b32 v177, 0
    v_mov_b32 v178, 0
    v_mov_b32 v179, 0
    v_mov_b32 v180, 0
    v_mov_b32 v181, 0
    v_mov_b32 v182, 0
    v_mov_b32 v183, 0
    v_mov_b32 v184, 0
    v_mov_b32 v185, 0
    v_mov_b32 v186, 0
    v_mov_b32 v187, 0
    v_mov_b32 v188, 0
    v_mov_b32 v189, 0
    v_mov_b32 v190, 0
    v_mov_b32 v191, 0
    v_mov_b32 v192, 0
    v_mov_b32 v193, 0
    v_mov_b32 v194, 0
    v_mov_b32 v195, 0
    v_mov_b32 v196, 0
    v_mov_b32 v197, 0
    v_mov_b32 v198, 0
    v_mov_b32 v199, 0
    v_mov_b32 v200, 0
    v_mov_b32 v201, 0
    v_mov_b32 v202, 0
    v_mov_b32 v203, 0
    v_mov_b32 v204, 0
    v_mov_b32 v205, 0
    v_mov_b32 v206, 0
    v_mov_b32 v207, 0
    v_mov_b32 v208, 0
    v_mov_b32 v209, 0
    v_mov_b32 v210, 0
    v_mov_b32 v211, 0
    v_mov_b32 v212, 0
    v_mov_b32 v213, 0
    v_mov_b32 v214, 0
    v_mov_b32 v215, 0
    v_mov_b32 v216, 0
    v_mov_b32 v217, 0
    v_mov_b32 v218, 0
    v_mov_b32 v219, 0
    v_mov_b32 v220, 0
    v_mov_b32 v221, 0
    v_mov_b32 v222, 0
    v_mov_b32 v223, 0
    v_mov_b32 v224, 0
    v_mov_b32 v225, 0
    v_mov_b32 v226, 0
    v_mov_b32 v227, 0
    v_mov_b32 v228, 0
    v_mov_b32 v229, 0
    v_mov_b32 v230, 0
    v_mov_b32 v231, 0
    v_mov_b32 v232, 0
    v_mov_b32 v233, 0
    v_mov_b32 v234, 0
    v_mov_b32 v235, 0
    v_mov_b32 v236, 0
    v_mov_b32 v237, 0
    v_mov_b32 v238, 0
    v_mov_b32 v239, 0
    v_mov_b32 v240, 0
    v_mov_b32 v241, 0
    v_mov_b32 v242, 0
    v_mov_b32 v243, 0
    s_lshl_b32 s45, s40, 10
    s_mul_i32 s46, s45, 4
    s_mul_i32 s45, s45, 4
    s_mov_b32 s53, s31
    s_mov_b32 s54, s32
    s_lshr_b32 s52, s2, 3
    s_and_b32 s52, s52, 31

    s_sub_u32 s4, s52, 8
    s_cmp_ge_u32 s52, 8
    s_cselect_b32 s52, s4, s52
    s_sub_u32 s4, s52, 8
    s_cmp_ge_u32 s52, 8
    s_cselect_b32 s52, s4, s52
    s_sub_u32 s4, s52, 8
    s_cmp_ge_u32 s52, 8
    s_cselect_b32 s52, s4, s52
    s_sub_u32 s4, s52, 8
    s_cmp_ge_u32 s52, 8
    s_cselect_b32 s52, s4, s52
    s_lshl_b32 s31, s52, 7
    s_add_u32 s31, s31, s53
    s_mul_i32 s32, s52, 524288
    s_add_u32 s32, s32, s54
    s_add_u32 s52, s52, 1
    s_cmp_eq_u32 s52, 8
    s_cselect_b32 s52, 0, s52
    s_add_u32 m0, s45, 0
    s_nop 0
    buffer_load_dwordx4 v32, s[8:11], s31 offen lds
    s_add_u32 m0, s45, 1024
    s_nop 0
    buffer_load_dwordx4 v33, s[8:11], s31 offen lds
    s_add_u32 m0, s45, 2048
    s_nop 0
    buffer_load_dwordx4 v34, s[8:11], s31 offen lds
    s_add_u32 m0, s45, 3072
    s_nop 0
    buffer_load_dwordx4 v35, s[8:11], s31 offen lds
    s_add_u32 m0, s46, 32768
    s_nop 0
    buffer_load_dwordx4 v36, s[12:15], s32 offen lds
    s_add_u32 m0, s46, 33792
    s_nop 0
    buffer_load_dwordx4 v37, s[12:15], s32 offen lds
    s_add_u32 m0, s46, 34816
    s_nop 0
    buffer_load_dwordx4 v38, s[12:15], s32 offen lds
    s_add_u32 m0, s46, 35840
    s_nop 0
    buffer_load_dwordx4 v39, s[12:15], s32 offen lds
    s_mov_b32 s30, 3
gloop_2:
    s_waitcnt vmcnt(0)
    s_barrier
    ds_read_b128 v[52:55], v40 offset:0
    ds_read_b128 v[56:59], v40 offset:4096
    ds_read_b128 v[60:63], v40 offset:8192
    ds_read_b128 v[64:67], v40 offset:12288
    ds_read_b64_tr_b16 v[68:69], v48 offset:0
    ds_read_b64_tr_b16 v[70:71], v48 offset:2048
    ds_read_b64_tr_b16 v[72:73], v49 offset:0
    ds_read_b64_tr_b16 v[74:75], v49 offset:2048
    ds_read_b128 v[76:79], v41 offset:0
    ds_read_b128 v[80:83], v41 offset:4096
    ds_read_b128 v[84:87], v41 offset:8192
    ds_read_b128 v[88:91], v41 offset:12288
    ds_read_b64_tr_b16 v[92:93], v48 offset:8192
    ds_read_b64_tr_b16 v[94:95], v48 offset:10240
    ds_read_b64_tr_b16 v[96:97], v49 offset:8192
    ds_read_b64_tr_b16 v[98:99], v49 offset:10240
    s_lshl_b32 s31, s52, 7
    s_add_u32 s31, s31, s53
    s_mul_i32 s32, s52, 524288
    s_add_u32 s32, s32, s54
    s_add_u32 s52, s52, 1
    s_cmp_eq_u32 s52, 8
    s_cselect_b32 s52, 0, s52
    s_add_u32 m0, s45, 65536
    s_nop 0
    buffer_load_dwordx4 v32, s[8:11], s31 offen lds
    s_add_u32 m0, s45, 66560
    s_nop 0
    buffer_load_dwordx4 v33, s[8:11], s31 offen lds
    s_add_u32 m0, s45, 67584
    s_nop 0
    buffer_load_dwordx4 v34, s[8:11], s31 offen lds
    s_add_u32 m0, s45, 68608
    s_nop 0
    buffer_load_dwordx4 v35, s[8:11], s31 offen lds
    s_add_u32 m0, s46, 98304
    s_nop 0
    buffer_load_dwordx4 v36, s[12:15], s32 offen lds
    s_add_u32 m0, s46, 99328
    s_nop 0
    buffer_load_dwordx4 v37, s[12:15], s32 offen lds
    s_add_u32 m0, s46, 100352
    s_nop 0
    buffer_load_dwordx4 v38, s[12:15], s32 offen lds
    s_add_u32 m0, s46, 101376
    s_nop 0
    buffer_load_dwordx4 v39, s[12:15], s32 offen lds
    s_waitcnt lgkmcnt(8)
    v_mfma_f32_32x32x16_bf16 v[116:131], v[68:71], v[52:55], v[116:131]
    v_mfma_f32_32x32x16_bf16 v[132:147], v[72:75], v[52:55], v[132:147]
    v_mfma_f32_32x32x16_bf16 v[148:163], v[68:71], v[56:59], v[148:163]
    v_mfma_f32_32x32x16_bf16 v[164:179], v[72:75], v[56:59], v[164:179]
    v_mfma_f32_32x32x16_bf16 v[180:195], v[68:71], v[60:63], v[180:195]
    v_mfma_f32_32x32x16_bf16 v[196:211], v[72:75], v[60:63], v[196:211]
    v_mfma_f32_32x32x16_bf16 v[212:227], v[68:71], v[64:67], v[212:227]
    v_mfma_f32_32x32x16_bf16 v[228:243], v[72:75], v[64:67], v[228:243]
    ds_read_b128 v[52:55], v42 offset:0
    ds_read_b128 v[56:59], v42 offset:4096
    ds_read_b128 v[60:63], v42 offset:8192
    ds_read_b128 v[64:67], v42 offset:12288
    ds_read_b64_tr_b16 v[68:69], v48 offset:16384
    ds_read_b64_tr_b16 v[70:71], v48 offset:18432
    ds_read_b64_tr_b16 v[72:73], v49 offset:16384
    ds_read_b64_tr_b16 v[74:75], v49 offset:18432
    s_waitcnt lgkmcnt(8)
    v_mfma_f32_32x32x16_bf16 v[116:131], v[92:95], v[76:79], v[116:131]
    v_mfma_f32_32x32x16_bf16 v[132:147], v[96:99], v[76:79], v[132:147]
    v_mfma_f32_32x32x16_bf16 v[148:163], v[92:95], v[80:83], v[148:163]
    v_mfma_f32_32x32x16_bf16 v[164:179], v[96:99], v[80:83], v[164:179]
    v_mfma_f32_32x32x16_bf16 v[180:195], v[92:95], v[84:87], v[180:195]
    v_mfma_f32_32x32x16_bf16 v[196:211], v[96:99], v[84:87], v[196:211]
    v_mfma_f32_32x32x16_bf16 v[212:227], v[92:95], v[88:91], v[212:227]
    v_mfma_f32_32x32x16_bf16 v[228:243], v[96:99], v[88:91], v[228:243]
    ds_read_b128 v[76:79], v43 offset:0
    ds_read_b128 v[80:83], v43 offset:4096
    ds_read_b128 v[84:87], v43 offset:8192
    ds_read_b128 v[88:91], v43 offset:12288
    ds_read_b64_tr_b16 v[92:93], v48 offset:24576
    ds_read_b64_tr_b16 v[94:95], v48 offset:26624
    ds_read_b64_tr_b16 v[96:97], v49 offset:24576
    ds_read_b64_tr_b16 v[98:99], v49 offset:26624
    s_waitcnt lgkmcnt(8)
    v_mfma_f32_32x32x16_bf16 v[116:131], v[68:71], v[52:55], v[116:131]
    v_mfma_f32_32x32x16_bf16 v[132:147], v[72:75], v[52:55], v[132:147]
    v_mfma_f32_32x32x16_bf16 v[148:163], v[68:71], v[56:59], v[148:163]
    v_mfma_f32_32x32x16_bf16 v[164:179], v[72:75], v[56:59], v[164:179]
    v_mfma_f32_32x32x16_bf16 v[180:195], v[68:71], v[60:63], v[180:195]
    v_mfma_f32_32x32x16_bf16 v[196:211], v[72:75], v[60:63], v[196:211]
    v_mfma_f32_32x32x16_bf16 v[212:227], v[68:71], v[64:67], v[212:227]
    v_mfma_f32_32x32x16_bf16 v[228:243], v[72:75], v[64:67], v[228:243]
    s_waitcnt lgkmcnt(0)
    v_mfma_f32_32x32x16_bf16 v[116:131], v[92:95], v[76:79], v[116:131]
    v_mfma_f32_32x32x16_bf16 v[132:147], v[96:99], v[76:79], v[132:147]
    v_mfma_f32_32x32x16_bf16 v[148:163], v[92:95], v[80:83], v[148:163]
    v_mfma_f32_32x32x16_bf16 v[164:179], v[96:99], v[80:83], v[164:179]
    v_mfma_f32_32x32x16_bf16 v[180:195], v[92:95], v[84:87], v[180:195]
    v_mfma_f32_32x32x16_bf16 v[196:211], v[96:99], v[84:87], v[196:211]
    v_mfma_f32_32x32x16_bf16 v[212:227], v[92:95], v[88:91], v[212:227]
    v_mfma_f32_32x32x16_bf16 v[228:243], v[96:99], v[88:91], v[228:243]
    s_waitcnt vmcnt(0)
    s_barrier
    ds_read_b128 v[52:55], v44 offset:0
    ds_read_b128 v[56:59], v44 offset:4096
    ds_read_b128 v[60:63], v44 offset:8192
    ds_read_b128 v[64:67], v44 offset:12288
    ds_read_b64_tr_b16 v[68:69], v50 offset:0
    ds_read_b64_tr_b16 v[70:71], v50 offset:2048
    ds_read_b64_tr_b16 v[72:73], v51 offset:0
    ds_read_b64_tr_b16 v[74:75], v51 offset:2048
    ds_read_b128 v[76:79], v45 offset:0
    ds_read_b128 v[80:83], v45 offset:4096
    ds_read_b128 v[84:87], v45 offset:8192
    ds_read_b128 v[88:91], v45 offset:12288
    ds_read_b64_tr_b16 v[92:93], v50 offset:8192
    ds_read_b64_tr_b16 v[94:95], v50 offset:10240
    ds_read_b64_tr_b16 v[96:97], v51 offset:8192
    ds_read_b64_tr_b16 v[98:99], v51 offset:10240
    s_lshl_b32 s31, s52, 7
    s_add_u32 s31, s31, s53
    s_mul_i32 s32, s52, 524288
    s_add_u32 s32, s32, s54
    s_add_u32 s52, s52, 1
    s_cmp_eq_u32 s52, 8
    s_cselect_b32 s52, 0, s52
    s_add_u32 m0, s45, 0
    s_nop 0
    buffer_load_dwordx4 v32, s[8:11], s31 offen lds
    s_add_u32 m0, s45, 1024
    s_nop 0
    buffer_load_dwordx4 v33, s[8:11], s31 offen lds
    s_add_u32 m0, s45, 2048
    s_nop 0
    buffer_load_dwordx4 v34, s[8:11], s31 offen lds
    s_add_u32 m0, s45, 3072
    s_nop 0
    buffer_load_dwordx4 v35, s[8:11], s31 offen lds
    s_add_u32 m0, s46, 32768
    s_nop 0
    buffer_load_dwordx4 v36, s[12:15], s32 offen lds
    s_add_u32 m0, s46, 33792
    s_nop 0
    buffer_load_dwordx4 v37, s[12:15], s32 offen lds
    s_add_u32 m0, s46, 34816
    s_nop 0
    buffer_load_dwordx4 v38, s[12:15], s32 offen lds
    s_add_u32 m0, s46, 35840
    s_nop 0
    buffer_load_dwordx4 v39, s[12:15], s32 offen lds
    s_waitcnt lgkmcnt(8)
    v_mfma_f32_32x32x16_bf16 v[116:131], v[68:71], v[52:55], v[116:131]
    v_mfma_f32_32x32x16_bf16 v[132:147], v[72:75], v[52:55], v[132:147]
    v_mfma_f32_32x32x16_bf16 v[148:163], v[68:71], v[56:59], v[148:163]
    v_mfma_f32_32x32x16_bf16 v[164:179], v[72:75], v[56:59], v[164:179]
    v_mfma_f32_32x32x16_bf16 v[180:195], v[68:71], v[60:63], v[180:195]
    v_mfma_f32_32x32x16_bf16 v[196:211], v[72:75], v[60:63], v[196:211]
    v_mfma_f32_32x32x16_bf16 v[212:227], v[68:71], v[64:67], v[212:227]
    v_mfma_f32_32x32x16_bf16 v[228:243], v[72:75], v[64:67], v[228:243]
    ds_read_b128 v[52:55], v46 offset:0
    ds_read_b128 v[56:59], v46 offset:4096
    ds_read_b128 v[60:63], v46 offset:8192
    ds_read_b128 v[64:67], v46 offset:12288
    ds_read_b64_tr_b16 v[68:69], v50 offset:16384
    ds_read_b64_tr_b16 v[70:71], v50 offset:18432
    ds_read_b64_tr_b16 v[72:73], v51 offset:16384
    ds_read_b64_tr_b16 v[74:75], v51 offset:18432
    s_waitcnt lgkmcnt(8)
    v_mfma_f32_32x32x16_bf16 v[116:131], v[92:95], v[76:79], v[116:131]
    v_mfma_f32_32x32x16_bf16 v[132:147], v[96:99], v[76:79], v[132:147]
    v_mfma_f32_32x32x16_bf16 v[148:163], v[92:95], v[80:83], v[148:163]
    v_mfma_f32_32x32x16_bf16 v[164:179], v[96:99], v[80:83], v[164:179]
    v_mfma_f32_32x32x16_bf16 v[180:195], v[92:95], v[84:87], v[180:195]
    v_mfma_f32_32x32x16_bf16 v[196:211], v[96:99], v[84:87], v[196:211]
    v_mfma_f32_32x32x16_bf16 v[212:227], v[92:95], v[88:91], v[212:227]
    v_mfma_f32_32x32x16_bf16 v[228:243], v[96:99], v[88:91], v[228:243]
    ds_read_b128 v[76:79], v47 offset:0
    ds_read_b128 v[80:83], v47 offset:4096
    ds_read_b128 v[84:87], v47 offset:8192
    ds_read_b128 v[88:91], v47 offset:12288
    ds_read_b64_tr_b16 v[92:93], v50 offset:24576
    ds_read_b64_tr_b16 v[94:95], v50 offset:26624
    ds_read_b64_tr_b16 v[96:97], v51 offset:24576
    ds_read_b64_tr_b16 v[98:99], v51 offset:26624
    s_waitcnt lgkmcnt(8)
    v_mfma_f32_32x32x16_bf16 v[116:131], v[68:71], v[52:55], v[116:131]
    v_mfma_f32_32x32x16_bf16 v[132:147], v[72:75], v[52:55], v[132:147]
    v_mfma_f32_32x32x16_bf16 v[148:163], v[68:71], v[56:59], v[148:163]
    v_mfma_f32_32x32x16_bf16 v[164:179], v[72:75], v[56:59], v[164:179]
    v_mfma_f32_32x32x16_bf16 v[180:195], v[68:71], v[60:63], v[180:195]
    v_mfma_f32_32x32x16_bf16 v[196:211], v[72:75], v[60:63], v[196:211]
    v_mfma_f32_32x32x16_bf16 v[212:227], v[68:71], v[64:67], v[212:227]
    v_mfma_f32_32x32x16_bf16 v[228:243], v[72:75], v[64:67], v[228:243]
    s_waitcnt lgkmcnt(0)
    v_mfma_f32_32x32x16_bf16 v[116:131], v[92:95], v[76:79], v[116:131]
    v_mfma_f32_32x32x16_bf16 v[132:147], v[96:99], v[76:79], v[132:147]
    v_mfma_f32_32x32x16_bf16 v[148:163], v[92:95], v[80:83], v[148:163]
    v_mfma_f32_32x32x16_bf16 v[164:179], v[96:99], v[80:83], v[164:179]
    v_mfma_f32_32x32x16_bf16 v[180:195], v[92:95], v[84:87], v[180:195]
    v_mfma_f32_32x32x16_bf16 v[196:211], v[96:99], v[84:87], v[196:211]
    v_mfma_f32_32x32x16_bf16 v[212:227], v[92:95], v[88:91], v[212:227]
    v_mfma_f32_32x32x16_bf16 v[228:243], v[96:99], v[88:91], v[228:243]
    s_sub_u32 s30, s30, 1
    s_cmp_lg_u32 s30, 0
    s_cbranch_scc1 gloop_2
    s_waitcnt vmcnt(0)
    s_barrier
    ds_read_b128 v[52:55], v40 offset:0
    ds_read_b128 v[56:59], v40 offset:4096
    ds_read_b128 v[60:63], v40 offset:8192
    ds_read_b128 v[64:67], v40 offset:12288
    ds_read_b64_tr_b16 v[68:69], v48 offset:0
    ds_read_b64_tr_b16 v[70:71], v48 offset:2048
    ds_read_b64_tr_b16 v[72:73], v49 offset:0
    ds_read_b64_tr_b16 v[74:75], v49 offset:2048
    ds_read_b128 v[76:79], v41 offset:0
    ds_read_b128 v[80:83], v41 offset:4096
    ds_read_b128 v[84:87], v41 offset:8192
    ds_read_b128 v[88:91], v41 offset:12288
    ds_read_b64_tr_b16 v[92:93], v48 offset:8192
    ds_read_b64_tr_b16 v[94:95], v48 offset:10240
    ds_read_b64_tr_b16 v[96:97], v49 offset:8192
    ds_read_b64_tr_b16 v[98:99], v49 offset:10240
    s_lshl_b32 s31, s52, 7
    s_add_u32 s31, s31, s53
    s_mul_i32 s32, s52, 524288
    s_add_u32 s32, s32, s54
    s_add_u32 s52, s52, 1
    s_cmp_eq_u32 s52, 8
    s_cselect_b32 s52, 0, s52
    s_add_u32 m0, s45, 65536
    s_nop 0
    buffer_load_dwordx4 v32, s[8:11], s31 offen lds
    s_add_u32 m0, s45, 66560
    s_nop 0
    buffer_load_dwordx4 v33, s[8:11], s31 offen lds
    s_add_u32 m0, s45, 67584
    s_nop 0
    buffer_load_dwordx4 v34, s[8:11], s31 offen lds
    s_add_u32 m0, s45, 68608
    s_nop 0
    buffer_load_dwordx4 v35, s[8:11], s31 offen lds
    s_add_u32 m0, s46, 98304
    s_nop 0
    buffer_load_dwordx4 v36, s[12:15], s32 offen lds
    s_add_u32 m0, s46, 99328
    s_nop 0
    buffer_load_dwordx4 v37, s[12:15], s32 offen lds
    s_add_u32 m0, s46, 100352
    s_nop 0
    buffer_load_dwordx4 v38, s[12:15], s32 offen lds
    s_add_u32 m0, s46, 101376
    s_nop 0
    buffer_load_dwordx4 v39, s[12:15], s32 offen lds
    s_waitcnt lgkmcnt(8)
    v_mfma_f32_32x32x16_bf16 v[116:131], v[68:71], v[52:55], v[116:131]
    v_mfma_f32_32x32x16_bf16 v[132:147], v[72:75], v[52:55], v[132:147]
    v_mfma_f32_32x32x16_bf16 v[148:163], v[68:71], v[56:59], v[148:163]
    v_mfma_f32_32x32x16_bf16 v[164:179], v[72:75], v[56:59], v[164:179]
    v_mfma_f32_32x32x16_bf16 v[180:195], v[68:71], v[60:63], v[180:195]
    v_mfma_f32_32x32x16_bf16 v[196:211], v[72:75], v[60:63], v[196:211]
    v_mfma_f32_32x32x16_bf16 v[212:227], v[68:71], v[64:67], v[212:227]
    v_mfma_f32_32x32x16_bf16 v[228:243], v[72:75], v[64:67], v[228:243]
    ds_read_b128 v[52:55], v42 offset:0
    ds_read_b128 v[56:59], v42 offset:4096
    ds_read_b128 v[60:63], v42 offset:8192
    ds_read_b128 v[64:67], v42 offset:12288
    ds_read_b64_tr_b16 v[68:69], v48 offset:16384
    ds_read_b64_tr_b16 v[70:71], v48 offset:18432
    ds_read_b64_tr_b16 v[72:73], v49 offset:16384
    ds_read_b64_tr_b16 v[74:75], v49 offset:18432
    s_waitcnt lgkmcnt(8)
    v_mfma_f32_32x32x16_bf16 v[116:131], v[92:95], v[76:79], v[116:131]
    v_mfma_f32_32x32x16_bf16 v[132:147], v[96:99], v[76:79], v[132:147]
    v_mfma_f32_32x32x16_bf16 v[148:163], v[92:95], v[80:83], v[148:163]
    v_mfma_f32_32x32x16_bf16 v[164:179], v[96:99], v[80:83], v[164:179]
    v_mfma_f32_32x32x16_bf16 v[180:195], v[92:95], v[84:87], v[180:195]
    v_mfma_f32_32x32x16_bf16 v[196:211], v[96:99], v[84:87], v[196:211]
    v_mfma_f32_32x32x16_bf16 v[212:227], v[92:95], v[88:91], v[212:227]
    v_mfma_f32_32x32x16_bf16 v[228:243], v[96:99], v[88:91], v[228:243]
    ds_read_b128 v[76:79], v43 offset:0
    ds_read_b128 v[80:83], v43 offset:4096
    ds_read_b128 v[84:87], v43 offset:8192
    ds_read_b128 v[88:91], v43 offset:12288
    ds_read_b64_tr_b16 v[92:93], v48 offset:24576
    ds_read_b64_tr_b16 v[94:95], v48 offset:26624
    ds_read_b64_tr_b16 v[96:97], v49 offset:24576
    ds_read_b64_tr_b16 v[98:99], v49 offset:26624
    s_waitcnt lgkmcnt(8)
    v_mfma_f32_32x32x16_bf16 v[116:131], v[68:71], v[52:55], v[116:131]
    v_mfma_f32_32x32x16_bf16 v[132:147], v[72:75], v[52:55], v[132:147]
    v_mfma_f32_32x32x16_bf16 v[148:163], v[68:71], v[56:59], v[148:163]
    v_mfma_f32_32x32x16_bf16 v[164:179], v[72:75], v[56:59], v[164:179]
    v_mfma_f32_32x32x16_bf16 v[180:195], v[68:71], v[60:63], v[180:195]
    v_mfma_f32_32x32x16_bf16 v[196:211], v[72:75], v[60:63], v[196:211]
    v_mfma_f32_32x32x16_bf16 v[212:227], v[68:71], v[64:67], v[212:227]
    v_mfma_f32_32x32x16_bf16 v[228:243], v[72:75], v[64:67], v[228:243]
    s_waitcnt lgkmcnt(0)
    v_mfma_f32_32x32x16_bf16 v[116:131], v[92:95], v[76:79], v[116:131]
    v_mfma_f32_32x32x16_bf16 v[132:147], v[96:99], v[76:79], v[132:147]
    v_mfma_f32_32x32x16_bf16 v[148:163], v[92:95], v[80:83], v[148:163]
    v_mfma_f32_32x32x16_bf16 v[164:179], v[96:99], v[80:83], v[164:179]
    v_mfma_f32_32x32x16_bf16 v[180:195], v[92:95], v[84:87], v[180:195]
    v_mfma_f32_32x32x16_bf16 v[196:211], v[96:99], v[84:87], v[196:211]
    v_mfma_f32_32x32x16_bf16 v[212:227], v[92:95], v[88:91], v[212:227]
    v_mfma_f32_32x32x16_bf16 v[228:243], v[96:99], v[88:91], v[228:243]
    s_waitcnt vmcnt(0)
    s_barrier
    ds_read_b128 v[52:55], v44 offset:0
    ds_read_b128 v[56:59], v44 offset:4096
    ds_read_b128 v[60:63], v44 offset:8192
    ds_read_b128 v[64:67], v44 offset:12288
    ds_read_b64_tr_b16 v[68:69], v50 offset:0
    ds_read_b64_tr_b16 v[70:71], v50 offset:2048
    ds_read_b64_tr_b16 v[72:73], v51 offset:0
    ds_read_b64_tr_b16 v[74:75], v51 offset:2048
    ds_read_b128 v[76:79], v45 offset:0
    ds_read_b128 v[80:83], v45 offset:4096
    ds_read_b128 v[84:87], v45 offset:8192
    ds_read_b128 v[88:91], v45 offset:12288
    ds_read_b64_tr_b16 v[92:93], v50 offset:8192
    ds_read_b64_tr_b16 v[94:95], v50 offset:10240
    ds_read_b64_tr_b16 v[96:97], v51 offset:8192
    ds_read_b64_tr_b16 v[98:99], v51 offset:10240
    s_waitcnt lgkmcnt(8)
    v_mfma_f32_32x32x16_bf16 v[116:131], v[68:71], v[52:55], v[116:131]
    v_mfma_f32_32x32x16_bf16 v[132:147], v[72:75], v[52:55], v[132:147]
    v_mfma_f32_32x32x16_bf16 v[148:163], v[68:71], v[56:59], v[148:163]
    v_mfma_f32_32x32x16_bf16 v[164:179], v[72:75], v[56:59], v[164:179]
    v_mfma_f32_32x32x16_bf16 v[180:195], v[68:71], v[60:63], v[180:195]
    v_mfma_f32_32x32x16_bf16 v[196:211], v[72:75], v[60:63], v[196:211]
    v_mfma_f32_32x32x16_bf16 v[212:227], v[68:71], v[64:67], v[212:227]
    v_mfma_f32_32x32x16_bf16 v[228:243], v[72:75], v[64:67], v[228:243]
    ds_read_b128 v[52:55], v46 offset:0
    ds_read_b128 v[56:59], v46 offset:4096
    ds_read_b128 v[60:63], v46 offset:8192
    ds_read_b128 v[64:67], v46 offset:12288
    ds_read_b64_tr_b16 v[68:69], v50 offset:16384
    ds_read_b64_tr_b16 v[70:71], v50 offset:18432
    ds_read_b64_tr_b16 v[72:73], v51 offset:16384
    ds_read_b64_tr_b16 v[74:75], v51 offset:18432
    s_waitcnt lgkmcnt(8)
    v_mfma_f32_32x32x16_bf16 v[116:131], v[92:95], v[76:79], v[116:131]
    v_mfma_f32_32x32x16_bf16 v[132:147], v[96:99], v[76:79], v[132:147]
    v_mfma_f32_32x32x16_bf16 v[148:163], v[92:95], v[80:83], v[148:163]
    v_mfma_f32_32x32x16_bf16 v[164:179], v[96:99], v[80:83], v[164:179]
    v_mfma_f32_32x32x16_bf16 v[180:195], v[92:95], v[84:87], v[180:195]
    v_mfma_f32_32x32x16_bf16 v[196:211], v[96:99], v[84:87], v[196:211]
    v_mfma_f32_32x32x16_bf16 v[212:227], v[92:95], v[88:91], v[212:227]
    v_mfma_f32_32x32x16_bf16 v[228:243], v[96:99], v[88:91], v[228:243]
    ds_read_b128 v[76:79], v47 offset:0
    ds_read_b128 v[80:83], v47 offset:4096
    ds_read_b128 v[84:87], v47 offset:8192
    ds_read_b128 v[88:91], v47 offset:12288
    ds_read_b64_tr_b16 v[92:93], v50 offset:24576
    ds_read_b64_tr_b16 v[94:95], v50 offset:26624
    ds_read_b64_tr_b16 v[96:97], v51 offset:24576
    ds_read_b64_tr_b16 v[98:99], v51 offset:26624
    s_waitcnt lgkmcnt(8)
    v_mfma_f32_32x32x16_bf16 v[116:131], v[68:71], v[52:55], v[116:131]
    v_mfma_f32_32x32x16_bf16 v[132:147], v[72:75], v[52:55], v[132:147]
    v_mfma_f32_32x32x16_bf16 v[148:163], v[68:71], v[56:59], v[148:163]
    v_mfma_f32_32x32x16_bf16 v[164:179], v[72:75], v[56:59], v[164:179]
    v_mfma_f32_32x32x16_bf16 v[180:195], v[68:71], v[60:63], v[180:195]
    v_mfma_f32_32x32x16_bf16 v[196:211], v[72:75], v[60:63], v[196:211]
    v_mfma_f32_32x32x16_bf16 v[212:227], v[68:71], v[64:67], v[212:227]
    v_mfma_f32_32x32x16_bf16 v[228:243], v[72:75], v[64:67], v[228:243]
    s_waitcnt lgkmcnt(0)
    v_mfma_f32_32x32x16_bf16 v[116:131], v[92:95], v[76:79], v[116:131]
    v_mfma_f32_32x32x16_bf16 v[132:147], v[96:99], v[76:79], v[132:147]
    v_mfma_f32_32x32x16_bf16 v[148:163], v[92:95], v[80:83], v[148:163]
    v_mfma_f32_32x32x16_bf16 v[164:179], v[96:99], v[80:83], v[164:179]
    v_mfma_f32_32x32x16_bf16 v[180:195], v[92:95], v[84:87], v[180:195]
    v_mfma_f32_32x32x16_bf16 v[196:211], v[96:99], v[84:87], v[196:211]
    v_mfma_f32_32x32x16_bf16 v[212:227], v[92:95], v[88:91], v[212:227]
    v_mfma_f32_32x32x16_bf16 v[228:243], v[96:99], v[88:91], v[228:243]
    s_nop 7
    s_nop 7
    s_lshl_b32 s50, s37, 11
    s_add_u32 s50, s50, s33
    s_lshl_b32 s50, s50, 8
    s_barrier
    s_mul_i32 s4, s41, 128
    s_mul_i32 s5, s42, 128
    v_add_u32 v1, s4, v24
    v_lshlrev_b32 v2, 4, v25
    v_add_u32 v2, s5, v2
    v_and_b32 v3, 15, v24
    v_lshlrev_b32 v3, 4, v3
    v_lshlrev_b32 v1, 9, v1

    v_cvt_pk_bf16_f32 v116, v116, v117
    v_cvt_pk_bf16_f32 v117, v118, v119
    v_cvt_pk_bf16_f32 v118, v120, v121
    v_cvt_pk_bf16_f32 v119, v122, v123
    v_cvt_pk_bf16_f32 v120, v124, v125
    v_cvt_pk_bf16_f32 v121, v126, v127
    v_cvt_pk_bf16_f32 v122, v128, v129
    v_cvt_pk_bf16_f32 v123, v130, v131
    v_add_u32 v4, 0, v2
    v_xor_b32 v4, v4, v3
    v_add_u32 v4, v4, v1
    ds_write_b128 v4, v[116:119] offset:0
    v_add_u32 v4, 32, v2
    v_xor_b32 v4, v4, v3
    v_add_u32 v4, v4, v1
    ds_write_b128 v4, v[120:123] offset:0
    v_cvt_pk_bf16_f32 v132, v132, v133
    v_cvt_pk_bf16_f32 v133, v134, v135
    v_cvt_pk_bf16_f32 v134, v136, v137
    v_cvt_pk_bf16_f32 v135, v138, v139
    v_cvt_pk_bf16_f32 v136, v140, v141
    v_cvt_pk_bf16_f32 v137, v142, v143
    v_cvt_pk_bf16_f32 v138, v144, v145
    v_cvt_pk_bf16_f32 v139, v146, v147
    v_add_u32 v4, 64, v2
    v_xor_b32 v4, v4, v3
    v_add_u32 v4, v4, v1
    ds_write_b128 v4, v[132:135] offset:0
    v_add_u32 v4, 96, v2
    v_xor_b32 v4, v4, v3
    v_add_u32 v4, v4, v1
    ds_write_b128 v4, v[136:139] offset:0
    v_cvt_pk_bf16_f32 v148, v148, v149
    v_cvt_pk_bf16_f32 v149, v150, v151
    v_cvt_pk_bf16_f32 v150, v152, v153
    v_cvt_pk_bf16_f32 v151, v154, v155
    v_cvt_pk_bf16_f32 v152, v156, v157
    v_cvt_pk_bf16_f32 v153, v158, v159
    v_cvt_pk_bf16_f32 v154, v160, v161
    v_cvt_pk_bf16_f32 v155, v162, v163
    v_add_u32 v4, 0, v2
    v_xor_b32 v4, v4, v3
    v_add_u32 v4, v4, v1
    ds_write_b128 v4, v[148:151] offset:16384
    v_add_u32 v4, 32, v2
    v_xor_b32 v4, v4, v3
    v_add_u32 v4, v4, v1
    ds_write_b128 v4, v[152:155] offset:16384
    v_cvt_pk_bf16_f32 v164, v164, v165
    v_cvt_pk_bf16_f32 v165, v166, v167
    v_cvt_pk_bf16_f32 v166, v168, v169
    v_cvt_pk_bf16_f32 v167, v170, v171
    v_cvt_pk_bf16_f32 v168, v172, v173
    v_cvt_pk_bf16_f32 v169, v174, v175
    v_cvt_pk_bf16_f32 v170, v176, v177
    v_cvt_pk_bf16_f32 v171, v178, v179
    v_add_u32 v4, 64, v2
    v_xor_b32 v4, v4, v3
    v_add_u32 v4, v4, v1
    ds_write_b128 v4, v[164:167] offset:16384
    v_add_u32 v4, 96, v2
    v_xor_b32 v4, v4, v3
    v_add_u32 v4, v4, v1
    ds_write_b128 v4, v[168:171] offset:16384
    v_cvt_pk_bf16_f32 v180, v180, v181
    v_cvt_pk_bf16_f32 v181, v182, v183
    v_cvt_pk_bf16_f32 v182, v184, v185
    v_cvt_pk_bf16_f32 v183, v186, v187
    v_cvt_pk_bf16_f32 v184, v188, v189
    v_cvt_pk_bf16_f32 v185, v190, v191
    v_cvt_pk_bf16_f32 v186, v192, v193
    v_cvt_pk_bf16_f32 v187, v194, v195
    v_add_u32 v4, 0, v2
    v_xor_b32 v4, v4, v3
    v_add_u32 v4, v4, v1
    ds_write_b128 v4, v[180:183] offset:32768
    v_add_u32 v4, 32, v2
    v_xor_b32 v4, v4, v3
    v_add_u32 v4, v4, v1
    ds_write_b128 v4, v[184:187] offset:32768
    v_cvt_pk_bf16_f32 v196, v196, v197
    v_cvt_pk_bf16_f32 v197, v198, v199
    v_cvt_pk_bf16_f32 v198, v200, v201
    v_cvt_pk_bf16_f32 v199, v202, v203
    v_cvt_pk_bf16_f32 v200, v204, v205
    v_cvt_pk_bf16_f32 v201, v206, v207
    v_cvt_pk_bf16_f32 v202, v208, v209
    v_cvt_pk_bf16_f32 v203, v210, v211
    v_add_u32 v4, 64, v2
    v_xor_b32 v4, v4, v3
    v_add_u32 v4, v4, v1
    ds_write_b128 v4, v[196:199] offset:32768
    v_add_u32 v4, 96, v2
    v_xor_b32 v4, v4, v3
    v_add_u32 v4, v4, v1
    ds_write_b128 v4, v[200:203] offset:32768
    v_cvt_pk_bf16_f32 v212, v212, v213
    v_cvt_pk_bf16_f32 v213, v214, v215
    v_cvt_pk_bf16_f32 v214, v216, v217
    v_cvt_pk_bf16_f32 v215, v218, v219
    v_cvt_pk_bf16_f32 v216, v220, v221
    v_cvt_pk_bf16_f32 v217, v222, v223
    v_cvt_pk_bf16_f32 v218, v224, v225
    v_cvt_pk_bf16_f32 v219, v226, v227
    v_add_u32 v4, 0, v2
    v_xor_b32 v4, v4, v3
    v_add_u32 v4, v4, v1
    ds_write_b128 v4, v[212:215] offset:49152
    v_add_u32 v4, 32, v2
    v_xor_b32 v4, v4, v3
    v_add_u32 v4, v4, v1
    ds_write_b128 v4, v[216:219] offset:49152
    v_cvt_pk_bf16_f32 v228, v228, v229
    v_cvt_pk_bf16_f32 v229, v230, v231
    v_cvt_pk_bf16_f32 v230, v232, v233
    v_cvt_pk_bf16_f32 v231, v234, v235
    v_cvt_pk_bf16_f32 v232, v236, v237
    v_cvt_pk_bf16_f32 v233, v238, v239
    v_cvt_pk_bf16_f32 v234, v240, v241
    v_cvt_pk_bf16_f32 v235, v242, v243
    v_add_u32 v4, 64, v2
    v_xor_b32 v4, v4, v3
    v_add_u32 v4, v4, v1
    ds_write_b128 v4, v[228:231] offset:49152
    v_add_u32 v4, 96, v2
    v_xor_b32 v4, v4, v3
    v_add_u32 v4, v4, v1
    ds_write_b128 v4, v[232:235] offset:49152
    s_waitcnt lgkmcnt(0)
    s_barrier
    v_lshrrev_b32 v1, 5, v0
    v_and_b32 v2, 31, v0
    v_lshlrev_b32 v2, 4, v2
    v_lshrrev_b32 v5, 8, v2
    v_and_b32 v6, 255, v2
    s_mov_b32 s4, 524288
    v_mul_lo_u32 v5, v5, s4
    v_add_u32 v5, v5, v6
    s_mov_b32 s4, 256
    v_mul_lo_u32 v6, v1, s4
    v_add_u32 v5, v5, v6
    v_add_u32 v5, s50, v5
    v_lshlrev_b32 v7, 9, v1

    v_add_u32 v3, 0, v1
    v_and_b32 v3, 15, v3
    v_lshlrev_b32 v3, 4, v3
    v_xor_b32 v3, v3, v2
    v_add_u32 v3, v3, v7
    ds_read_b128 v[116:119], v3 offset:0
    v_add_u32 v3, 16, v1
    v_and_b32 v3, 15, v3
    v_lshlrev_b32 v3, 4, v3
    v_xor_b32 v3, v3, v2
    v_add_u32 v3, v3, v7
    ds_read_b128 v[120:123], v3 offset:8192
    v_add_u32 v3, 32, v1
    v_and_b32 v3, 15, v3
    v_lshlrev_b32 v3, 4, v3
    v_xor_b32 v3, v3, v2
    v_add_u32 v3, v3, v7
    ds_read_b128 v[124:127], v3 offset:16384
    v_add_u32 v3, 48, v1
    v_and_b32 v3, 15, v3
    v_lshlrev_b32 v3, 4, v3
    v_xor_b32 v3, v3, v2
    v_add_u32 v3, v3, v7
    ds_read_b128 v[128:131], v3 offset:24576
    v_add_u32 v3, 64, v1
    v_and_b32 v3, 15, v3
    v_lshlrev_b32 v3, 4, v3
    v_xor_b32 v3, v3, v2
    v_add_u32 v3, v3, v7
    ds_read_b128 v[132:135], v3 offset:32768
    v_add_u32 v3, 80, v1
    v_and_b32 v3, 15, v3
    v_lshlrev_b32 v3, 4, v3
    v_xor_b32 v3, v3, v2
    v_add_u32 v3, v3, v7
    ds_read_b128 v[136:139], v3 offset:40960
    v_add_u32 v3, 96, v1
    v_and_b32 v3, 15, v3
    v_lshlrev_b32 v3, 4, v3
    v_xor_b32 v3, v3, v2
    v_add_u32 v3, v3, v7
    ds_read_b128 v[140:143], v3 offset:49152
    v_add_u32 v3, 112, v1
    v_and_b32 v3, 15, v3
    v_lshlrev_b32 v3, 4, v3
    v_xor_b32 v3, v3, v2
    v_add_u32 v3, v3, v7
    ds_read_b128 v[144:147], v3 offset:57344
    v_add_u32 v3, 128, v1
    v_and_b32 v3, 15, v3
    v_lshlrev_b32 v3, 4, v3
    v_xor_b32 v3, v3, v2
    v_add_u32 v3, v3, v7
    v_add_u32 v3, 65536, v3
    ds_read_b128 v[148:151], v3 offset:0
    v_add_u32 v3, 144, v1
    v_and_b32 v3, 15, v3
    v_lshlrev_b32 v3, 4, v3
    v_xor_b32 v3, v3, v2
    v_add_u32 v3, v3, v7
    v_add_u32 v3, 73728, v3
    ds_read_b128 v[152:155], v3 offset:0
    v_add_u32 v3, 160, v1
    v_and_b32 v3, 15, v3
    v_lshlrev_b32 v3, 4, v3
    v_xor_b32 v3, v3, v2
    v_add_u32 v3, v3, v7
    v_add_u32 v3, 81920, v3
    ds_read_b128 v[156:159], v3 offset:0
    v_add_u32 v3, 176, v1
    v_and_b32 v3, 15, v3
    v_lshlrev_b32 v3, 4, v3
    v_xor_b32 v3, v3, v2
    v_add_u32 v3, v3, v7
    v_add_u32 v3, 90112, v3
    ds_read_b128 v[160:163], v3 offset:0
    v_add_u32 v3, 192, v1
    v_and_b32 v3, 15, v3
    v_lshlrev_b32 v3, 4, v3
    v_xor_b32 v3, v3, v2
    v_add_u32 v3, v3, v7
    v_add_u32 v3, 98304, v3
    ds_read_b128 v[164:167], v3 offset:0
    v_add_u32 v3, 208, v1
    v_and_b32 v3, 15, v3
    v_lshlrev_b32 v3, 4, v3
    v_xor_b32 v3, v3, v2
    v_add_u32 v3, v3, v7
    v_add_u32 v3, 106496, v3
    ds_read_b128 v[168:171], v3 offset:0
    v_add_u32 v3, 224, v1
    v_and_b32 v3, 15, v3
    v_lshlrev_b32 v3, 4, v3
    v_xor_b32 v3, v3, v2
    v_add_u32 v3, v3, v7
    v_add_u32 v3, 114688, v3
    ds_read_b128 v[172:175], v3 offset:0
    v_add_u32 v3, 240, v1
    v_and_b32 v3, 15, v3
    v_lshlrev_b32 v3, 4, v3
    v_xor_b32 v3, v3, v2
    v_add_u32 v3, v3, v7
    v_add_u32 v3, 122880, v3
    ds_read_b128 v[176:179], v3 offset:0
    s_waitcnt lgkmcnt(15)
    s_mov_b32 s4, 0
    buffer_store_dwordx4 v[116:119], v5, s[16:19], s4 offen
    s_waitcnt lgkmcnt(14)
    s_mov_b32 s4, 4096
    buffer_store_dwordx4 v[120:123], v5, s[16:19], s4 offen
    s_waitcnt lgkmcnt(13)
    s_mov_b32 s4, 8192
    buffer_store_dwordx4 v[124:127], v5, s[16:19], s4 offen
    s_waitcnt lgkmcnt(12)
    s_mov_b32 s4, 12288
    buffer_store_dwordx4 v[128:131], v5, s[16:19], s4 offen
    s_waitcnt lgkmcnt(11)
    s_mov_b32 s4, 16384
    buffer_store_dwordx4 v[132:135], v5, s[16:19], s4 offen
    s_waitcnt lgkmcnt(10)
    s_mov_b32 s4, 20480
    buffer_store_dwordx4 v[136:139], v5, s[16:19], s4 offen
    s_waitcnt lgkmcnt(9)
    s_mov_b32 s4, 24576
    buffer_store_dwordx4 v[140:143], v5, s[16:19], s4 offen
    s_waitcnt lgkmcnt(8)
    s_mov_b32 s4, 28672
    buffer_store_dwordx4 v[144:147], v5, s[16:19], s4 offen
    s_waitcnt lgkmcnt(7)
    s_mov_b32 s4, 32768
    buffer_store_dwordx4 v[148:151], v5, s[16:19], s4 offen
    s_waitcnt lgkmcnt(6)
    s_mov_b32 s4, 36864
    buffer_store_dwordx4 v[152:155], v5, s[16:19], s4 offen
    s_waitcnt lgkmcnt(5)
    s_mov_b32 s4, 40960
    buffer_store_dwordx4 v[156:159], v5, s[16:19], s4 offen
    s_waitcnt lgkmcnt(4)
    s_mov_b32 s4, 45056
    buffer_store_dwordx4 v[160:163], v5, s[16:19], s4 offen
    s_waitcnt lgkmcnt(3)
    s_mov_b32 s4, 49152
    buffer_store_dwordx4 v[164:167], v5, s[16:19], s4 offen
    s_waitcnt lgkmcnt(2)
    s_mov_b32 s4, 53248
    buffer_store_dwordx4 v[168:171], v5, s[16:19], s4 offen
    s_waitcnt lgkmcnt(1)
    s_mov_b32 s4, 57344
    buffer_store_dwordx4 v[172:175], v5, s[16:19], s4 offen
    s_waitcnt lgkmcnt(0)
    s_mov_b32 s4, 61440
    buffer_store_dwordx4 v[176:179], v5, s[16:19], s4 offen
    s_branch qkv_done
qkv_v:
    v_and_b32 v26, 63, v0
    v_and_b32 v24, 31, v0
    v_bfe_u32 v25, v0, 5, 1
    v_lshrrev_b32 v1, 6, v0
    s_nop 0
    v_readfirstlane_b32 s40, v1
    s_nop 3
    s_lshr_b32 s41, s40, 2
    s_and_b32 s42, s40, 3

    s_load_dwordx2 s[8:9], s[0:1], 8
    s_mov_b32 s10, 2097152
    s_mov_b32 s11, 0x00020000
    s_load_dwordx2 s[12:13], s[0:1], 32
    s_mov_b32 s14, 4194304
    s_mov_b32 s15, 0x00020000
    s_load_dwordx2 s[16:17], s[0:1], 104
    s_mov_b32 s18, 16777216
    s_mov_b32 s19, 0x00020000
    s_waitcnt lgkmcnt(0)
    s_add_u32 s16, s16, 50331648
    s_addc_u32 s17, s17, 0
    v_lshrrev_b32 v1, 3, v26
    v_lshrrev_b32 v2, 4, v26
    v_and_b32 v3, 7, v26
    s_mul_i32 s4, s40, 4
    s_mov_b32 s5, 1024

    s_add_u32 s6, s4, 0
    s_lshl_b32 s7, s6, 2
    v_add_u32 v4, s7, v2
    v_and_b32 v4, 7, v4
    v_xor_b32 v4, v4, v3
    s_lshl_b32 s7, s6, 3
    s_add_u32 s7, s7, s33
    v_add_u32 v5, s7, v1
    v_mul_lo_u32 v5, v5, s5
    v_lshl_add_u32 v32, v4, 4, v5

    s_add_u32 s6, s4, 1
    s_lshl_b32 s7, s6, 2
    v_add_u32 v4, s7, v2
    v_and_b32 v4, 7, v4
    v_xor_b32 v4, v4, v3
    s_lshl_b32 s7, s6, 3
    s_add_u32 s7, s7, s33
    v_add_u32 v5, s7, v1
    v_mul_lo_u32 v5, v5, s5
    v_lshl_add_u32 v33, v4, 4, v5

    s_add_u32 s6, s4, 2
    s_lshl_b32 s7, s6, 2
    v_add_u32 v4, s7, v2
    v_and_b32 v4, 7, v4
    v_xor_b32 v4, v4, v3
    s_lshl_b32 s7, s6, 3
    s_add_u32 s7, s7, s33
    v_add_u32 v5, s7, v1
    v_mul_lo_u32 v5, v5, s5
    v_lshl_add_u32 v34, v4, 4, v5

    s_add_u32 s6, s4, 3
    s_lshl_b32 s7, s6, 2
    v_add_u32 v4, s7, v2
    v_and_b32 v4, 7, v4
    v_xor_b32 v4, v4, v3
    s_lshl_b32 s7, s6, 3
    s_add_u32 s7, s7, s33
    v_add_u32 v5, s7, v1
    v_mul_lo_u32 v5, v5, s5
    v_lshl_add_u32 v35, v4, 4, v5

    s_mul_i32 s4, s40, 4
    s_mov_b32 s5, 8192
    s_lshl_b32 s44, s34, 1
    v_lshlrev_b32 v1, 4, v26

    s_add_u32 s6, s4, 0
    s_lshl_b32 s6, s6, 10
    v_add_u32 v2, s6, v1
    v_lshrrev_b32 v3, 9, v2
    v_and_b32 v4, 511, v2

    v_and_b32 v5, 3, v3
    v_lshlrev_b32 v5, 6, v5
    v_xor_b32 v4, v4, v5
    v_mul_lo_u32 v3, v3, s5
    v_add_u32 v3, v3, v4
    v_add_u32 v36, s44, v3
    s_add_u32 s6, s4, 1
    s_lshl_b32 s6, s6, 10
    v_add_u32 v2, s6, v1
    v_lshrrev_b32 v3, 9, v2
    v_and_b32 v4, 511, v2

    v_and_b32 v5, 3, v3
    v_lshlrev_b32 v5, 6, v5
    v_xor_b32 v4, v4, v5
    v_mul_lo_u32 v3, v3, s5
    v_add_u32 v3, v3, v4
    v_add_u32 v37, s44, v3
    s_add_u32 s6, s4, 2
    s_lshl_b32 s6, s6, 10
    v_add_u32 v2, s6, v1
    v_lshrrev_b32 v3, 9, v2
    v_and_b32 v4, 511, v2

    v_and_b32 v5, 3, v3
    v_lshlrev_b32 v5, 6, v5
    v_xor_b32 v4, v4, v5
    v_mul_lo_u32 v3, v3, s5
    v_add_u32 v3, v3, v4
    v_add_u32 v38, s44, v3
    s_add_u32 s6, s4, 3
    s_lshl_b32 s6, s6, 10
    v_add_u32 v2, s6, v1
    v_lshrrev_b32 v3, 9, v2
    v_and_b32 v4, 511, v2

    v_and_b32 v5, 3, v3
    v_lshlrev_b32 v5, 6, v5
    v_xor_b32 v4, v4, v5
    v_mul_lo_u32 v3, v3, s5
    v_add_u32 v3, v3, v4
    v_add_u32 v39, s44, v3
    s_mul_i32 s4, s41, 128
    v_add_u32 v1, s4, v24
    v_bfe_u32 v2, v1, 1, 3
    v_lshlrev_b32 v1, 7, v1

    v_add_u32 v3, 0, v25
    v_xor_b32 v3, v3, v2
    v_lshl_add_u32 v40, v3, 4, v1
    v_add_u32 v3, 2, v25
    v_xor_b32 v3, v3, v2
    v_lshl_add_u32 v41, v3, 4, v1
    v_add_u32 v3, 4, v25
    v_xor_b32 v3, v3, v2
    v_lshl_add_u32 v42, v3, 4, v1
    v_add_u32 v3, 6, v25
    v_xor_b32 v3, v3, v2
    v_lshl_add_u32 v43, v3, 4, v1
    v_bfe_u32 v1, v26, 2, 2
    v_lshrrev_b32 v2, 5, v26
    v_lshlrev_b32 v2, 12, v2
    v_lshl_add_u32 v2, v1, 9, v2
    v_bfe_u32 v3, v26, 4, 1
    v_lshl_add_u32 v2, v3, 5, v2
    v_and_b32 v3, 3, v26
    v_lshl_add_u32 v2, v3, 3, v2
    v_add_u32 v2, 32768, v2
    s_mul_i32 s4, s42, 2

    s_add_u32 s5, s4, 0
    v_xor_b32 v3, s5, v1
    v_lshl_add_u32 v48, v3, 6, v2
    s_add_u32 s5, s4, 1
    v_xor_b32 v3, s5, v1
    v_lshl_add_u32 v49, v3, 6, v2
    v_add_u32 v44, 65536, v40
    v_add_u32 v45, 65536, v41
    v_add_u32 v46, 65536, v42
    v_add_u32 v47, 65536, v43
    v_add_u32 v50, 65536, v48
    v_add_u32 v51, 65536, v49
    v_mov_b32 v116, 0
    v_mov_b32 v117, 0
    v_mov_b32 v118, 0
    v_mov_b32 v119, 0
    v_mov_b32 v120, 0
    v_mov_b32 v121, 0
    v_mov_b32 v122, 0
    v_mov_b32 v123, 0
    v_mov_b32 v124, 0
    v_mov_b32 v125, 0
    v_mov_b32 v126, 0
    v_mov_b32 v127, 0
    v_mov_b32 v128, 0
    v_mov_b32 v129, 0
    v_mov_b32 v130, 0
    v_mov_b32 v131, 0
    v_mov_b32 v132, 0
    v_mov_b32 v133, 0
    v_mov_b32 v134, 0
    v_mov_b32 v135, 0
    v_mov_b32 v136, 0
    v_mov_b32 v137, 0
    v_mov_b32 v138, 0
    v_mov_b32 v139, 0
    v_mov_b32 v140, 0
    v_mov_b32 v141, 0
    v_mov_b32 v142, 0
    v_mov_b32 v143, 0
    v_mov_b32 v144, 0
    v_mov_b32 v145, 0
    v_mov_b32 v146, 0
    v_mov_b32 v147, 0
    v_mov_b32 v148, 0
    v_mov_b32 v149, 0
    v_mov_b32 v150, 0
    v_mov_b32 v151, 0
    v_mov_b32 v152, 0
    v_mov_b32 v153, 0
    v_mov_b32 v154, 0
    v_mov_b32 v155, 0
    v_mov_b32 v156, 0
    v_mov_b32 v157, 0
    v_mov_b32 v158, 0
    v_mov_b32 v159, 0
    v_mov_b32 v160, 0
    v_mov_b32 v161, 0
    v_mov_b32 v162, 0
    v_mov_b32 v163, 0
    v_mov_b32 v164, 0
    v_mov_b32 v165, 0
    v_mov_b32 v166, 0
    v_mov_b32 v167, 0
    v_mov_b32 v168, 0
    v_mov_b32 v169, 0
    v_mov_b32 v170, 0
    v_mov_b32 v171, 0
    v_mov_b32 v172, 0
    v_mov_b32 v173, 0
    v_mov_b32 v174, 0
    v_mov_b32 v175, 0
    v_mov_b32 v176, 0
    v_mov_b32 v177, 0
    v_mov_b32 v178, 0
    v_mov_b32 v179, 0
    v_mov_b32 v180, 0
    v_mov_b32 v181, 0
    v_mov_b32 v182, 0
    v_mov_b32 v183, 0
    v_mov_b32 v184, 0
    v_mov_b32 v185, 0
    v_mov_b32 v186, 0
    v_mov_b32 v187, 0
    v_mov_b32 v188, 0
    v_mov_b32 v189, 0
    v_mov_b32 v190, 0
    v_mov_b32 v191, 0
    v_mov_b32 v192, 0
    v_mov_b32 v193, 0
    v_mov_b32 v194, 0
    v_mov_b32 v195, 0
    v_mov_b32 v196, 0
    v_mov_b32 v197, 0
    v_mov_b32 v198, 0
    v_mov_b32 v199, 0
    v_mov_b32 v200, 0
    v_mov_b32 v201, 0
    v_mov_b32 v202, 0
    v_mov_b32 v203, 0
    v_mov_b32 v204, 0
    v_mov_b32 v205, 0
    v_mov_b32 v206, 0
    v_mov_b32 v207, 0
    v_mov_b32 v208, 0
    v_mov_b32 v209, 0
    v_mov_b32 v210, 0
    v_mov_b32 v211, 0
    v_mov_b32 v212, 0
    v_mov_b32 v213, 0
    v_mov_b32 v214, 0
    v_mov_b32 v215, 0
    v_mov_b32 v216, 0
    v_mov_b32 v217, 0
    v_mov_b32 v218, 0
    v_mov_b32 v219, 0
    v_mov_b32 v220, 0
    v_mov_b32 v221, 0
    v_mov_b32 v222, 0
    v_mov_b32 v223, 0
    v_mov_b32 v224, 0
    v_mov_b32 v225, 0
    v_mov_b32 v226, 0
    v_mov_b32 v227, 0
    v_mov_b32 v228, 0
    v_mov_b32 v229, 0
    v_mov_b32 v230, 0
    v_mov_b32 v231, 0
    v_mov_b32 v232, 0
    v_mov_b32 v233, 0
    v_mov_b32 v234, 0
    v_mov_b32 v235, 0
    v_mov_b32 v236, 0
    v_mov_b32 v237, 0
    v_mov_b32 v238, 0
    v_mov_b32 v239, 0
    v_mov_b32 v240, 0
    v_mov_b32 v241, 0
    v_mov_b32 v242, 0
    v_mov_b32 v243, 0
    s_lshl_b32 s45, s40, 10
    s_mul_i32 s46, s45, 4
    s_mul_i32 s45, s45, 4
    s_mov_b32 s53, s31
    s_mov_b32 s54, s32
    s_lshr_b32 s52, s2, 3
    s_and_b32 s52, s52, 31

    s_sub_u32 s4, s52, 8
    s_cmp_ge_u32 s52, 8
    s_cselect_b32 s52, s4, s52
    s_sub_u32 s4, s52, 8
    s_cmp_ge_u32 s52, 8
    s_cselect_b32 s52, s4, s52
    s_sub_u32 s4, s52, 8
    s_cmp_ge_u32 s52, 8
    s_cselect_b32 s52, s4, s52
    s_sub_u32 s4, s52, 8
    s_cmp_ge_u32 s52, 8
    s_cselect_b32 s52, s4, s52
    s_lshl_b32 s31, s52, 7
    s_add_u32 s31, s31, s53
    s_mul_i32 s32, s52, 524288
    s_add_u32 s32, s32, s54
    s_add_u32 s52, s52, 1
    s_cmp_eq_u32 s52, 8
    s_cselect_b32 s52, 0, s52
    s_add_u32 m0, s45, 0
    s_nop 0
    buffer_load_dwordx4 v32, s[8:11], s31 offen lds
    s_add_u32 m0, s45, 1024
    s_nop 0
    buffer_load_dwordx4 v33, s[8:11], s31 offen lds
    s_add_u32 m0, s45, 2048
    s_nop 0
    buffer_load_dwordx4 v34, s[8:11], s31 offen lds
    s_add_u32 m0, s45, 3072
    s_nop 0
    buffer_load_dwordx4 v35, s[8:11], s31 offen lds
    s_add_u32 m0, s46, 32768
    s_nop 0
    buffer_load_dwordx4 v36, s[12:15], s32 offen lds
    s_add_u32 m0, s46, 33792
    s_nop 0
    buffer_load_dwordx4 v37, s[12:15], s32 offen lds
    s_add_u32 m0, s46, 34816
    s_nop 0
    buffer_load_dwordx4 v38, s[12:15], s32 offen lds
    s_add_u32 m0, s46, 35840
    s_nop 0
    buffer_load_dwordx4 v39, s[12:15], s32 offen lds
    s_mov_b32 s30, 3
gloop_3:
    s_waitcnt vmcnt(0)
    s_barrier
    ds_read_b128 v[52:55], v40 offset:0
    ds_read_b128 v[56:59], v40 offset:4096
    ds_read_b128 v[60:63], v40 offset:8192
    ds_read_b128 v[64:67], v40 offset:12288
    ds_read_b64_tr_b16 v[68:69], v48 offset:0
    ds_read_b64_tr_b16 v[70:71], v48 offset:2048
    ds_read_b64_tr_b16 v[72:73], v49 offset:0
    ds_read_b64_tr_b16 v[74:75], v49 offset:2048
    ds_read_b128 v[76:79], v41 offset:0
    ds_read_b128 v[80:83], v41 offset:4096
    ds_read_b128 v[84:87], v41 offset:8192
    ds_read_b128 v[88:91], v41 offset:12288
    ds_read_b64_tr_b16 v[92:93], v48 offset:8192
    ds_read_b64_tr_b16 v[94:95], v48 offset:10240
    ds_read_b64_tr_b16 v[96:97], v49 offset:8192
    ds_read_b64_tr_b16 v[98:99], v49 offset:10240
    s_lshl_b32 s31, s52, 7
    s_add_u32 s31, s31, s53
    s_mul_i32 s32, s52, 524288
    s_add_u32 s32, s32, s54
    s_add_u32 s52, s52, 1
    s_cmp_eq_u32 s52, 8
    s_cselect_b32 s52, 0, s52
    s_add_u32 m0, s45, 65536
    s_nop 0
    buffer_load_dwordx4 v32, s[8:11], s31 offen lds
    s_add_u32 m0, s45, 66560
    s_nop 0
    buffer_load_dwordx4 v33, s[8:11], s31 offen lds
    s_add_u32 m0, s45, 67584
    s_nop 0
    buffer_load_dwordx4 v34, s[8:11], s31 offen lds
    s_add_u32 m0, s45, 68608
    s_nop 0
    buffer_load_dwordx4 v35, s[8:11], s31 offen lds
    s_add_u32 m0, s46, 98304
    s_nop 0
    buffer_load_dwordx4 v36, s[12:15], s32 offen lds
    s_add_u32 m0, s46, 99328
    s_nop 0
    buffer_load_dwordx4 v37, s[12:15], s32 offen lds
    s_add_u32 m0, s46, 100352
    s_nop 0
    buffer_load_dwordx4 v38, s[12:15], s32 offen lds
    s_add_u32 m0, s46, 101376
    s_nop 0
    buffer_load_dwordx4 v39, s[12:15], s32 offen lds
    s_waitcnt lgkmcnt(8)
    v_mfma_f32_32x32x16_bf16 v[116:131], v[52:55], v[68:71], v[116:131]
    v_mfma_f32_32x32x16_bf16 v[132:147], v[52:55], v[72:75], v[132:147]
    v_mfma_f32_32x32x16_bf16 v[148:163], v[56:59], v[68:71], v[148:163]
    v_mfma_f32_32x32x16_bf16 v[164:179], v[56:59], v[72:75], v[164:179]
    v_mfma_f32_32x32x16_bf16 v[180:195], v[60:63], v[68:71], v[180:195]
    v_mfma_f32_32x32x16_bf16 v[196:211], v[60:63], v[72:75], v[196:211]
    v_mfma_f32_32x32x16_bf16 v[212:227], v[64:67], v[68:71], v[212:227]
    v_mfma_f32_32x32x16_bf16 v[228:243], v[64:67], v[72:75], v[228:243]
    ds_read_b128 v[52:55], v42 offset:0
    ds_read_b128 v[56:59], v42 offset:4096
    ds_read_b128 v[60:63], v42 offset:8192
    ds_read_b128 v[64:67], v42 offset:12288
    ds_read_b64_tr_b16 v[68:69], v48 offset:16384
    ds_read_b64_tr_b16 v[70:71], v48 offset:18432
    ds_read_b64_tr_b16 v[72:73], v49 offset:16384
    ds_read_b64_tr_b16 v[74:75], v49 offset:18432
    s_waitcnt lgkmcnt(8)
    v_mfma_f32_32x32x16_bf16 v[116:131], v[76:79], v[92:95], v[116:131]
    v_mfma_f32_32x32x16_bf16 v[132:147], v[76:79], v[96:99], v[132:147]
    v_mfma_f32_32x32x16_bf16 v[148:163], v[80:83], v[92:95], v[148:163]
    v_mfma_f32_32x32x16_bf16 v[164:179], v[80:83], v[96:99], v[164:179]
    v_mfma_f32_32x32x16_bf16 v[180:195], v[84:87], v[92:95], v[180:195]
    v_mfma_f32_32x32x16_bf16 v[196:211], v[84:87], v[96:99], v[196:211]
    v_mfma_f32_32x32x16_bf16 v[212:227], v[88:91], v[92:95], v[212:227]
    v_mfma_f32_32x32x16_bf16 v[228:243], v[88:91], v[96:99], v[228:243]
    ds_read_b128 v[76:79], v43 offset:0
    ds_read_b128 v[80:83], v43 offset:4096
    ds_read_b128 v[84:87], v43 offset:8192
    ds_read_b128 v[88:91], v43 offset:12288
    ds_read_b64_tr_b16 v[92:93], v48 offset:24576
    ds_read_b64_tr_b16 v[94:95], v48 offset:26624
    ds_read_b64_tr_b16 v[96:97], v49 offset:24576
    ds_read_b64_tr_b16 v[98:99], v49 offset:26624
    s_waitcnt lgkmcnt(8)
    v_mfma_f32_32x32x16_bf16 v[116:131], v[52:55], v[68:71], v[116:131]
    v_mfma_f32_32x32x16_bf16 v[132:147], v[52:55], v[72:75], v[132:147]
    v_mfma_f32_32x32x16_bf16 v[148:163], v[56:59], v[68:71], v[148:163]
    v_mfma_f32_32x32x16_bf16 v[164:179], v[56:59], v[72:75], v[164:179]
    v_mfma_f32_32x32x16_bf16 v[180:195], v[60:63], v[68:71], v[180:195]
    v_mfma_f32_32x32x16_bf16 v[196:211], v[60:63], v[72:75], v[196:211]
    v_mfma_f32_32x32x16_bf16 v[212:227], v[64:67], v[68:71], v[212:227]
    v_mfma_f32_32x32x16_bf16 v[228:243], v[64:67], v[72:75], v[228:243]
    s_waitcnt lgkmcnt(0)
    v_mfma_f32_32x32x16_bf16 v[116:131], v[76:79], v[92:95], v[116:131]
    v_mfma_f32_32x32x16_bf16 v[132:147], v[76:79], v[96:99], v[132:147]
    v_mfma_f32_32x32x16_bf16 v[148:163], v[80:83], v[92:95], v[148:163]
    v_mfma_f32_32x32x16_bf16 v[164:179], v[80:83], v[96:99], v[164:179]
    v_mfma_f32_32x32x16_bf16 v[180:195], v[84:87], v[92:95], v[180:195]
    v_mfma_f32_32x32x16_bf16 v[196:211], v[84:87], v[96:99], v[196:211]
    v_mfma_f32_32x32x16_bf16 v[212:227], v[88:91], v[92:95], v[212:227]
    v_mfma_f32_32x32x16_bf16 v[228:243], v[88:91], v[96:99], v[228:243]
    s_waitcnt vmcnt(0)
    s_barrier
    ds_read_b128 v[52:55], v44 offset:0
    ds_read_b128 v[56:59], v44 offset:4096
    ds_read_b128 v[60:63], v44 offset:8192
    ds_read_b128 v[64:67], v44 offset:12288
    ds_read_b64_tr_b16 v[68:69], v50 offset:0
    ds_read_b64_tr_b16 v[70:71], v50 offset:2048
    ds_read_b64_tr_b16 v[72:73], v51 offset:0
    ds_read_b64_tr_b16 v[74:75], v51 offset:2048
    ds_read_b128 v[76:79], v45 offset:0
    ds_read_b128 v[80:83], v45 offset:4096
    ds_read_b128 v[84:87], v45 offset:8192
    ds_read_b128 v[88:91], v45 offset:12288
    ds_read_b64_tr_b16 v[92:93], v50 offset:8192
    ds_read_b64_tr_b16 v[94:95], v50 offset:10240
    ds_read_b64_tr_b16 v[96:97], v51 offset:8192
    ds_read_b64_tr_b16 v[98:99], v51 offset:10240
    s_lshl_b32 s31, s52, 7
    s_add_u32 s31, s31, s53
    s_mul_i32 s32, s52, 524288
    s_add_u32 s32, s32, s54
    s_add_u32 s52, s52, 1
    s_cmp_eq_u32 s52, 8
    s_cselect_b32 s52, 0, s52
    s_add_u32 m0, s45, 0
    s_nop 0
    buffer_load_dwordx4 v32, s[8:11], s31 offen lds
    s_add_u32 m0, s45, 1024
    s_nop 0
    buffer_load_dwordx4 v33, s[8:11], s31 offen lds
    s_add_u32 m0, s45, 2048
    s_nop 0
    buffer_load_dwordx4 v34, s[8:11], s31 offen lds
    s_add_u32 m0, s45, 3072
    s_nop 0
    buffer_load_dwordx4 v35, s[8:11], s31 offen lds
    s_add_u32 m0, s46, 32768
    s_nop 0
    buffer_load_dwordx4 v36, s[12:15], s32 offen lds
    s_add_u32 m0, s46, 33792
    s_nop 0
    buffer_load_dwordx4 v37, s[12:15], s32 offen lds
    s_add_u32 m0, s46, 34816
    s_nop 0
    buffer_load_dwordx4 v38, s[12:15], s32 offen lds
    s_add_u32 m0, s46, 35840
    s_nop 0
    buffer_load_dwordx4 v39, s[12:15], s32 offen lds
    s_waitcnt lgkmcnt(8)
    v_mfma_f32_32x32x16_bf16 v[116:131], v[52:55], v[68:71], v[116:131]
    v_mfma_f32_32x32x16_bf16 v[132:147], v[52:55], v[72:75], v[132:147]
    v_mfma_f32_32x32x16_bf16 v[148:163], v[56:59], v[68:71], v[148:163]
    v_mfma_f32_32x32x16_bf16 v[164:179], v[56:59], v[72:75], v[164:179]
    v_mfma_f32_32x32x16_bf16 v[180:195], v[60:63], v[68:71], v[180:195]
    v_mfma_f32_32x32x16_bf16 v[196:211], v[60:63], v[72:75], v[196:211]
    v_mfma_f32_32x32x16_bf16 v[212:227], v[64:67], v[68:71], v[212:227]
    v_mfma_f32_32x32x16_bf16 v[228:243], v[64:67], v[72:75], v[228:243]
    ds_read_b128 v[52:55], v46 offset:0
    ds_read_b128 v[56:59], v46 offset:4096
    ds_read_b128 v[60:63], v46 offset:8192
    ds_read_b128 v[64:67], v46 offset:12288
    ds_read_b64_tr_b16 v[68:69], v50 offset:16384
    ds_read_b64_tr_b16 v[70:71], v50 offset:18432
    ds_read_b64_tr_b16 v[72:73], v51 offset:16384
    ds_read_b64_tr_b16 v[74:75], v51 offset:18432
    s_waitcnt lgkmcnt(8)
    v_mfma_f32_32x32x16_bf16 v[116:131], v[76:79], v[92:95], v[116:131]
    v_mfma_f32_32x32x16_bf16 v[132:147], v[76:79], v[96:99], v[132:147]
    v_mfma_f32_32x32x16_bf16 v[148:163], v[80:83], v[92:95], v[148:163]
    v_mfma_f32_32x32x16_bf16 v[164:179], v[80:83], v[96:99], v[164:179]
    v_mfma_f32_32x32x16_bf16 v[180:195], v[84:87], v[92:95], v[180:195]
    v_mfma_f32_32x32x16_bf16 v[196:211], v[84:87], v[96:99], v[196:211]
    v_mfma_f32_32x32x16_bf16 v[212:227], v[88:91], v[92:95], v[212:227]
    v_mfma_f32_32x32x16_bf16 v[228:243], v[88:91], v[96:99], v[228:243]
    ds_read_b128 v[76:79], v47 offset:0
    ds_read_b128 v[80:83], v47 offset:4096
    ds_read_b128 v[84:87], v47 offset:8192
    ds_read_b128 v[88:91], v47 offset:12288
    ds_read_b64_tr_b16 v[92:93], v50 offset:24576
    ds_read_b64_tr_b16 v[94:95], v50 offset:26624
    ds_read_b64_tr_b16 v[96:97], v51 offset:24576
    ds_read_b64_tr_b16 v[98:99], v51 offset:26624
    s_waitcnt lgkmcnt(8)
    v_mfma_f32_32x32x16_bf16 v[116:131], v[52:55], v[68:71], v[116:131]
    v_mfma_f32_32x32x16_bf16 v[132:147], v[52:55], v[72:75], v[132:147]
    v_mfma_f32_32x32x16_bf16 v[148:163], v[56:59], v[68:71], v[148:163]
    v_mfma_f32_32x32x16_bf16 v[164:179], v[56:59], v[72:75], v[164:179]
    v_mfma_f32_32x32x16_bf16 v[180:195], v[60:63], v[68:71], v[180:195]
    v_mfma_f32_32x32x16_bf16 v[196:211], v[60:63], v[72:75], v[196:211]
    v_mfma_f32_32x32x16_bf16 v[212:227], v[64:67], v[68:71], v[212:227]
    v_mfma_f32_32x32x16_bf16 v[228:243], v[64:67], v[72:75], v[228:243]
    s_waitcnt lgkmcnt(0)
    v_mfma_f32_32x32x16_bf16 v[116:131], v[76:79], v[92:95], v[116:131]
    v_mfma_f32_32x32x16_bf16 v[132:147], v[76:79], v[96:99], v[132:147]
    v_mfma_f32_32x32x16_bf16 v[148:163], v[80:83], v[92:95], v[148:163]
    v_mfma_f32_32x32x16_bf16 v[164:179], v[80:83], v[96:99], v[164:179]
    v_mfma_f32_32x32x16_bf16 v[180:195], v[84:87], v[92:95], v[180:195]
    v_mfma_f32_32x32x16_bf16 v[196:211], v[84:87], v[96:99], v[196:211]
    v_mfma_f32_32x32x16_bf16 v[212:227], v[88:91], v[92:95], v[212:227]
    v_mfma_f32_32x32x16_bf16 v[228:243], v[88:91], v[96:99], v[228:243]
    s_sub_u32 s30, s30, 1
    s_cmp_lg_u32 s30, 0
    s_cbranch_scc1 gloop_3
    s_waitcnt vmcnt(0)
    s_barrier
    ds_read_b128 v[52:55], v40 offset:0
    ds_read_b128 v[56:59], v40 offset:4096
    ds_read_b128 v[60:63], v40 offset:8192
    ds_read_b128 v[64:67], v40 offset:12288
    ds_read_b64_tr_b16 v[68:69], v48 offset:0
    ds_read_b64_tr_b16 v[70:71], v48 offset:2048
    ds_read_b64_tr_b16 v[72:73], v49 offset:0
    ds_read_b64_tr_b16 v[74:75], v49 offset:2048
    ds_read_b128 v[76:79], v41 offset:0
    ds_read_b128 v[80:83], v41 offset:4096
    ds_read_b128 v[84:87], v41 offset:8192
    ds_read_b128 v[88:91], v41 offset:12288
    ds_read_b64_tr_b16 v[92:93], v48 offset:8192
    ds_read_b64_tr_b16 v[94:95], v48 offset:10240
    ds_read_b64_tr_b16 v[96:97], v49 offset:8192
    ds_read_b64_tr_b16 v[98:99], v49 offset:10240
    s_lshl_b32 s31, s52, 7
    s_add_u32 s31, s31, s53
    s_mul_i32 s32, s52, 524288
    s_add_u32 s32, s32, s54
    s_add_u32 s52, s52, 1
    s_cmp_eq_u32 s52, 8
    s_cselect_b32 s52, 0, s52
    s_add_u32 m0, s45, 65536
    s_nop 0
    buffer_load_dwordx4 v32, s[8:11], s31 offen lds
    s_add_u32 m0, s45, 66560
    s_nop 0
    buffer_load_dwordx4 v33, s[8:11], s31 offen lds
    s_add_u32 m0, s45, 67584
    s_nop 0
    buffer_load_dwordx4 v34, s[8:11], s31 offen lds
    s_add_u32 m0, s45, 68608
    s_nop 0
    buffer_load_dwordx4 v35, s[8:11], s31 offen lds
    s_add_u32 m0, s46, 98304
    s_nop 0
    buffer_load_dwordx4 v36, s[12:15], s32 offen lds
    s_add_u32 m0, s46, 99328
    s_nop 0
    buffer_load_dwordx4 v37, s[12:15], s32 offen lds
    s_add_u32 m0, s46, 100352
    s_nop 0
    buffer_load_dwordx4 v38, s[12:15], s32 offen lds
    s_add_u32 m0, s46, 101376
    s_nop 0
    buffer_load_dwordx4 v39, s[12:15], s32 offen lds
    s_waitcnt lgkmcnt(8)
    v_mfma_f32_32x32x16_bf16 v[116:131], v[52:55], v[68:71], v[116:131]
    v_mfma_f32_32x32x16_bf16 v[132:147], v[52:55], v[72:75], v[132:147]
    v_mfma_f32_32x32x16_bf16 v[148:163], v[56:59], v[68:71], v[148:163]
    v_mfma_f32_32x32x16_bf16 v[164:179], v[56:59], v[72:75], v[164:179]
    v_mfma_f32_32x32x16_bf16 v[180:195], v[60:63], v[68:71], v[180:195]
    v_mfma_f32_32x32x16_bf16 v[196:211], v[60:63], v[72:75], v[196:211]
    v_mfma_f32_32x32x16_bf16 v[212:227], v[64:67], v[68:71], v[212:227]
    v_mfma_f32_32x32x16_bf16 v[228:243], v[64:67], v[72:75], v[228:243]
    ds_read_b128 v[52:55], v42 offset:0
    ds_read_b128 v[56:59], v42 offset:4096
    ds_read_b128 v[60:63], v42 offset:8192
    ds_read_b128 v[64:67], v42 offset:12288
    ds_read_b64_tr_b16 v[68:69], v48 offset:16384
    ds_read_b64_tr_b16 v[70:71], v48 offset:18432
    ds_read_b64_tr_b16 v[72:73], v49 offset:16384
    ds_read_b64_tr_b16 v[74:75], v49 offset:18432
    s_waitcnt lgkmcnt(8)
    v_mfma_f32_32x32x16_bf16 v[116:131], v[76:79], v[92:95], v[116:131]
    v_mfma_f32_32x32x16_bf16 v[132:147], v[76:79], v[96:99], v[132:147]
    v_mfma_f32_32x32x16_bf16 v[148:163], v[80:83], v[92:95], v[148:163]
    v_mfma_f32_32x32x16_bf16 v[164:179], v[80:83], v[96:99], v[164:179]
    v_mfma_f32_32x32x16_bf16 v[180:195], v[84:87], v[92:95], v[180:195]
    v_mfma_f32_32x32x16_bf16 v[196:211], v[84:87], v[96:99], v[196:211]
    v_mfma_f32_32x32x16_bf16 v[212:227], v[88:91], v[92:95], v[212:227]
    v_mfma_f32_32x32x16_bf16 v[228:243], v[88:91], v[96:99], v[228:243]
    ds_read_b128 v[76:79], v43 offset:0
    ds_read_b128 v[80:83], v43 offset:4096
    ds_read_b128 v[84:87], v43 offset:8192
    ds_read_b128 v[88:91], v43 offset:12288
    ds_read_b64_tr_b16 v[92:93], v48 offset:24576
    ds_read_b64_tr_b16 v[94:95], v48 offset:26624
    ds_read_b64_tr_b16 v[96:97], v49 offset:24576
    ds_read_b64_tr_b16 v[98:99], v49 offset:26624
    s_waitcnt lgkmcnt(8)
    v_mfma_f32_32x32x16_bf16 v[116:131], v[52:55], v[68:71], v[116:131]
    v_mfma_f32_32x32x16_bf16 v[132:147], v[52:55], v[72:75], v[132:147]
    v_mfma_f32_32x32x16_bf16 v[148:163], v[56:59], v[68:71], v[148:163]
    v_mfma_f32_32x32x16_bf16 v[164:179], v[56:59], v[72:75], v[164:179]
    v_mfma_f32_32x32x16_bf16 v[180:195], v[60:63], v[68:71], v[180:195]
    v_mfma_f32_32x32x16_bf16 v[196:211], v[60:63], v[72:75], v[196:211]
    v_mfma_f32_32x32x16_bf16 v[212:227], v[64:67], v[68:71], v[212:227]
    v_mfma_f32_32x32x16_bf16 v[228:243], v[64:67], v[72:75], v[228:243]
    s_waitcnt lgkmcnt(0)
    v_mfma_f32_32x32x16_bf16 v[116:131], v[76:79], v[92:95], v[116:131]
    v_mfma_f32_32x32x16_bf16 v[132:147], v[76:79], v[96:99], v[132:147]
    v_mfma_f32_32x32x16_bf16 v[148:163], v[80:83], v[92:95], v[148:163]
    v_mfma_f32_32x32x16_bf16 v[164:179], v[80:83], v[96:99], v[164:179]
    v_mfma_f32_32x32x16_bf16 v[180:195], v[84:87], v[92:95], v[180:195]
    v_mfma_f32_32x32x16_bf16 v[196:211], v[84:87], v[96:99], v[196:211]
    v_mfma_f32_32x32x16_bf16 v[212:227], v[88:91], v[92:95], v[212:227]
    v_mfma_f32_32x32x16_bf16 v[228:243], v[88:91], v[96:99], v[228:243]
    s_waitcnt vmcnt(0)
    s_barrier
    ds_read_b128 v[52:55], v44 offset:0
    ds_read_b128 v[56:59], v44 offset:4096
    ds_read_b128 v[60:63], v44 offset:8192
    ds_read_b128 v[64:67], v44 offset:12288
    ds_read_b64_tr_b16 v[68:69], v50 offset:0
    ds_read_b64_tr_b16 v[70:71], v50 offset:2048
    ds_read_b64_tr_b16 v[72:73], v51 offset:0
    ds_read_b64_tr_b16 v[74:75], v51 offset:2048
    ds_read_b128 v[76:79], v45 offset:0
    ds_read_b128 v[80:83], v45 offset:4096
    ds_read_b128 v[84:87], v45 offset:8192
    ds_read_b128 v[88:91], v45 offset:12288
    ds_read_b64_tr_b16 v[92:93], v50 offset:8192
    ds_read_b64_tr_b16 v[94:95], v50 offset:10240
    ds_read_b64_tr_b16 v[96:97], v51 offset:8192
    ds_read_b64_tr_b16 v[98:99], v51 offset:10240
    s_waitcnt lgkmcnt(8)
    v_mfma_f32_32x32x16_bf16 v[116:131], v[52:55], v[68:71], v[116:131]
    v_mfma_f32_32x32x16_bf16 v[132:147], v[52:55], v[72:75], v[132:147]
    v_mfma_f32_32x32x16_bf16 v[148:163], v[56:59], v[68:71], v[148:163]
    v_mfma_f32_32x32x16_bf16 v[164:179], v[56:59], v[72:75], v[164:179]
    v_mfma_f32_32x32x16_bf16 v[180:195], v[60:63], v[68:71], v[180:195]
    v_mfma_f32_32x32x16_bf16 v[196:211], v[60:63], v[72:75], v[196:211]
    v_mfma_f32_32x32x16_bf16 v[212:227], v[64:67], v[68:71], v[212:227]
    v_mfma_f32_32x32x16_bf16 v[228:243], v[64:67], v[72:75], v[228:243]
    ds_read_b128 v[52:55], v46 offset:0
    ds_read_b128 v[56:59], v46 offset:4096
    ds_read_b128 v[60:63], v46 offset:8192
    ds_read_b128 v[64:67], v46 offset:12288
    ds_read_b64_tr_b16 v[68:69], v50 offset:16384
    ds_read_b64_tr_b16 v[70:71], v50 offset:18432
    ds_read_b64_tr_b16 v[72:73], v51 offset:16384
    ds_read_b64_tr_b16 v[74:75], v51 offset:18432
    s_waitcnt lgkmcnt(8)
    v_mfma_f32_32x32x16_bf16 v[116:131], v[76:79], v[92:95], v[116:131]
    v_mfma_f32_32x32x16_bf16 v[132:147], v[76:79], v[96:99], v[132:147]
    v_mfma_f32_32x32x16_bf16 v[148:163], v[80:83], v[92:95], v[148:163]
    v_mfma_f32_32x32x16_bf16 v[164:179], v[80:83], v[96:99], v[164:179]
    v_mfma_f32_32x32x16_bf16 v[180:195], v[84:87], v[92:95], v[180:195]
    v_mfma_f32_32x32x16_bf16 v[196:211], v[84:87], v[96:99], v[196:211]
    v_mfma_f32_32x32x16_bf16 v[212:227], v[88:91], v[92:95], v[212:227]
    v_mfma_f32_32x32x16_bf16 v[228:243], v[88:91], v[96:99], v[228:243]
    ds_read_b128 v[76:79], v47 offset:0
    ds_read_b128 v[80:83], v47 offset:4096
    ds_read_b128 v[84:87], v47 offset:8192
    ds_read_b128 v[88:91], v47 offset:12288
    ds_read_b64_tr_b16 v[92:93], v50 offset:24576
    ds_read_b64_tr_b16 v[94:95], v50 offset:26624
    ds_read_b64_tr_b16 v[96:97], v51 offset:24576
    ds_read_b64_tr_b16 v[98:99], v51 offset:26624
    s_waitcnt lgkmcnt(8)
    v_mfma_f32_32x32x16_bf16 v[116:131], v[52:55], v[68:71], v[116:131]
    v_mfma_f32_32x32x16_bf16 v[132:147], v[52:55], v[72:75], v[132:147]
    v_mfma_f32_32x32x16_bf16 v[148:163], v[56:59], v[68:71], v[148:163]
    v_mfma_f32_32x32x16_bf16 v[164:179], v[56:59], v[72:75], v[164:179]
    v_mfma_f32_32x32x16_bf16 v[180:195], v[60:63], v[68:71], v[180:195]
    v_mfma_f32_32x32x16_bf16 v[196:211], v[60:63], v[72:75], v[196:211]
    v_mfma_f32_32x32x16_bf16 v[212:227], v[64:67], v[68:71], v[212:227]
    v_mfma_f32_32x32x16_bf16 v[228:243], v[64:67], v[72:75], v[228:243]
    s_waitcnt lgkmcnt(0)
    v_mfma_f32_32x32x16_bf16 v[116:131], v[76:79], v[92:95], v[116:131]
    v_mfma_f32_32x32x16_bf16 v[132:147], v[76:79], v[96:99], v[132:147]
    v_mfma_f32_32x32x16_bf16 v[148:163], v[80:83], v[92:95], v[148:163]
    v_mfma_f32_32x32x16_bf16 v[164:179], v[80:83], v[96:99], v[164:179]
    v_mfma_f32_32x32x16_bf16 v[180:195], v[84:87], v[92:95], v[180:195]
    v_mfma_f32_32x32x16_bf16 v[196:211], v[84:87], v[96:99], v[196:211]
    v_mfma_f32_32x32x16_bf16 v[212:227], v[88:91], v[92:95], v[212:227]
    v_mfma_f32_32x32x16_bf16 v[228:243], v[88:91], v[96:99], v[228:243]
    s_nop 7
    s_nop 7
    s_lshl_b32 s50, s34, 12
    s_lshl_b32 s5, s33, 1
    s_add_u32 s50, s50, s5
    s_barrier
    s_mul_i32 s4, s42, 64
    s_mul_i32 s5, s41, 256
    v_add_u32 v1, s4, v24
    v_lshlrev_b32 v2, 4, v25
    v_add_u32 v2, s5, v2
    v_and_b32 v3, 15, v24
    v_lshlrev_b32 v3, 4, v3
    v_lshlrev_b32 v1, 9, v1

    v_cvt_pk_bf16_f32 v116, v116, v117
    v_cvt_pk_bf16_f32 v117, v118, v119
    v_cvt_pk_bf16_f32 v118, v120, v121
    v_cvt_pk_bf16_f32 v119, v122, v123
    v_cvt_pk_bf16_f32 v120, v124, v125
    v_cvt_pk_bf16_f32 v121, v126, v127
    v_cvt_pk_bf16_f32 v122, v128, v129
    v_cvt_pk_bf16_f32 v123, v130, v131
    v_add_u32 v4, 0, v2
    v_xor_b32 v4, v4, v3
    v_add_u32 v4, v4, v1
    ds_write_b128 v4, v[116:119] offset:0
    v_add_u32 v4, 32, v2
    v_xor_b32 v4, v4, v3
    v_add_u32 v4, v4, v1
    ds_write_b128 v4, v[120:123] offset:0
    v_cvt_pk_bf16_f32 v132, v132, v133
    v_cvt_pk_bf16_f32 v133, v134, v135
    v_cvt_pk_bf16_f32 v134, v136, v137
    v_cvt_pk_bf16_f32 v135, v138, v139
    v_cvt_pk_bf16_f32 v136, v140, v141
    v_cvt_pk_bf16_f32 v137, v142, v143
    v_cvt_pk_bf16_f32 v138, v144, v145
    v_cvt_pk_bf16_f32 v139, v146, v147
    v_add_u32 v4, 0, v2
    v_xor_b32 v4, v4, v3
    v_add_u32 v4, v4, v1
    ds_write_b128 v4, v[132:135] offset:16384
    v_add_u32 v4, 32, v2
    v_xor_b32 v4, v4, v3
    v_add_u32 v4, v4, v1
    ds_write_b128 v4, v[136:139] offset:16384
    v_cvt_pk_bf16_f32 v148, v148, v149
    v_cvt_pk_bf16_f32 v149, v150, v151
    v_cvt_pk_bf16_f32 v150, v152, v153
    v_cvt_pk_bf16_f32 v151, v154, v155
    v_cvt_pk_bf16_f32 v152, v156, v157
    v_cvt_pk_bf16_f32 v153, v158, v159
    v_cvt_pk_bf16_f32 v154, v160, v161
    v_cvt_pk_bf16_f32 v155, v162, v163
    v_add_u32 v4, 64, v2
    v_xor_b32 v4, v4, v3
    v_add_u32 v4, v4, v1
    ds_write_b128 v4, v[148:151] offset:0
    v_add_u32 v4, 96, v2
    v_xor_b32 v4, v4, v3
    v_add_u32 v4, v4, v1
    ds_write_b128 v4, v[152:155] offset:0
    v_cvt_pk_bf16_f32 v164, v164, v165
    v_cvt_pk_bf16_f32 v165, v166, v167
    v_cvt_pk_bf16_f32 v166, v168, v169
    v_cvt_pk_bf16_f32 v167, v170, v171
    v_cvt_pk_bf16_f32 v168, v172, v173
    v_cvt_pk_bf16_f32 v169, v174, v175
    v_cvt_pk_bf16_f32 v170, v176, v177
    v_cvt_pk_bf16_f32 v171, v178, v179
    v_add_u32 v4, 64, v2
    v_xor_b32 v4, v4, v3
    v_add_u32 v4, v4, v1
    ds_write_b128 v4, v[164:167] offset:16384
    v_add_u32 v4, 96, v2
    v_xor_b32 v4, v4, v3
    v_add_u32 v4, v4, v1
    ds_write_b128 v4, v[168:171] offset:16384
    v_cvt_pk_bf16_f32 v180, v180, v181
    v_cvt_pk_bf16_f32 v181, v182, v183
    v_cvt_pk_bf16_f32 v182, v184, v185
    v_cvt_pk_bf16_f32 v183, v186, v187
    v_cvt_pk_bf16_f32 v184, v188, v189
    v_cvt_pk_bf16_f32 v185, v190, v191
    v_cvt_pk_bf16_f32 v186, v192, v193
    v_cvt_pk_bf16_f32 v187, v194, v195
    v_add_u32 v4, 128, v2
    v_xor_b32 v4, v4, v3
    v_add_u32 v4, v4, v1
    ds_write_b128 v4, v[180:183] offset:0
    v_add_u32 v4, 160, v2
    v_xor_b32 v4, v4, v3
    v_add_u32 v4, v4, v1
    ds_write_b128 v4, v[184:187] offset:0
    v_cvt_pk_bf16_f32 v196, v196, v197
    v_cvt_pk_bf16_f32 v197, v198, v199
    v_cvt_pk_bf16_f32 v198, v200, v201
    v_cvt_pk_bf16_f32 v199, v202, v203
    v_cvt_pk_bf16_f32 v200, v204, v205
    v_cvt_pk_bf16_f32 v201, v206, v207
    v_cvt_pk_bf16_f32 v202, v208, v209
    v_cvt_pk_bf16_f32 v203, v210, v211
    v_add_u32 v4, 128, v2
    v_xor_b32 v4, v4, v3
    v_add_u32 v4, v4, v1
    ds_write_b128 v4, v[196:199] offset:16384
    v_add_u32 v4, 160, v2
    v_xor_b32 v4, v4, v3
    v_add_u32 v4, v4, v1
    ds_write_b128 v4, v[200:203] offset:16384
    v_cvt_pk_bf16_f32 v212, v212, v213
    v_cvt_pk_bf16_f32 v213, v214, v215
    v_cvt_pk_bf16_f32 v214, v216, v217
    v_cvt_pk_bf16_f32 v215, v218, v219
    v_cvt_pk_bf16_f32 v216, v220, v221
    v_cvt_pk_bf16_f32 v217, v222, v223
    v_cvt_pk_bf16_f32 v218, v224, v225
    v_cvt_pk_bf16_f32 v219, v226, v227
    v_add_u32 v4, 192, v2
    v_xor_b32 v4, v4, v3
    v_add_u32 v4, v4, v1
    ds_write_b128 v4, v[212:215] offset:0
    v_add_u32 v4, 224, v2
    v_xor_b32 v4, v4, v3
    v_add_u32 v4, v4, v1
    ds_write_b128 v4, v[216:219] offset:0
    v_cvt_pk_bf16_f32 v228, v228, v229
    v_cvt_pk_bf16_f32 v229, v230, v231
    v_cvt_pk_bf16_f32 v230, v232, v233
    v_cvt_pk_bf16_f32 v231, v234, v235
    v_cvt_pk_bf16_f32 v232, v236, v237
    v_cvt_pk_bf16_f32 v233, v238, v239
    v_cvt_pk_bf16_f32 v234, v240, v241
    v_cvt_pk_bf16_f32 v235, v242, v243
    v_add_u32 v4, 192, v2
    v_xor_b32 v4, v4, v3
    v_add_u32 v4, v4, v1
    ds_write_b128 v4, v[228:231] offset:16384
    v_add_u32 v4, 224, v2
    v_xor_b32 v4, v4, v3
    v_add_u32 v4, v4, v1
    ds_write_b128 v4, v[232:235] offset:16384
    s_waitcnt lgkmcnt(0)
    s_barrier
    v_lshrrev_b32 v1, 5, v0
    v_and_b32 v2, 31, v0
    v_lshlrev_b32 v2, 4, v2
    v_lshrrev_b32 v5, 8, v2
    v_and_b32 v6, 255, v2
    s_mov_b32 s4, 256
    v_mul_lo_u32 v5, v5, s4
    v_add_u32 v5, v5, v6
    s_mov_b32 s4, 4096
    v_mul_lo_u32 v6, v1, s4
    v_add_u32 v5, v5, v6
    v_add_u32 v5, s50, v5
    v_lshlrev_b32 v7, 9, v1

    v_add_u32 v3, 0, v1
    v_and_b32 v3, 15, v3
    v_lshlrev_b32 v3, 4, v3
    v_xor_b32 v3, v3, v2
    v_add_u32 v3, v3, v7
    ds_read_b128 v[116:119], v3 offset:0
    v_add_u32 v3, 16, v1
    v_and_b32 v3, 15, v3
    v_lshlrev_b32 v3, 4, v3
    v_xor_b32 v3, v3, v2
    v_add_u32 v3, v3, v7
    ds_read_b128 v[120:123], v3 offset:8192
    v_add_u32 v3, 32, v1
    v_and_b32 v3, 15, v3
    v_lshlrev_b32 v3, 4, v3
    v_xor_b32 v3, v3, v2
    v_add_u32 v3, v3, v7
    ds_read_b128 v[124:127], v3 offset:16384
    v_add_u32 v3, 48, v1
    v_and_b32 v3, 15, v3
    v_lshlrev_b32 v3, 4, v3
    v_xor_b32 v3, v3, v2
    v_add_u32 v3, v3, v7
    ds_read_b128 v[128:131], v3 offset:24576
    v_add_u32 v3, 64, v1
    v_and_b32 v3, 15, v3
    v_lshlrev_b32 v3, 4, v3
    v_xor_b32 v3, v3, v2
    v_add_u32 v3, v3, v7
    ds_read_b128 v[132:135], v3 offset:32768
    v_add_u32 v3, 80, v1
    v_and_b32 v3, 15, v3
    v_lshlrev_b32 v3, 4, v3
    v_xor_b32 v3, v3, v2
    v_add_u32 v3, v3, v7
    ds_read_b128 v[136:139], v3 offset:40960
    v_add_u32 v3, 96, v1
    v_and_b32 v3, 15, v3
    v_lshlrev_b32 v3, 4, v3
    v_xor_b32 v3, v3, v2
    v_add_u32 v3, v3, v7
    ds_read_b128 v[140:143], v3 offset:49152
    v_add_u32 v3, 112, v1
    v_and_b32 v3, 15, v3
    v_lshlrev_b32 v3, 4, v3
    v_xor_b32 v3, v3, v2
    v_add_u32 v3, v3, v7
    ds_read_b128 v[144:147], v3 offset:57344
    v_add_u32 v3, 128, v1
    v_and_b32 v3, 15, v3
    v_lshlrev_b32 v3, 4, v3
    v_xor_b32 v3, v3, v2
    v_add_u32 v3, v3, v7
    v_add_u32 v3, 65536, v3
    ds_read_b128 v[148:151], v3 offset:0
    v_add_u32 v3, 144, v1
    v_and_b32 v3, 15, v3
    v_lshlrev_b32 v3, 4, v3
    v_xor_b32 v3, v3, v2
    v_add_u32 v3, v3, v7
    v_add_u32 v3, 73728, v3
    ds_read_b128 v[152:155], v3 offset:0
    v_add_u32 v3, 160, v1
    v_and_b32 v3, 15, v3
    v_lshlrev_b32 v3, 4, v3
    v_xor_b32 v3, v3, v2
    v_add_u32 v3, v3, v7
    v_add_u32 v3, 81920, v3
    ds_read_b128 v[156:159], v3 offset:0
    v_add_u32 v3, 176, v1
    v_and_b32 v3, 15, v3
    v_lshlrev_b32 v3, 4, v3
    v_xor_b32 v3, v3, v2
    v_add_u32 v3, v3, v7
    v_add_u32 v3, 90112, v3
    ds_read_b128 v[160:163], v3 offset:0
    v_add_u32 v3, 192, v1
    v_and_b32 v3, 15, v3
    v_lshlrev_b32 v3, 4, v3
    v_xor_b32 v3, v3, v2
    v_add_u32 v3, v3, v7
    v_add_u32 v3, 98304, v3
    ds_read_b128 v[164:167], v3 offset:0
    v_add_u32 v3, 208, v1
    v_and_b32 v3, 15, v3
    v_lshlrev_b32 v3, 4, v3
    v_xor_b32 v3, v3, v2
    v_add_u32 v3, v3, v7
    v_add_u32 v3, 106496, v3
    ds_read_b128 v[168:171], v3 offset:0
    v_add_u32 v3, 224, v1
    v_and_b32 v3, 15, v3
    v_lshlrev_b32 v3, 4, v3
    v_xor_b32 v3, v3, v2
    v_add_u32 v3, v3, v7
    v_add_u32 v3, 114688, v3
    ds_read_b128 v[172:175], v3 offset:0
    v_add_u32 v3, 240, v1
    v_and_b32 v3, 15, v3
    v_lshlrev_b32 v3, 4, v3
    v_xor_b32 v3, v3, v2
    v_add_u32 v3, v3, v7
    v_add_u32 v3, 122880, v3
    ds_read_b128 v[176:179], v3 offset:0
    s_waitcnt lgkmcnt(15)
    s_mov_b32 s4, 0
    buffer_store_dwordx4 v[116:119], v5, s[16:19], s4 offen
    s_waitcnt lgkmcnt(14)
    s_mov_b32 s4, 65536
    buffer_store_dwordx4 v[120:123], v5, s[16:19], s4 offen
    s_waitcnt lgkmcnt(13)
    s_mov_b32 s4, 131072
    buffer_store_dwordx4 v[124:127], v5, s[16:19], s4 offen
    s_waitcnt lgkmcnt(12)
    s_mov_b32 s4, 196608
    buffer_store_dwordx4 v[128:131], v5, s[16:19], s4 offen
    s_waitcnt lgkmcnt(11)
    s_mov_b32 s4, 262144
    buffer_store_dwordx4 v[132:135], v5, s[16:19], s4 offen
    s_waitcnt lgkmcnt(10)
    s_mov_b32 s4, 327680
    buffer_store_dwordx4 v[136:139], v5, s[16:19], s4 offen
    s_waitcnt lgkmcnt(9)
    s_mov_b32 s4, 393216
    buffer_store_dwordx4 v[140:143], v5, s[16:19], s4 offen
    s_waitcnt lgkmcnt(8)
    s_mov_b32 s4, 458752
    buffer_store_dwordx4 v[144:147], v5, s[16:19], s4 offen
    s_waitcnt lgkmcnt(7)
    s_mov_b32 s4, 524288
    buffer_store_dwordx4 v[148:151], v5, s[16:19], s4 offen
    s_waitcnt lgkmcnt(6)
    s_mov_b32 s4, 589824
    buffer_store_dwordx4 v[152:155], v5, s[16:19], s4 offen
    s_waitcnt lgkmcnt(5)
    s_mov_b32 s4, 655360
    buffer_store_dwordx4 v[156:159], v5, s[16:19], s4 offen
    s_waitcnt lgkmcnt(4)
    s_mov_b32 s4, 720896
    buffer_store_dwordx4 v[160:163], v5, s[16:19], s4 offen
    s_waitcnt lgkmcnt(3)
    s_mov_b32 s4, 786432
    buffer_store_dwordx4 v[164:167], v5, s[16:19], s4 offen
    s_waitcnt lgkmcnt(2)
    s_mov_b32 s4, 851968
    buffer_store_dwordx4 v[168:171], v5, s[16:19], s4 offen
    s_waitcnt lgkmcnt(1)
    s_mov_b32 s4, 917504
    buffer_store_dwordx4 v[172:175], v5, s[16:19], s4 offen
    s_waitcnt lgkmcnt(0)
    s_mov_b32 s4, 983040
    buffer_store_dwordx4 v[176:179], v5, s[16:19], s4 offen
    s_branch qkv_done
qkv_q:
    s_lshl_b32 s37, s4, 2
    s_add_u32 s37, s37, s5
    s_lshl_b32 s34, s37, 7
    v_and_b32 v26, 63, v0
    v_and_b32 v24, 31, v0
    v_bfe_u32 v25, v0, 5, 1
    v_lshrrev_b32 v1, 6, v0
    s_nop 0
    v_readfirstlane_b32 s40, v1
    s_nop 3
    s_lshr_b32 s41, s40, 1
    s_and_b32 s42, s40, 1

    s_load_dwordx2 s[8:9], s[0:1], 104
    s_mov_b32 s10, 2097152
    s_mov_b32 s11, 0x00020000
    s_load_dwordx2 s[12:13], s[0:1], 16
    s_mov_b32 s14, 4194304
    s_mov_b32 s15, 0x00020000
    s_load_dwordx2 s[16:17], s[0:1], 104
    s_mov_b32 s18, 16777216
    s_mov_b32 s19, 0x00020000
    s_waitcnt lgkmcnt(0)
    s_add_u32 s8, s8, 1048576
    s_addc_u32 s9, s9, 0
    s_add_u32 s16, s16, 16777216
    s_addc_u32 s17, s17, 0
    v_lshrrev_b32 v1, 3, v26
    v_lshrrev_b32 v2, 4, v26
    v_and_b32 v3, 7, v26
    s_mul_i32 s4, s40, 4
    s_mov_b32 s5, 1024

    s_add_u32 s6, s4, 0
    s_lshl_b32 s7, s6, 2
    v_add_u32 v4, s7, v2
    v_and_b32 v4, 7, v4
    v_xor_b32 v4, v4, v3
    s_lshl_b32 s7, s6, 3
    s_add_u32 s7, s7, s33
    v_add_u32 v5, s7, v1
    v_mul_lo_u32 v5, v5, s5
    v_lshl_add_u32 v32, v4, 4, v5

    s_add_u32 s6, s4, 1
    s_lshl_b32 s7, s6, 2
    v_add_u32 v4, s7, v2
    v_and_b32 v4, 7, v4
    v_xor_b32 v4, v4, v3
    s_lshl_b32 s7, s6, 3
    s_add_u32 s7, s7, s33
    v_add_u32 v5, s7, v1
    v_mul_lo_u32 v5, v5, s5
    v_lshl_add_u32 v33, v4, 4, v5

    s_add_u32 s6, s4, 2
    s_lshl_b32 s7, s6, 2
    v_add_u32 v4, s7, v2
    v_and_b32 v4, 7, v4
    v_xor_b32 v4, v4, v3
    s_lshl_b32 s7, s6, 3
    s_add_u32 s7, s7, s33
    v_add_u32 v5, s7, v1
    v_mul_lo_u32 v5, v5, s5
    v_lshl_add_u32 v34, v4, 4, v5

    s_add_u32 s6, s4, 3
    s_lshl_b32 s7, s6, 2
    v_add_u32 v4, s7, v2
    v_and_b32 v4, 7, v4
    v_xor_b32 v4, v4, v3
    s_lshl_b32 s7, s6, 3
    s_add_u32 s7, s7, s33
    v_add_u32 v5, s7, v1
    v_mul_lo_u32 v5, v5, s5
    v_lshl_add_u32 v35, v4, 4, v5

    s_mul_i32 s4, s40, 2
    s_mov_b32 s5, 8192
    s_lshl_b32 s44, s34, 1
    v_lshlrev_b32 v1, 4, v26

    s_add_u32 s6, s4, 0
    s_lshl_b32 s6, s6, 10
    v_add_u32 v2, s6, v1
    v_lshrrev_b32 v3, 8, v2
    v_and_b32 v4, 255, v2

    v_and_b32 v5, 3, v3
    v_lshlrev_b32 v5, 6, v5
    v_xor_b32 v4, v4, v5
    v_mul_lo_u32 v3, v3, s5
    v_add_u32 v3, v3, v4
    v_add_u32 v36, s44, v3
    s_add_u32 s6, s4, 1
    s_lshl_b32 s6, s6, 10
    v_add_u32 v2, s6, v1
    v_lshrrev_b32 v3, 8, v2
    v_and_b32 v4, 255, v2

    v_and_b32 v5, 3, v3
    v_lshlrev_b32 v5, 6, v5
    v_xor_b32 v4, v4, v5
    v_mul_lo_u32 v3, v3, s5
    v_add_u32 v3, v3, v4
    v_add_u32 v37, s44, v3
    s_mul_i32 s4, s41, 64
    v_add_u32 v1, s4, v24
    v_bfe_u32 v2, v1, 1, 3
    v_lshlrev_b32 v1, 7, v1

    v_add_u32 v3, 0, v25
    v_xor_b32 v3, v3, v2
    v_lshl_add_u32 v38, v3, 4, v1
    v_add_u32 v3, 2, v25
    v_xor_b32 v3, v3, v2
    v_lshl_add_u32 v39, v3, 4, v1
    v_add_u32 v3, 4, v25
    v_xor_b32 v3, v3, v2
    v_lshl_add_u32 v40, v3, 4, v1
    v_add_u32 v3, 6, v25
    v_xor_b32 v3, v3, v2
    v_lshl_add_u32 v41, v3, 4, v1
    v_bfe_u32 v1, v26, 2, 2
    v_lshrrev_b32 v2, 5, v26
    v_lshlrev_b32 v2, 11, v2
    v_lshl_add_u32 v2, v1, 8, v2
    v_bfe_u32 v3, v26, 4, 1
    v_lshl_add_u32 v2, v3, 5, v2
    v_and_b32 v3, 3, v26
    v_lshl_add_u32 v2, v3, 3, v2
    v_add_u32 v2, 32768, v2
    s_mul_i32 s4, s42, 2

    s_add_u32 s5, s4, 0
    v_xor_b32 v3, s5, v1
    v_lshl_add_u32 v46, v3, 6, v2
    s_add_u32 s5, s4, 1
    v_xor_b32 v3, s5, v1
    v_lshl_add_u32 v47, v3, 6, v2
    v_add_u32 v42, 65536, v38
    v_add_u32 v43, 65536, v39
    v_add_u32 v44, 65536, v40
    v_add_u32 v45, 65536, v41
    v_add_u32 v48, 65536, v46
    v_add_u32 v49, 65536, v47
    v_mov_b32 v116, 0
    v_mov_b32 v117, 0
    v_mov_b32 v118, 0
    v_mov_b32 v119, 0
    v_mov_b32 v120, 0
    v_mov_b32 v121, 0
    v_mov_b32 v122, 0
    v_mov_b32 v123, 0
    v_mov_b32 v124, 0
    v_mov_b32 v125, 0
    v_mov_b32 v126, 0
    v_mov_b32 v127, 0
    v_mov_b32 v128, 0
    v_mov_b32 v129, 0
    v_mov_b32 v130, 0
    v_mov_b32 v131, 0
    v_mov_b32 v132, 0
    v_mov_b32 v133, 0
    v_mov_b32 v134, 0
    v_mov_b32 v135, 0
    v_mov_b32 v136, 0
    v_mov_b32 v137, 0
    v_mov_b32 v138, 0
    v_mov_b32 v139, 0
    v_mov_b32 v140, 0
    v_mov_b32 v141, 0
    v_mov_b32 v142, 0
    v_mov_b32 v143, 0
    v_mov_b32 v144, 0
    v_mov_b32 v145, 0
    v_mov_b32 v146, 0
    v_mov_b32 v147, 0
    v_mov_b32 v148, 0
    v_mov_b32 v149, 0
    v_mov_b32 v150, 0
    v_mov_b32 v151, 0
    v_mov_b32 v152, 0
    v_mov_b32 v153, 0
    v_mov_b32 v154, 0
    v_mov_b32 v155, 0
    v_mov_b32 v156, 0
    v_mov_b32 v157, 0
    v_mov_b32 v158, 0
    v_mov_b32 v159, 0
    v_mov_b32 v160, 0
    v_mov_b32 v161, 0
    v_mov_b32 v162, 0
    v_mov_b32 v163, 0
    v_mov_b32 v164, 0
    v_mov_b32 v165, 0
    v_mov_b32 v166, 0
    v_mov_b32 v167, 0
    v_mov_b32 v168, 0
    v_mov_b32 v169, 0
    v_mov_b32 v170, 0
    v_mov_b32 v171, 0
    v_mov_b32 v172, 0
    v_mov_b32 v173, 0
    v_mov_b32 v174, 0
    v_mov_b32 v175, 0
    v_mov_b32 v176, 0
    v_mov_b32 v177, 0
    v_mov_b32 v178, 0
    v_mov_b32 v179, 0
    s_lshl_b32 s45, s40, 10
    s_mul_i32 s46, s45, 2
    s_mul_i32 s45, s45, 4
    s_mov_b32 s53, s31
    s_mov_b32 s54, s32
    s_lshr_b32 s52, s2, 3
    s_and_b32 s52, s52, 31

    s_sub_u32 s4, s52, 8
    s_cmp_ge_u32 s52, 8
    s_cselect_b32 s52, s4, s52
    s_sub_u32 s4, s52, 8
    s_cmp_ge_u32 s52, 8
    s_cselect_b32 s52, s4, s52
    s_sub_u32 s4, s52, 8
    s_cmp_ge_u32 s52, 8
    s_cselect_b32 s52, s4, s52
    s_sub_u32 s4, s52, 8
    s_cmp_ge_u32 s52, 8
    s_cselect_b32 s52, s4, s52
    s_lshl_b32 s31, s52, 7
    s_add_u32 s31, s31, s53
    s_mul_i32 s32, s52, 524288
    s_add_u32 s32, s32, s54
    s_add_u32 s52, s52, 1
    s_cmp_eq_u32 s52, 8
    s_cselect_b32 s52, 0, s52
    s_add_u32 m0, s45, 0
    s_nop 0
    buffer_load_dwordx4 v32, s[8:11], s31 offen lds
    s_add_u32 m0, s45, 1024
    s_nop 0
    buffer_load_dwordx4 v33, s[8:11], s31 offen lds
    s_add_u32 m0, s45, 2048
    s_nop 0
    buffer_load_dwordx4 v34, s[8:11], s31 offen lds
    s_add_u32 m0, s45, 3072
    s_nop 0
    buffer_load_dwordx4 v35, s[8:11], s31 offen lds
    s_add_u32 m0, s46, 32768
    s_nop 0
    buffer_load_dwordx4 v36, s[12:15], s32 offen lds
    s_add_u32 m0, s46, 33792
    s_nop 0
    buffer_load_dwordx4 v37, s[12:15], s32 offen lds
    s_mov_b32 s30, 3
gloop_4:
    s_waitcnt vmcnt(0)
    s_barrier
    ds_read_b128 v[52:55], v38 offset:0
    ds_read_b128 v[56:59], v38 offset:4096
    ds_read_b64_tr_b16 v[60:61], v46 offset:0
    ds_read_b64_tr_b16 v[62:63], v46 offset:1024
    ds_read_b64_tr_b16 v[64:65], v47 offset:0
    ds_read_b64_tr_b16 v[66:67], v47 offset:1024
    ds_read_b128 v[68:71], v39 offset:0
    ds_read_b128 v[72:75], v39 offset:4096
    ds_read_b64_tr_b16 v[76:77], v46 offset:4096
    ds_read_b64_tr_b16 v[78:79], v46 offset:5120
    ds_read_b64_tr_b16 v[80:81], v47 offset:4096
    ds_read_b64_tr_b16 v[82:83], v47 offset:5120
    s_lshl_b32 s31, s52, 7
    s_add_u32 s31, s31, s53
    s_mul_i32 s32, s52, 524288
    s_add_u32 s32, s32, s54
    s_add_u32 s52, s52, 1
    s_cmp_eq_u32 s52, 8
    s_cselect_b32 s52, 0, s52
    s_add_u32 m0, s45, 49152
    s_nop 0
    buffer_load_dwordx4 v32, s[8:11], s31 offen lds
    s_add_u32 m0, s45, 50176
    s_nop 0
    buffer_load_dwordx4 v33, s[8:11], s31 offen lds
    s_add_u32 m0, s45, 51200
    s_nop 0
    buffer_load_dwordx4 v34, s[8:11], s31 offen lds
    s_add_u32 m0, s45, 52224
    s_nop 0
    buffer_load_dwordx4 v35, s[8:11], s31 offen lds
    s_add_u32 m0, s46, 81920
    s_nop 0
    buffer_load_dwordx4 v36, s[12:15], s32 offen lds
    s_add_u32 m0, s46, 82944
    s_nop 0
    buffer_load_dwordx4 v37, s[12:15], s32 offen lds
    s_waitcnt lgkmcnt(6)
    v_mfma_f32_32x32x16_bf16 v[116:131], v[60:63], v[52:55], v[116:131]
    v_mfma_f32_32x32x16_bf16 v[132:147], v[64:67], v[52:55], v[132:147]
    v_mfma_f32_32x32x16_bf16 v[148:163], v[60:63], v[56:59], v[148:163]
    v_mfma_f32_32x32x16_bf16 v[164:179], v[64:67], v[56:59], v[164:179]
    ds_read_b128 v[84:87], v40 offset:0
    ds_read_b128 v[88:91], v40 offset:4096
    ds_read_b64_tr_b16 v[92:93], v46 offset:8192
    ds_read_b64_tr_b16 v[94:95], v46 offset:9216
    ds_read_b64_tr_b16 v[96:97], v47 offset:8192
    ds_read_b64_tr_b16 v[98:99], v47 offset:9216
    s_waitcnt lgkmcnt(6)
    v_mfma_f32_32x32x16_bf16 v[116:131], v[76:79], v[68:71], v[116:131]
    v_mfma_f32_32x32x16_bf16 v[132:147], v[80:83], v[68:71], v[132:147]
    v_mfma_f32_32x32x16_bf16 v[148:163], v[76:79], v[72:75], v[148:163]
    v_mfma_f32_32x32x16_bf16 v[164:179], v[80:83], v[72:75], v[164:179]
    ds_read_b128 v[100:103], v41 offset:0
    ds_read_b128 v[104:107], v41 offset:4096
    ds_read_b64_tr_b16 v[108:109], v46 offset:12288
    ds_read_b64_tr_b16 v[110:111], v46 offset:13312
    ds_read_b64_tr_b16 v[112:113], v47 offset:12288
    ds_read_b64_tr_b16 v[114:115], v47 offset:13312
    s_waitcnt lgkmcnt(6)
    v_mfma_f32_32x32x16_bf16 v[116:131], v[92:95], v[84:87], v[116:131]
    v_mfma_f32_32x32x16_bf16 v[132:147], v[96:99], v[84:87], v[132:147]
    v_mfma_f32_32x32x16_bf16 v[148:163], v[92:95], v[88:91], v[148:163]
    v_mfma_f32_32x32x16_bf16 v[164:179], v[96:99], v[88:91], v[164:179]
    s_waitcnt lgkmcnt(0)
    v_mfma_f32_32x32x16_bf16 v[116:131], v[108:111], v[100:103], v[116:131]
    v_mfma_f32_32x32x16_bf16 v[132:147], v[112:115], v[100:103], v[132:147]
    v_mfma_f32_32x32x16_bf16 v[148:163], v[108:111], v[104:107], v[148:163]
    v_mfma_f32_32x32x16_bf16 v[164:179], v[112:115], v[104:107], v[164:179]
    s_waitcnt vmcnt(0)
    s_barrier
    ds_read_b128 v[52:55], v38 offset:49152
    ds_read_b128 v[56:59], v38 offset:53248
    ds_read_b64_tr_b16 v[60:61], v46 offset:49152
    ds_read_b64_tr_b16 v[62:63], v46 offset:50176
    ds_read_b64_tr_b16 v[64:65], v47 offset:49152
    ds_read_b64_tr_b16 v[66:67], v47 offset:50176
    ds_read_b128 v[68:71], v39 offset:49152
    ds_read_b128 v[72:75], v39 offset:53248
    ds_read_b64_tr_b16 v[76:77], v46 offset:53248
    ds_read_b64_tr_b16 v[78:79], v46 offset:54272
    ds_read_b64_tr_b16 v[80:81], v47 offset:53248
    ds_read_b64_tr_b16 v[82:83], v47 offset:54272
    s_lshl_b32 s31, s52, 7
    s_add_u32 s31, s31, s53
    s_mul_i32 s32, s52, 524288
    s_add_u32 s32, s32, s54
    s_add_u32 s52, s52, 1
    s_cmp_eq_u32 s52, 8
    s_cselect_b32 s52, 0, s52
    s_add_u32 m0, s45, 0
    s_nop 0
    buffer_load_dwordx4 v32, s[8:11], s31 offen lds
    s_add_u32 m0, s45, 1024
    s_nop 0
    buffer_load_dwordx4 v33, s[8:11], s31 offen lds
    s_add_u32 m0, s45, 2048
    s_nop 0
    buffer_load_dwordx4 v34, s[8:11], s31 offen lds
    s_add_u32 m0, s45, 3072
    s_nop 0
    buffer_load_dwordx4 v35, s[8:11], s31 offen lds
    s_add_u32 m0, s46, 32768
    s_nop 0
    buffer_load_dwordx4 v36, s[12:15], s32 offen lds
    s_add_u32 m0, s46, 33792
    s_nop 0
    buffer_load_dwordx4 v37, s[12:15], s32 offen lds
    s_waitcnt lgkmcnt(6)
    v_mfma_f32_32x32x16_bf16 v[116:131], v[60:63], v[52:55], v[116:131]
    v_mfma_f32_32x32x16_bf16 v[132:147], v[64:67], v[52:55], v[132:147]
    v_mfma_f32_32x32x16_bf16 v[148:163], v[60:63], v[56:59], v[148:163]
    v_mfma_f32_32x32x16_bf16 v[164:179], v[64:67], v[56:59], v[164:179]
    ds_read_b128 v[84:87], v40 offset:49152
    ds_read_b128 v[88:91], v40 offset:53248
    ds_read_b64_tr_b16 v[92:93], v46 offset:57344
    ds_read_b64_tr_b16 v[94:95], v46 offset:58368
    ds_read_b64_tr_b16 v[96:97], v47 offset:57344
    ds_read_b64_tr_b16 v[98:99], v47 offset:58368
    s_waitcnt lgkmcnt(6)
    v_mfma_f32_32x32x16_bf16 v[116:131], v[76:79], v[68:71], v[116:131]
    v_mfma_f32_32x32x16_bf16 v[132:147], v[80:83], v[68:71], v[132:147]
    v_mfma_f32_32x32x16_bf16 v[148:163], v[76:79], v[72:75], v[148:163]
    v_mfma_f32_32x32x16_bf16 v[164:179], v[80:83], v[72:75], v[164:179]
    ds_read_b128 v[100:103], v41 offset:49152
    ds_read_b128 v[104:107], v41 offset:53248
    ds_read_b64_tr_b16 v[108:109], v46 offset:61440
    ds_read_b64_tr_b16 v[110:111], v46 offset:62464
    ds_read_b64_tr_b16 v[112:113], v47 offset:61440
    ds_read_b64_tr_b16 v[114:115], v47 offset:62464
    s_waitcnt lgkmcnt(6)
    v_mfma_f32_32x32x16_bf16 v[116:131], v[92:95], v[84:87], v[116:131]
    v_mfma_f32_32x32x16_bf16 v[132:147], v[96:99], v[84:87], v[132:147]
    v_mfma_f32_32x32x16_bf16 v[148:163], v[92:95], v[88:91], v[148:163]
    v_mfma_f32_32x32x16_bf16 v[164:179], v[96:99], v[88:91], v[164:179]
    s_waitcnt lgkmcnt(0)
    v_mfma_f32_32x32x16_bf16 v[116:131], v[108:111], v[100:103], v[116:131]
    v_mfma_f32_32x32x16_bf16 v[132:147], v[112:115], v[100:103], v[132:147]
    v_mfma_f32_32x32x16_bf16 v[148:163], v[108:111], v[104:107], v[148:163]
    v_mfma_f32_32x32x16_bf16 v[164:179], v[112:115], v[104:107], v[164:179]
    s_sub_u32 s30, s30, 1
    s_cmp_lg_u32 s30, 0
    s_cbranch_scc1 gloop_4
    s_waitcnt vmcnt(0)
    s_barrier
    ds_read_b128 v[52:55], v38 offset:0
    ds_read_b128 v[56:59], v38 offset:4096
    ds_read_b64_tr_b16 v[60:61], v46 offset:0
    ds_read_b64_tr_b16 v[62:63], v46 offset:1024
    ds_read_b64_tr_b16 v[64:65], v47 offset:0
    ds_read_b64_tr_b16 v[66:67], v47 offset:1024
    ds_read_b128 v[68:71], v39 offset:0
    ds_read_b128 v[72:75], v39 offset:4096
    ds_read_b64_tr_b16 v[76:77], v46 offset:4096
    ds_read_b64_tr_b16 v[78:79], v46 offset:5120
    ds_read_b64_tr_b16 v[80:81], v47 offset:4096
    ds_read_b64_tr_b16 v[82:83], v47 offset:5120
    s_lshl_b32 s31, s52, 7
    s_add_u32 s31, s31, s53
    s_mul_i32 s32, s52, 524288
    s_add_u32 s32, s32, s54
    s_add_u32 s52, s52, 1
    s_cmp_eq_u32 s52, 8
    s_cselect_b32 s52, 0, s52
    s_add_u32 m0, s45, 49152
    s_nop 0
    buffer_load_dwordx4 v32, s[8:11], s31 offen lds
    s_add_u32 m0, s45, 50176
    s_nop 0
    buffer_load_dwordx4 v33, s[8:11], s31 offen lds
    s_add_u32 m0, s45, 51200
    s_nop 0
    buffer_load_dwordx4 v34, s[8:11], s31 offen lds
    s_add_u32 m0, s45, 52224
    s_nop 0
    buffer_load_dwordx4 v35, s[8:11], s31 offen lds
    s_add_u32 m0, s46, 81920
    s_nop 0
    buffer_load_dwordx4 v36, s[12:15], s32 offen lds
    s_add_u32 m0, s46, 82944
    s_nop 0
    buffer_load_dwordx4 v37, s[12:15], s32 offen lds
    s_waitcnt lgkmcnt(6)
    v_mfma_f32_32x32x16_bf16 v[116:131], v[60:63], v[52:55], v[116:131]
    v_mfma_f32_32x32x16_bf16 v[132:147], v[64:67], v[52:55], v[132:147]
    v_mfma_f32_32x32x16_bf16 v[148:163], v[60:63], v[56:59], v[148:163]
    v_mfma_f32_32x32x16_bf16 v[164:179], v[64:67], v[56:59], v[164:179]
    ds_read_b128 v[84:87], v40 offset:0
    ds_read_b128 v[88:91], v40 offset:4096
    ds_read_b64_tr_b16 v[92:93], v46 offset:8192
    ds_read_b64_tr_b16 v[94:95], v46 offset:9216
    ds_read_b64_tr_b16 v[96:97], v47 offset:8192
    ds_read_b64_tr_b16 v[98:99], v47 offset:9216
    s_waitcnt lgkmcnt(6)
    v_mfma_f32_32x32x16_bf16 v[116:131], v[76:79], v[68:71], v[116:131]
    v_mfma_f32_32x32x16_bf16 v[132:147], v[80:83], v[68:71], v[132:147]
    v_mfma_f32_32x32x16_bf16 v[148:163], v[76:79], v[72:75], v[148:163]
    v_mfma_f32_32x32x16_bf16 v[164:179], v[80:83], v[72:75], v[164:179]
    ds_read_b128 v[100:103], v41 offset:0
    ds_read_b128 v[104:107], v41 offset:4096
    ds_read_b64_tr_b16 v[108:109], v46 offset:12288
    ds_read_b64_tr_b16 v[110:111], v46 offset:13312
    ds_read_b64_tr_b16 v[112:113], v47 offset:12288
    ds_read_b64_tr_b16 v[114:115], v47 offset:13312
    s_waitcnt lgkmcnt(6)
    v_mfma_f32_32x32x16_bf16 v[116:131], v[92:95], v[84:87], v[116:131]
    v_mfma_f32_32x32x16_bf16 v[132:147], v[96:99], v[84:87], v[132:147]
    v_mfma_f32_32x32x16_bf16 v[148:163], v[92:95], v[88:91], v[148:163]
    v_mfma_f32_32x32x16_bf16 v[164:179], v[96:99], v[88:91], v[164:179]
    s_waitcnt lgkmcnt(0)
    v_mfma_f32_32x32x16_bf16 v[116:131], v[108:111], v[100:103], v[116:131]
    v_mfma_f32_32x32x16_bf16 v[132:147], v[112:115], v[100:103], v[132:147]
    v_mfma_f32_32x32x16_bf16 v[148:163], v[108:111], v[104:107], v[148:163]
    v_mfma_f32_32x32x16_bf16 v[164:179], v[112:115], v[104:107], v[164:179]
    s_waitcnt vmcnt(0)
    s_barrier
    ds_read_b128 v[52:55], v38 offset:49152
    ds_read_b128 v[56:59], v38 offset:53248
    ds_read_b64_tr_b16 v[60:61], v46 offset:49152
    ds_read_b64_tr_b16 v[62:63], v46 offset:50176
    ds_read_b64_tr_b16 v[64:65], v47 offset:49152
    ds_read_b64_tr_b16 v[66:67], v47 offset:50176
    ds_read_b128 v[68:71], v39 offset:49152
    ds_read_b128 v[72:75], v39 offset:53248
    ds_read_b64_tr_b16 v[76:77], v46 offset:53248
    ds_read_b64_tr_b16 v[78:79], v46 offset:54272
    ds_read_b64_tr_b16 v[80:81], v47 offset:53248
    ds_read_b64_tr_b16 v[82:83], v47 offset:54272
    s_waitcnt lgkmcnt(6)
    v_mfma_f32_32x32x16_bf16 v[116:131], v[60:63], v[52:55], v[116:131]
    v_mfma_f32_32x32x16_bf16 v[132:147], v[64:67], v[52:55], v[132:147]
    v_mfma_f32_32x32x16_bf16 v[148:163], v[60:63], v[56:59], v[148:163]
    v_mfma_f32_32x32x16_bf16 v[164:179], v[64:67], v[56:59], v[164:179]
    ds_read_b128 v[84:87], v40 offset:49152
    ds_read_b128 v[88:91], v40 offset:53248
    ds_read_b64_tr_b16 v[92:93], v46 offset:57344
    ds_read_b64_tr_b16 v[94:95], v46 offset:58368
    ds_read_b64_tr_b16 v[96:97], v47 offset:57344
    ds_read_b64_tr_b16 v[98:99], v47 offset:58368
    s_waitcnt lgkmcnt(6)
    v_mfma_f32_32x32x16_bf16 v[116:131], v[76:79], v[68:71], v[116:131]
    v_mfma_f32_32x32x16_bf16 v[132:147], v[80:83], v[68:71], v[132:147]
    v_mfma_f32_32x32x16_bf16 v[148:163], v[76:79], v[72:75], v[148:163]
    v_mfma_f32_32x32x16_bf16 v[164:179], v[80:83], v[72:75], v[164:179]
    ds_read_b128 v[100:103], v41 offset:49152
    ds_read_b128 v[104:107], v41 offset:53248
    ds_read_b64_tr_b16 v[108:109], v46 offset:61440
    ds_read_b64_tr_b16 v[110:111], v46 offset:62464
    ds_read_b64_tr_b16 v[112:113], v47 offset:61440
    ds_read_b64_tr_b16 v[114:115], v47 offset:62464
    s_waitcnt lgkmcnt(6)
    v_mfma_f32_32x32x16_bf16 v[116:131], v[92:95], v[84:87], v[116:131]
    v_mfma_f32_32x32x16_bf16 v[132:147], v[96:99], v[84:87], v[132:147]
    v_mfma_f32_32x32x16_bf16 v[148:163], v[92:95], v[88:91], v[148:163]
    v_mfma_f32_32x32x16_bf16 v[164:179], v[96:99], v[88:91], v[164:179]
    s_waitcnt lgkmcnt(0)
    v_mfma_f32_32x32x16_bf16 v[116:131], v[108:111], v[100:103], v[116:131]
    v_mfma_f32_32x32x16_bf16 v[132:147], v[112:115], v[100:103], v[132:147]
    v_mfma_f32_32x32x16_bf16 v[148:163], v[108:111], v[104:107], v[148:163]
    v_mfma_f32_32x32x16_bf16 v[164:179], v[112:115], v[104:107], v[164:179]
    s_nop 7
    s_nop 7
    s_lshl_b32 s50, s37, 11
    s_add_u32 s50, s50, s33
    s_lshl_b32 s50, s50, 8
    s_barrier
    s_mul_i32 s4, s41, 64
    s_mul_i32 s5, s42, 128
    v_add_u32 v1, s4, v24
    v_lshlrev_b32 v2, 4, v25
    v_add_u32 v2, s5, v2
    v_and_b32 v3, 15, v24
    v_lshlrev_b32 v3, 4, v3
    v_lshlrev_b32 v1, 8, v1

    v_cvt_pk_bf16_f32 v116, v116, v117
    v_cvt_pk_bf16_f32 v117, v118, v119
    v_cvt_pk_bf16_f32 v118, v120, v121
    v_cvt_pk_bf16_f32 v119, v122, v123
    v_cvt_pk_bf16_f32 v120, v124, v125
    v_cvt_pk_bf16_f32 v121, v126, v127
    v_cvt_pk_bf16_f32 v122, v128, v129
    v_cvt_pk_bf16_f32 v123, v130, v131
    v_add_u32 v4, 0, v2
    v_xor_b32 v4, v4, v3
    v_add_u32 v4, v4, v1
    ds_write_b128 v4, v[116:119] offset:0
    v_add_u32 v4, 32, v2
    v_xor_b32 v4, v4, v3
    v_add_u32 v4, v4, v1
    ds_write_b128 v4, v[120:123] offset:0
    v_cvt_pk_bf16_f32 v132, v132, v133
    v_cvt_pk_bf16_f32 v133, v134, v135
    v_cvt_pk_bf16_f32 v134, v136, v137
    v_cvt_pk_bf16_f32 v135, v138, v139
    v_cvt_pk_bf16_f32 v136, v140, v141
    v_cvt_pk_bf16_f32 v137, v142, v143
    v_cvt_pk_bf16_f32 v138, v144, v145
    v_cvt_pk_bf16_f32 v139, v146, v147
    v_add_u32 v4, 64, v2
    v_xor_b32 v4, v4, v3
    v_add_u32 v4, v4, v1
    ds_write_b128 v4, v[132:135] offset:0
    v_add_u32 v4, 96, v2
    v_xor_b32 v4, v4, v3
    v_add_u32 v4, v4, v1
    ds_write_b128 v4, v[136:139] offset:0
    v_cvt_pk_bf16_f32 v148, v148, v149
    v_cvt_pk_bf16_f32 v149, v150, v151
    v_cvt_pk_bf16_f32 v150, v152, v153
    v_cvt_pk_bf16_f32 v151, v154, v155
    v_cvt_pk_bf16_f32 v152, v156, v157
    v_cvt_pk_bf16_f32 v153, v158, v159
    v_cvt_pk_bf16_f32 v154, v160, v161
    v_cvt_pk_bf16_f32 v155, v162, v163
    v_add_u32 v4, 0, v2
    v_xor_b32 v4, v4, v3
    v_add_u32 v4, v4, v1
    ds_write_b128 v4, v[148:151] offset:8192
    v_add_u32 v4, 32, v2
    v_xor_b32 v4, v4, v3
    v_add_u32 v4, v4, v1
    ds_write_b128 v4, v[152:155] offset:8192
    v_cvt_pk_bf16_f32 v164, v164, v165
    v_cvt_pk_bf16_f32 v165, v166, v167
    v_cvt_pk_bf16_f32 v166, v168, v169
    v_cvt_pk_bf16_f32 v167, v170, v171
    v_cvt_pk_bf16_f32 v168, v172, v173
    v_cvt_pk_bf16_f32 v169, v174, v175
    v_cvt_pk_bf16_f32 v170, v176, v177
    v_cvt_pk_bf16_f32 v171, v178, v179
    v_add_u32 v4, 64, v2
    v_xor_b32 v4, v4, v3
    v_add_u32 v4, v4, v1
    ds_write_b128 v4, v[164:167] offset:8192
    v_add_u32 v4, 96, v2
    v_xor_b32 v4, v4, v3
    v_add_u32 v4, v4, v1
    ds_write_b128 v4, v[168:171] offset:8192
    s_waitcnt lgkmcnt(0)
    s_barrier
    v_lshrrev_b32 v1, 4, v0
    v_and_b32 v2, 15, v0
    v_lshlrev_b32 v2, 4, v2
    v_lshrrev_b32 v5, 8, v2
    v_and_b32 v6, 255, v2
    s_mov_b32 s4, 524288
    v_mul_lo_u32 v5, v5, s4
    v_add_u32 v5, v5, v6
    s_mov_b32 s4, 256
    v_mul_lo_u32 v6, v1, s4
    v_add_u32 v5, v5, v6
    v_add_u32 v5, s50, v5
    v_lshlrev_b32 v7, 8, v1

    v_add_u32 v3, 0, v1
    v_and_b32 v3, 15, v3
    v_lshlrev_b32 v3, 4, v3
    v_xor_b32 v3, v3, v2
    v_add_u32 v3, v3, v7
    ds_read_b128 v[116:119], v3 offset:0
    v_add_u32 v3, 32, v1
    v_and_b32 v3, 15, v3
    v_lshlrev_b32 v3, 4, v3
    v_xor_b32 v3, v3, v2
    v_add_u32 v3, v3, v7
    ds_read_b128 v[120:123], v3 offset:8192
    v_add_u32 v3, 64, v1
    v_and_b32 v3, 15, v3
    v_lshlrev_b32 v3, 4, v3
    v_xor_b32 v3, v3, v2
    v_add_u32 v3, v3, v7
    ds_read_b128 v[124:127], v3 offset:16384
    v_add_u32 v3, 96, v1
    v_and_b32 v3, 15, v3
    v_lshlrev_b32 v3, 4, v3
    v_xor_b32 v3, v3, v2
    v_add_u32 v3, v3, v7
    ds_read_b128 v[128:131], v3 offset:24576
    v_add_u32 v3, 128, v1
    v_and_b32 v3, 15, v3
    v_lshlrev_b32 v3, 4, v3
    v_xor_b32 v3, v3, v2
    v_add_u32 v3, v3, v7
    ds_read_b128 v[132:135], v3 offset:32768
    v_add_u32 v3, 160, v1
    v_and_b32 v3, 15, v3
    v_lshlrev_b32 v3, 4, v3
    v_xor_b32 v3, v3, v2
    v_add_u32 v3, v3, v7
    ds_read_b128 v[136:139], v3 offset:40960
    v_add_u32 v3, 192, v1
    v_and_b32 v3, 15, v3
    v_lshlrev_b32 v3, 4, v3
    v_xor_b32 v3, v3, v2
    v_add_u32 v3, v3, v7
    ds_read_b128 v[140:143], v3 offset:49152
    v_add_u32 v3, 224, v1
    v_and_b32 v3, 15, v3
    v_lshlrev_b32 v3, 4, v3
    v_xor_b32 v3, v3, v2
    v_add_u32 v3, v3, v7
    ds_read_b128 v[144:147], v3 offset:57344
    s_waitcnt lgkmcnt(7)
    s_mov_b32 s4, 0
    buffer_store_dwordx4 v[116:119], v5, s[16:19], s4 offen
    s_waitcnt lgkmcnt(6)
    s_mov_b32 s4, 8192
    buffer_store_dwordx4 v[120:123], v5, s[16:19], s4 offen
    s_waitcnt lgkmcnt(5)
    s_mov_b32 s4, 16384
    buffer_store_dwordx4 v[124:127], v5, s[16:19], s4 offen
    s_waitcnt lgkmcnt(4)
    s_mov_b32 s4, 24576
    buffer_store_dwordx4 v[128:131], v5, s[16:19], s4 offen
    s_waitcnt lgkmcnt(3)
    s_mov_b32 s4, 32768
    buffer_store_dwordx4 v[132:135], v5, s[16:19], s4 offen
    s_waitcnt lgkmcnt(2)
    s_mov_b32 s4, 40960
    buffer_store_dwordx4 v[136:139], v5, s[16:19], s4 offen
    s_waitcnt lgkmcnt(1)
    s_mov_b32 s4, 49152
    buffer_store_dwordx4 v[140:143], v5, s[16:19], s4 offen
    s_waitcnt lgkmcnt(0)
    s_mov_b32 s4, 57344
    buffer_store_dwordx4 v[144:147], v5, s[16:19], s4 offen
    s_branch qkv_done
qkv_done:
    s_endpgm
.globl attn_kernel
.p2align 8
.type attn_kernel,@function
attn_kernel:
    s_cmp_ge_u32 s2, 256
    s_cbranch_scc1 attn_done
    s_load_dwordx2 s[8:9], s[0:1], 104
    s_mov_b32 s10, 16777216
    s_mov_b32 s11, 0x00020000
    s_load_dwordx2 s[12:13], s[0:1], 104
    s_mov_b32 s14, 16777216
    s_mov_b32 s15, 0x00020000
    s_load_dwordx2 s[16:17], s[0:1], 104
    s_mov_b32 s18, 16777216
    s_mov_b32 s19, 0x00020000
    s_load_dwordx2 s[20:21], s[0:1], 104
    s_mov_b32 s22, 16777216
    s_mov_b32 s23, 0x00020000
    v_and_b32 v26, 63, v0
    v_and_b32 v24, 31, v0
    v_bfe_u32 v25, v0, 5, 1
    v_lshrrev_b32 v1, 6, v0
    s_nop 0
    v_readfirstlane_b32 s40, v1
    s_nop 3
    s_lshr_b32 s48, s40, 2
    s_and_b32 s40, s40, 3
    s_lshl_b32 s41, s40, 5
    s_lshl_b32 s43, s40, 4
    s_lshl_b32 s49, s48, 16
    s_lshl_b32 s40, s40, 12
    s_add_u32 s40, s40, s49
    s_and_b32 s33, s2, 7
    s_lshl_b32 s33, s33, 2
    s_lshr_b32 s34, s2, 3
    s_and_b32 s4, s34, 3
    s_add_u32 s33, s33, s4
    s_lshr_b32 s34, s34, 2
    s_waitcnt lgkmcnt(0)

    s_add_u32 s8, s8, 33554432
    s_addc_u32 s9, s9, 0
    s_add_u32 s12, s12, 50331648
    s_addc_u32 s13, s13, 0
    s_add_u32 s16, s16, 16777216
    s_addc_u32 s17, s17, 0
    s_add_u32 s20, s20, 67108864
    s_addc_u32 s21, s21, 0
    v_lshrrev_b32 v2, 4, v26
    v_and_b32 v3, 15, v26
    s_lshl_b32 s4, s33, 11
    s_add_u32 s4, s4, s43
    v_add_u32 v1, s4, v2

    v_add_u32 v4, 0, v2
    v_xor_b32 v4, v4, v3
    v_add_u32 v5, 0, v1
    v_lshlrev_b32 v5, 8, v5
    v_lshl_add_u32 v10, v4, 4, v5
    v_add_u32 v4, 4, v2
    v_xor_b32 v4, v4, v3
    v_add_u32 v5, 4, v1
    v_lshlrev_b32 v5, 8, v5
    v_lshl_add_u32 v11, v4, 4, v5
    v_add_u32 v4, 8, v2
    v_xor_b32 v4, v4, v3
    v_add_u32 v5, 8, v1
    v_lshlrev_b32 v5, 8, v5
    v_lshl_add_u32 v12, v4, 4, v5
    v_add_u32 v4, 12, v2
    v_xor_b32 v4, v4, v3
    v_add_u32 v5, 12, v1
    v_lshlrev_b32 v5, 8, v5
    v_lshl_add_u32 v13, v4, 4, v5
    v_lshrrev_b32 v1, 3, v26
    v_and_b32 v3, 7, v26
    s_lshl_b32 s4, s33, 7
    s_add_u32 s4, s4, s41
    v_add_u32 v1, s4, v1

    v_add_u32 v4, 0, v2
    v_and_b32 v4, 7, v4
    v_xor_b32 v4, v4, v3
    v_add_u32 v5, 0, v1
    v_lshlrev_b32 v5, 12, v5
    v_lshl_add_u32 v14, v4, 4, v5
    v_add_u32 v4, 4, v2
    v_and_b32 v4, 7, v4
    v_xor_b32 v4, v4, v3
    v_add_u32 v5, 8, v1
    v_lshlrev_b32 v5, 12, v5
    v_lshl_add_u32 v15, v4, 4, v5
    v_add_u32 v4, 8, v2
    v_and_b32 v4, 7, v4
    v_xor_b32 v4, v4, v3
    v_add_u32 v5, 16, v1
    v_lshlrev_b32 v5, 12, v5
    v_lshl_add_u32 v16, v4, 4, v5
    v_add_u32 v4, 12, v2
    v_and_b32 v4, 7, v4
    v_xor_b32 v4, v4, v3
    v_add_u32 v5, 24, v1
    v_lshlrev_b32 v5, 12, v5
    v_lshl_add_u32 v17, v4, 4, v5
    v_and_b32 v2, 15, v24
    v_lshlrev_b32 v1, 8, v24
    v_add_u32 v1, s49, v1
    v_add_u32 v3, 0, v25
    v_xor_b32 v3, v3, v2
    v_lshl_add_u32 v32, v3, 4, v1
    v_add_u32 v3, 2, v25
    v_xor_b32 v3, v3, v2
    v_lshl_add_u32 v33, v3, 4, v1
    v_add_u32 v3, 4, v25
    v_xor_b32 v3, v3, v2
    v_lshl_add_u32 v34, v3, 4, v1
    v_add_u32 v3, 6, v25
    v_xor_b32 v3, v3, v2
    v_lshl_add_u32 v35, v3, 4, v1
    v_add_u32 v3, 8, v25
    v_xor_b32 v3, v3, v2
    v_lshl_add_u32 v36, v3, 4, v1
    v_add_u32 v3, 10, v25
    v_xor_b32 v3, v3, v2
    v_lshl_add_u32 v37, v3, 4, v1
    v_add_u32 v3, 12, v25
    v_xor_b32 v3, v3, v2
    v_lshl_add_u32 v38, v3, 4, v1
    v_add_u32 v3, 14, v25
    v_xor_b32 v3, v3, v2
    v_lshl_add_u32 v39, v3, 4, v1
    v_bfe_u32 v2, v24, 1, 3
    v_lshlrev_b32 v1, 7, v24
    v_add_u32 v1, 16384, v1
    v_add_u32 v1, s49, v1
    v_add_u32 v3, 0, v25
    v_xor_b32 v3, v3, v2
    v_lshl_add_u32 v18, v3, 4, v1
    v_add_u32 v3, 2, v25
    v_xor_b32 v3, v3, v2
    v_lshl_add_u32 v19, v3, 4, v1
    v_add_u32 v3, 4, v25
    v_xor_b32 v3, v3, v2
    v_lshl_add_u32 v20, v3, 4, v1
    v_add_u32 v3, 6, v25
    v_xor_b32 v3, v3, v2
    v_lshl_add_u32 v21, v3, 4, v1
    v_add_u32 v27, s41, v24
    v_lshlrev_b32 v1, 2, v25
    v_sub_u32 v27, v27, v1
    s_lshl_b32 s4, s48, 6
    v_subrev_u32 v27, s4, v27
    v_mov_b32 v29, 0xf149f2ca
    s_mov_b32 s35, 0

attn_outer:
    s_sub_u32 s4, 15, s34
    s_cmp_eq_u32 s35, 0
    s_cselect_b32 s44, s4, s34
    s_mov_b32 s36, s44
    s_lshl_b32 s4, s33, 11
    s_lshl_b32 s5, s44, 7
    s_add_u32 s4, s4, s5
    s_add_u32 s4, s4, s41
    v_add_u32 v1, s4, v24
    v_lshlrev_b32 v1, 8, v1
    v_lshl_add_u32 v1, v25, 4, v1

    buffer_load_dwordx4 v[40:43], v1, s[16:19], 0 offen offset:0
    buffer_load_dwordx4 v[44:47], v1, s[16:19], 0 offen offset:32
    buffer_load_dwordx4 v[48:51], v1, s[16:19], 0 offen offset:64
    buffer_load_dwordx4 v[52:55], v1, s[16:19], 0 offen offset:96
    buffer_load_dwordx4 v[56:59], v1, s[16:19], 0 offen offset:128
    buffer_load_dwordx4 v[60:63], v1, s[16:19], 0 offen offset:160
    buffer_load_dwordx4 v[64:67], v1, s[16:19], 0 offen offset:192
    buffer_load_dwordx4 v[68:71], v1, s[16:19], 0 offen offset:224
    v_mov_b32 v184, 0
    v_mov_b32 v185, 0
    v_mov_b32 v186, 0
    v_mov_b32 v187, 0
    v_mov_b32 v188, 0
    v_mov_b32 v189, 0
    v_mov_b32 v190, 0
    v_mov_b32 v191, 0
    v_mov_b32 v192, 0
    v_mov_b32 v193, 0
    v_mov_b32 v194, 0
    v_mov_b32 v195, 0
    v_mov_b32 v196, 0
    v_mov_b32 v197, 0
    v_mov_b32 v198, 0
    v_mov_b32 v199, 0
    v_mov_b32 v200, 0
    v_mov_b32 v201, 0
    v_mov_b32 v202, 0
    v_mov_b32 v203, 0
    v_mov_b32 v204, 0
    v_mov_b32 v205, 0
    v_mov_b32 v206, 0
    v_mov_b32 v207, 0
    v_mov_b32 v208, 0
    v_mov_b32 v209, 0
    v_mov_b32 v210, 0
    v_mov_b32 v211, 0
    v_mov_b32 v212, 0
    v_mov_b32 v213, 0
    v_mov_b32 v214, 0
    v_mov_b32 v215, 0
    v_mov_b32 v216, 0
    v_mov_b32 v217, 0
    v_mov_b32 v218, 0
    v_mov_b32 v219, 0
    v_mov_b32 v220, 0
    v_mov_b32 v221, 0
    v_mov_b32 v222, 0
    v_mov_b32 v223, 0
    v_mov_b32 v224, 0
    v_mov_b32 v225, 0
    v_mov_b32 v226, 0
    v_mov_b32 v227, 0
    v_mov_b32 v228, 0
    v_mov_b32 v229, 0
    v_mov_b32 v230, 0
    v_mov_b32 v231, 0
    v_mov_b32 v232, 0
    v_mov_b32 v233, 0
    v_mov_b32 v234, 0
    v_mov_b32 v235, 0
    v_mov_b32 v236, 0
    v_mov_b32 v237, 0
    v_mov_b32 v238, 0
    v_mov_b32 v239, 0
    v_mov_b32 v240, 0
    v_mov_b32 v241, 0
    v_mov_b32 v242, 0
    v_mov_b32 v243, 0
    v_mov_b32 v244, 0
    v_mov_b32 v245, 0
    v_mov_b32 v246, 0
    v_mov_b32 v247, 0
    v_mov_b32 v30, 0xf149f2ca
    v_mov_b32 v31, 0
    s_lshl_b32 s37, s48, 14
    s_lshl_b32 s38, s48, 7
    s_mov_b32 s47, s40

    s_add_u32 m0, s47, 0
    s_nop 0
    buffer_load_dwordx4 v10, s[8:11], s37 offen lds
    s_add_u32 m0, s47, 1024
    s_nop 0
    buffer_load_dwordx4 v11, s[8:11], s37 offen lds
    s_add_u32 m0, s47, 2048
    s_nop 0
    buffer_load_dwordx4 v12, s[8:11], s37 offen lds
    s_add_u32 m0, s47, 3072
    s_nop 0
    buffer_load_dwordx4 v13, s[8:11], s37 offen lds
    s_add_u32 m0, s47, 16384
    s_nop 0
    buffer_load_dwordx4 v14, s[12:15], s38 offen lds
    s_add_u32 m0, s47, 17408
    s_nop 0
    buffer_load_dwordx4 v15, s[12:15], s38 offen lds
    s_add_u32 m0, s47, 18432
    s_nop 0
    buffer_load_dwordx4 v16, s[12:15], s38 offen lds
    s_add_u32 m0, s47, 19456
    s_nop 0
    buffer_load_dwordx4 v17, s[12:15], s38 offen lds
    s_add_u32 s37, s37, 32768
    s_add_u32 s38, s38, 256
    s_xor_b32 s47, s47, 32768
    s_cmp_eq_u32 s36, 0
    s_cbranch_scc1 attn_skip_5
attn_loop_6:
    s_waitcnt vmcnt(0)
    s_barrier
    s_add_u32 m0, s47, 0
    s_nop 0
    buffer_load_dwordx4 v10, s[8:11], s37 offen lds
    s_add_u32 m0, s47, 1024
    s_nop 0
    buffer_load_dwordx4 v11, s[8:11], s37 offen lds
    s_add_u32 m0, s47, 2048
    s_nop 0
    buffer_load_dwordx4 v12, s[8:11], s37 offen lds
    s_add_u32 m0, s47, 3072
    s_nop 0
    buffer_load_dwordx4 v13, s[8:11], s37 offen lds
    s_add_u32 m0, s47, 16384
    s_nop 0
    buffer_load_dwordx4 v14, s[12:15], s38 offen lds
    s_add_u32 m0, s47, 17408
    s_nop 0
    buffer_load_dwordx4 v15, s[12:15], s38 offen lds
    s_add_u32 m0, s47, 18432
    s_nop 0
    buffer_load_dwordx4 v16, s[12:15], s38 offen lds
    s_add_u32 m0, s47, 19456
    s_nop 0
    buffer_load_dwordx4 v17, s[12:15], s38 offen lds
    s_add_u32 s37, s37, 32768
    s_add_u32 s38, s38, 256
    s_xor_b32 s47, s47, 32768
    ds_read_b128 v[120:123], v32 offset:0
    ds_read_b128 v[124:127], v32 offset:8192
    ds_read_b128 v[128:131], v33 offset:0
    ds_read_b128 v[132:135], v33 offset:8192
    ds_read_b128 v[136:139], v34 offset:0
    ds_read_b128 v[140:143], v34 offset:8192
    ds_read_b128 v[144:147], v35 offset:0
    ds_read_b128 v[148:151], v35 offset:8192
    s_waitcnt lgkmcnt(6)
    v_mfma_f32_32x32x16_bf16 v[72:87], v[120:123], v[40:43], 0
    v_mfma_f32_32x32x16_bf16 v[88:103], v[124:127], v[40:43], 0
    s_waitcnt lgkmcnt(4)
    v_mfma_f32_32x32x16_bf16 v[72:87], v[128:131], v[44:47], v[72:87]
    v_mfma_f32_32x32x16_bf16 v[88:103], v[132:135], v[44:47], v[88:103]
    s_waitcnt lgkmcnt(2)
    v_mfma_f32_32x32x16_bf16 v[72:87], v[136:139], v[48:51], v[72:87]
    v_mfma_f32_32x32x16_bf16 v[88:103], v[140:143], v[48:51], v[88:103]
    s_waitcnt lgkmcnt(0)
    v_mfma_f32_32x32x16_bf16 v[72:87], v[144:147], v[52:55], v[72:87]
    v_mfma_f32_32x32x16_bf16 v[88:103], v[148:151], v[52:55], v[88:103]
    ds_read_b128 v[120:123], v36 offset:0
    ds_read_b128 v[124:127], v36 offset:8192
    ds_read_b128 v[128:131], v37 offset:0
    ds_read_b128 v[132:135], v37 offset:8192
    ds_read_b128 v[136:139], v38 offset:0
    ds_read_b128 v[140:143], v38 offset:8192
    ds_read_b128 v[144:147], v39 offset:0
    ds_read_b128 v[148:151], v39 offset:8192
    s_waitcnt lgkmcnt(6)
    v_mfma_f32_32x32x16_bf16 v[72:87], v[120:123], v[56:59], v[72:87]
    v_mfma_f32_32x32x16_bf16 v[88:103], v[124:127], v[56:59], v[88:103]
    s_waitcnt lgkmcnt(4)
    v_mfma_f32_32x32x16_bf16 v[72:87], v[128:131], v[60:63], v[72:87]
    v_mfma_f32_32x32x16_bf16 v[88:103], v[132:135], v[60:63], v[88:103]
    s_waitcnt lgkmcnt(2)
    v_mfma_f32_32x32x16_bf16 v[72:87], v[136:139], v[64:67], v[72:87]
    v_mfma_f32_32x32x16_bf16 v[88:103], v[140:143], v[64:67], v[88:103]
    s_waitcnt lgkmcnt(0)
    v_mfma_f32_32x32x16_bf16 v[72:87], v[144:147], v[68:71], v[72:87]
    v_mfma_f32_32x32x16_bf16 v[88:103], v[148:151], v[68:71], v[88:103]
    ds_read_b128 v[152:155], v18
    ds_read_b128 v[156:159], v19
    ds_read_b128 v[160:163], v20
    ds_read_b128 v[164:167], v21
    s_nop 7
    s_nop 4
    v_max3_f32 v1, v72, v73, v74
    v_max3_f32 v1, v1, v75, v76
    v_max3_f32 v1, v1, v77, v78
    v_max3_f32 v1, v1, v79, v80
    v_max3_f32 v1, v1, v81, v82
    v_max3_f32 v1, v1, v83, v84
    v_max3_f32 v1, v1, v85, v86
    v_max3_f32 v1, v1, v87, v88
    v_max3_f32 v1, v1, v89, v90
    v_max3_f32 v1, v1, v91, v92
    v_max3_f32 v1, v1, v93, v94
    v_max3_f32 v1, v1, v95, v96
    v_max3_f32 v1, v1, v97, v98
    v_max3_f32 v1, v1, v99, v100
    v_max3_f32 v1, v1, v101, v102
    v_max_f32 v1, v1, v103
    v_mov_b32 v2, v1
    s_nop 1
    v_permlane32_swap_b32 v1, v2
    s_nop 1
    v_max_f32 v1, v1, v2
    v_mul_f32 v1, 0x3e0293ee, v1
    v_max_f32 v1, v1, v30
    v_sub_f32 v2, v30, v1
    v_exp_f32 v2, v2
    v_mov_b32 v30, v1
    s_mov_b32 s4, 0x3e0293ee
    v_fma_f32 v72, v72, s4, -v1
    v_fma_f32 v73, v73, s4, -v1
    v_fma_f32 v74, v74, s4, -v1
    v_fma_f32 v75, v75, s4, -v1
    v_fma_f32 v76, v76, s4, -v1
    v_fma_f32 v77, v77, s4, -v1
    v_fma_f32 v78, v78, s4, -v1
    v_fma_f32 v79, v79, s4, -v1
    v_fma_f32 v80, v80, s4, -v1
    v_fma_f32 v81, v81, s4, -v1
    v_fma_f32 v82, v82, s4, -v1
    v_fma_f32 v83, v83, s4, -v1
    v_fma_f32 v84, v84, s4, -v1
    v_fma_f32 v85, v85, s4, -v1
    v_fma_f32 v86, v86, s4, -v1
    v_fma_f32 v87, v87, s4, -v1
    v_fma_f32 v88, v88, s4, -v1
    v_fma_f32 v89, v89, s4, -v1
    v_fma_f32 v90, v90, s4, -v1
    v_fma_f32 v91, v91, s4, -v1
    v_fma_f32 v92, v92, s4, -v1
    v_fma_f32 v93, v93, s4, -v1
    v_fma_f32 v94, v94, s4, -v1
    v_fma_f32 v95, v95, s4, -v1
    v_fma_f32 v96, v96, s4, -v1
    v_fma_f32 v97, v97, s4, -v1
    v_fma_f32 v98, v98, s4, -v1
    v_fma_f32 v99, v99, s4, -v1
    v_fma_f32 v100, v100, s4, -v1
    v_fma_f32 v101, v101, s4, -v1
    v_fma_f32 v102, v102, s4, -v1
    v_fma_f32 v103, v103, s4, -v1
    v_exp_f32 v72, v72
    v_exp_f32 v73, v73
    v_exp_f32 v74, v74
    v_exp_f32 v75, v75
    v_exp_f32 v76, v76
    v_exp_f32 v77, v77
    v_exp_f32 v78, v78
    v_exp_f32 v79, v79
    v_exp_f32 v80, v80
    v_exp_f32 v81, v81
    v_exp_f32 v82, v82
    v_exp_f32 v83, v83
    v_exp_f32 v84, v84
    v_exp_f32 v85, v85
    v_exp_f32 v86, v86
    v_exp_f32 v87, v87
    v_exp_f32 v88, v88
    v_exp_f32 v89, v89
    v_exp_f32 v90, v90
    v_exp_f32 v91, v91
    v_exp_f32 v92, v92
    v_exp_f32 v93, v93
    v_exp_f32 v94, v94
    v_exp_f32 v95, v95
    v_exp_f32 v96, v96
    v_exp_f32 v97, v97
    v_exp_f32 v98, v98
    v_exp_f32 v99, v99
    v_exp_f32 v100, v100
    v_exp_f32 v101, v101
    v_exp_f32 v102, v102
    v_exp_f32 v103, v103
    v_mul_f32 v31, v31, v2
    v_mul_f32 v184, v184, v2
    v_mul_f32 v185, v185, v2
    v_mul_f32 v186, v186, v2
    v_mul_f32 v187, v187, v2
    v_mul_f32 v188, v188, v2
    v_mul_f32 v189, v189, v2
    v_mul_f32 v190, v190, v2
    v_mul_f32 v191, v191, v2
    v_mul_f32 v192, v192, v2
    v_mul_f32 v193, v193, v2
    v_mul_f32 v194, v194, v2
    v_mul_f32 v195, v195, v2
    v_mul_f32 v196, v196, v2
    v_mul_f32 v197, v197, v2
    v_mul_f32 v198, v198, v2
    v_mul_f32 v199, v199, v2
    v_mul_f32 v200, v200, v2
    v_mul_f32 v201, v201, v2
    v_mul_f32 v202, v202, v2
    v_mul_f32 v203, v203, v2
    v_mul_f32 v204, v204, v2
    v_mul_f32 v205, v205, v2
    v_mul_f32 v206, v206, v2
    v_mul_f32 v207, v207, v2
    v_mul_f32 v208, v208, v2
    v_mul_f32 v209, v209, v2
    v_mul_f32 v210, v210, v2
    v_mul_f32 v211, v211, v2
    v_mul_f32 v212, v212, v2
    v_mul_f32 v213, v213, v2
    v_mul_f32 v214, v214, v2
    v_mul_f32 v215, v215, v2
    v_mul_f32 v216, v216, v2
    v_mul_f32 v217, v217, v2
    v_mul_f32 v218, v218, v2
    v_mul_f32 v219, v219, v2
    v_mul_f32 v220, v220, v2
    v_mul_f32 v221, v221, v2
    v_mul_f32 v222, v222, v2
    v_mul_f32 v223, v223, v2
    v_mul_f32 v224, v224, v2
    v_mul_f32 v225, v225, v2
    v_mul_f32 v226, v226, v2
    v_mul_f32 v227, v227, v2
    v_mul_f32 v228, v228, v2
    v_mul_f32 v229, v229, v2
    v_mul_f32 v230, v230, v2
    v_mul_f32 v231, v231, v2
    v_mul_f32 v232, v232, v2
    v_mul_f32 v233, v233, v2
    v_mul_f32 v234, v234, v2
    v_mul_f32 v235, v235, v2
    v_mul_f32 v236, v236, v2
    v_mul_f32 v237, v237, v2
    v_mul_f32 v238, v238, v2
    v_mul_f32 v239, v239, v2
    v_mul_f32 v240, v240, v2
    v_mul_f32 v241, v241, v2
    v_mul_f32 v242, v242, v2
    v_mul_f32 v243, v243, v2
    v_mul_f32 v244, v244, v2
    v_mul_f32 v245, v245, v2
    v_mul_f32 v246, v246, v2
    v_mul_f32 v247, v247, v2
    v_add_f32 v31, v31, v72
    v_add_f32 v31, v31, v73
    v_add_f32 v31, v31, v74
    v_add_f32 v31, v31, v75
    v_add_f32 v31, v31, v76
    v_add_f32 v31, v31, v77
    v_add_f32 v31, v31, v78
    v_add_f32 v31, v31, v79
    v_add_f32 v31, v31, v80
    v_add_f32 v31, v31, v81
    v_add_f32 v31, v31, v82
    v_add_f32 v31, v31, v83
    v_add_f32 v31, v31, v84
    v_add_f32 v31, v31, v85
    v_add_f32 v31, v31, v86
    v_add_f32 v31, v31, v87
    v_add_f32 v31, v31, v88
    v_add_f32 v31, v31, v89
    v_add_f32 v31, v31, v90
    v_add_f32 v31, v31, v91
    v_add_f32 v31, v31, v92
    v_add_f32 v31, v31, v93
    v_add_f32 v31, v31, v94
    v_add_f32 v31, v31, v95
    v_add_f32 v31, v31, v96
    v_add_f32 v31, v31, v97
    v_add_f32 v31, v31, v98
    v_add_f32 v31, v31, v99
    v_add_f32 v31, v31, v100
    v_add_f32 v31, v31, v101
    v_add_f32 v31, v31, v102
    v_add_f32 v31, v31, v103
    v_cvt_pk_bf16_f32 v104, v72, v73
    v_cvt_pk_bf16_f32 v105, v74, v75
    v_cvt_pk_bf16_f32 v106, v76, v77
    v_cvt_pk_bf16_f32 v107, v78, v79
    v_cvt_pk_bf16_f32 v108, v80, v81
    v_cvt_pk_bf16_f32 v109, v82, v83
    v_cvt_pk_bf16_f32 v110, v84, v85
    v_cvt_pk_bf16_f32 v111, v86, v87
    v_cvt_pk_bf16_f32 v112, v88, v89
    v_cvt_pk_bf16_f32 v113, v90, v91
    v_cvt_pk_bf16_f32 v114, v92, v93
    v_cvt_pk_bf16_f32 v115, v94, v95
    v_cvt_pk_bf16_f32 v116, v96, v97
    v_cvt_pk_bf16_f32 v117, v98, v99
    v_cvt_pk_bf16_f32 v118, v100, v101
    v_cvt_pk_bf16_f32 v119, v102, v103
    ds_read_b128 v[168:171], v18 offset:4096
    ds_read_b128 v[172:175], v19 offset:4096
    ds_read_b128 v[176:179], v20 offset:4096
    ds_read_b128 v[180:183], v21 offset:4096
    s_waitcnt lgkmcnt(4)
    v_mfma_f32_32x32x16_bf16 v[184:199], v[152:155], v[104:107], v[184:199]
    v_mfma_f32_32x32x16_bf16 v[184:199], v[156:159], v[108:111], v[184:199]
    v_mfma_f32_32x32x16_bf16 v[184:199], v[160:163], v[112:115], v[184:199]
    v_mfma_f32_32x32x16_bf16 v[184:199], v[164:167], v[116:119], v[184:199]
    ds_read_b128 v[152:155], v18 offset:8192
    ds_read_b128 v[156:159], v19 offset:8192
    ds_read_b128 v[160:163], v20 offset:8192
    ds_read_b128 v[164:167], v21 offset:8192
    s_waitcnt lgkmcnt(4)
    v_mfma_f32_32x32x16_bf16 v[200:215], v[168:171], v[104:107], v[200:215]
    v_mfma_f32_32x32x16_bf16 v[200:215], v[172:175], v[108:111], v[200:215]
    v_mfma_f32_32x32x16_bf16 v[200:215], v[176:179], v[112:115], v[200:215]
    v_mfma_f32_32x32x16_bf16 v[200:215], v[180:183], v[116:119], v[200:215]
    ds_read_b128 v[168:171], v18 offset:12288
    ds_read_b128 v[172:175], v19 offset:12288
    ds_read_b128 v[176:179], v20 offset:12288
    ds_read_b128 v[180:183], v21 offset:12288
    s_waitcnt lgkmcnt(4)
    v_mfma_f32_32x32x16_bf16 v[216:231], v[152:155], v[104:107], v[216:231]
    v_mfma_f32_32x32x16_bf16 v[216:231], v[156:159], v[108:111], v[216:231]
    v_mfma_f32_32x32x16_bf16 v[216:231], v[160:163], v[112:115], v[216:231]
    v_mfma_f32_32x32x16_bf16 v[216:231], v[164:167], v[116:119], v[216:231]
    s_waitcnt lgkmcnt(0)
    v_mfma_f32_32x32x16_bf16 v[232:247], v[168:171], v[104:107], v[232:247]
    v_mfma_f32_32x32x16_bf16 v[232:247], v[172:175], v[108:111], v[232:247]
    v_mfma_f32_32x32x16_bf16 v[232:247], v[176:179], v[112:115], v[232:247]
    v_mfma_f32_32x32x16_bf16 v[232:247], v[180:183], v[116:119], v[232:247]
    v_xor_b32 v32, 32768, v32
    v_xor_b32 v33, 32768, v33
    v_xor_b32 v34, 32768, v34
    v_xor_b32 v35, 32768, v35
    v_xor_b32 v36, 32768, v36
    v_xor_b32 v37, 32768, v37
    v_xor_b32 v38, 32768, v38
    v_xor_b32 v39, 32768, v39
    v_xor_b32 v18, 32768, v18
    v_xor_b32 v19, 32768, v19
    v_xor_b32 v20, 32768, v20
    v_xor_b32 v21, 32768, v21
    s_sub_u32 s36, s36, 1
    s_cmp_lg_u32 s36, 0
    s_cbranch_scc1 attn_loop_6
attn_skip_5:
    s_waitcnt vmcnt(0)
    s_barrier
    ds_read_b128 v[120:123], v32 offset:0
    ds_read_b128 v[124:127], v32 offset:8192
    ds_read_b128 v[128:131], v33 offset:0
    ds_read_b128 v[132:135], v33 offset:8192
    ds_read_b128 v[136:139], v34 offset:0
    ds_read_b128 v[140:143], v34 offset:8192
    ds_read_b128 v[144:147], v35 offset:0
    ds_read_b128 v[148:151], v35 offset:8192
    s_waitcnt lgkmcnt(6)
    v_mfma_f32_32x32x16_bf16 v[72:87], v[120:123], v[40:43], 0
    v_mfma_f32_32x32x16_bf16 v[88:103], v[124:127], v[40:43], 0
    s_waitcnt lgkmcnt(4)
    v_mfma_f32_32x32x16_bf16 v[72:87], v[128:131], v[44:47], v[72:87]
    v_mfma_f32_32x32x16_bf16 v[88:103], v[132:135], v[44:47], v[88:103]
    s_waitcnt lgkmcnt(2)
    v_mfma_f32_32x32x16_bf16 v[72:87], v[136:139], v[48:51], v[72:87]
    v_mfma_f32_32x32x16_bf16 v[88:103], v[140:143], v[48:51], v[88:103]
    s_waitcnt lgkmcnt(0)
    v_mfma_f32_32x32x16_bf16 v[72:87], v[144:147], v[52:55], v[72:87]
    v_mfma_f32_32x32x16_bf16 v[88:103], v[148:151], v[52:55], v[88:103]
    ds_read_b128 v[120:123], v36 offset:0
    ds_read_b128 v[124:127], v36 offset:8192
    ds_read_b128 v[128:131], v37 offset:0
    ds_read_b128 v[132:135], v37 offset:8192
    ds_read_b128 v[136:139], v38 offset:0
    ds_read_b128 v[140:143], v38 offset:8192
    ds_read_b128 v[144:147], v39 offset:0
    ds_read_b128 v[148:151], v39 offset:8192
    s_waitcnt lgkmcnt(6)
    v_mfma_f32_32x32x16_bf16 v[72:87], v[120:123], v[56:59], v[72:87]
    v_mfma_f32_32x32x16_bf16 v[88:103], v[124:127], v[56:59], v[88:103]
    s_waitcnt lgkmcnt(4)
    v_mfma_f32_32x32x16_bf16 v[72:87], v[128:131], v[60:63], v[72:87]
    v_mfma_f32_32x32x16_bf16 v[88:103], v[132:135], v[60:63], v[88:103]
    s_waitcnt lgkmcnt(2)
    v_mfma_f32_32x32x16_bf16 v[72:87], v[136:139], v[64:67], v[72:87]
    v_mfma_f32_32x32x16_bf16 v[88:103], v[140:143], v[64:67], v[88:103]
    s_waitcnt lgkmcnt(0)
    v_mfma_f32_32x32x16_bf16 v[72:87], v[144:147], v[68:71], v[72:87]
    v_mfma_f32_32x32x16_bf16 v[88:103], v[148:151], v[68:71], v[88:103]
    ds_read_b128 v[152:155], v18
    ds_read_b128 v[156:159], v19
    ds_read_b128 v[160:163], v20
    ds_read_b128 v[164:167], v21
    s_nop 7
    s_nop 4
    v_cmp_le_i32 vcc, 0, v27
    s_nop 1
    v_cndmask_b32 v72, v29, v72, vcc
    v_cmp_le_i32 vcc, 1, v27
    s_nop 1
    v_cndmask_b32 v73, v29, v73, vcc
    v_cmp_le_i32 vcc, 2, v27
    s_nop 1
    v_cndmask_b32 v74, v29, v74, vcc
    v_cmp_le_i32 vcc, 3, v27
    s_nop 1
    v_cndmask_b32 v75, v29, v75, vcc
    v_cmp_le_i32 vcc, 8, v27
    s_nop 1
    v_cndmask_b32 v76, v29, v76, vcc
    v_cmp_le_i32 vcc, 9, v27
    s_nop 1
    v_cndmask_b32 v77, v29, v77, vcc
    v_cmp_le_i32 vcc, 10, v27
    s_nop 1
    v_cndmask_b32 v78, v29, v78, vcc
    v_cmp_le_i32 vcc, 11, v27
    s_nop 1
    v_cndmask_b32 v79, v29, v79, vcc
    v_cmp_le_i32 vcc, 16, v27
    s_nop 1
    v_cndmask_b32 v80, v29, v80, vcc
    v_cmp_le_i32 vcc, 17, v27
    s_nop 1
    v_cndmask_b32 v81, v29, v81, vcc
    v_cmp_le_i32 vcc, 18, v27
    s_nop 1
    v_cndmask_b32 v82, v29, v82, vcc
    v_cmp_le_i32 vcc, 19, v27
    s_nop 1
    v_cndmask_b32 v83, v29, v83, vcc
    v_cmp_le_i32 vcc, 24, v27
    s_nop 1
    v_cndmask_b32 v84, v29, v84, vcc
    v_cmp_le_i32 vcc, 25, v27
    s_nop 1
    v_cndmask_b32 v85, v29, v85, vcc
    v_cmp_le_i32 vcc, 26, v27
    s_nop 1
    v_cndmask_b32 v86, v29, v86, vcc
    v_cmp_le_i32 vcc, 27, v27
    s_nop 1
    v_cndmask_b32 v87, v29, v87, vcc
    v_cmp_le_i32 vcc, 32, v27
    s_nop 1
    v_cndmask_b32 v88, v29, v88, vcc
    v_cmp_le_i32 vcc, 33, v27
    s_nop 1
    v_cndmask_b32 v89, v29, v89, vcc
    v_cmp_le_i32 vcc, 34, v27
    s_nop 1
    v_cndmask_b32 v90, v29, v90, vcc
    v_cmp_le_i32 vcc, 35, v27
    s_nop 1
    v_cndmask_b32 v91, v29, v91, vcc
    v_cmp_le_i32 vcc, 40, v27
    s_nop 1
    v_cndmask_b32 v92, v29, v92, vcc
    v_cmp_le_i32 vcc, 41, v27
    s_nop 1
    v_cndmask_b32 v93, v29, v93, vcc
    v_cmp_le_i32 vcc, 42, v27
    s_nop 1
    v_cndmask_b32 v94, v29, v94, vcc
    v_cmp_le_i32 vcc, 43, v27
    s_nop 1
    v_cndmask_b32 v95, v29, v95, vcc
    v_cmp_le_i32 vcc, 48, v27
    s_nop 1
    v_cndmask_b32 v96, v29, v96, vcc
    v_cmp_le_i32 vcc, 49, v27
    s_nop 1
    v_cndmask_b32 v97, v29, v97, vcc
    v_cmp_le_i32 vcc, 50, v27
    s_nop 1
    v_cndmask_b32 v98, v29, v98, vcc
    v_cmp_le_i32 vcc, 51, v27
    s_nop 1
    v_cndmask_b32 v99, v29, v99, vcc
    v_cmp_le_i32 vcc, 56, v27
    s_nop 1
    v_cndmask_b32 v100, v29, v100, vcc
    v_cmp_le_i32 vcc, 57, v27
    s_nop 1
    v_cndmask_b32 v101, v29, v101, vcc
    v_cmp_le_i32 vcc, 58, v27
    s_nop 1
    v_cndmask_b32 v102, v29, v102, vcc
    v_cmp_le_i32 vcc, 59, v27
    s_nop 1
    v_cndmask_b32 v103, v29, v103, vcc
    v_max3_f32 v1, v72, v73, v74
    v_max3_f32 v1, v1, v75, v76
    v_max3_f32 v1, v1, v77, v78
    v_max3_f32 v1, v1, v79, v80
    v_max3_f32 v1, v1, v81, v82
    v_max3_f32 v1, v1, v83, v84
    v_max3_f32 v1, v1, v85, v86
    v_max3_f32 v1, v1, v87, v88
    v_max3_f32 v1, v1, v89, v90
    v_max3_f32 v1, v1, v91, v92
    v_max3_f32 v1, v1, v93, v94
    v_max3_f32 v1, v1, v95, v96
    v_max3_f32 v1, v1, v97, v98
    v_max3_f32 v1, v1, v99, v100
    v_max3_f32 v1, v1, v101, v102
    v_max_f32 v1, v1, v103
    v_mov_b32 v2, v1
    s_nop 1
    v_permlane32_swap_b32 v1, v2
    s_nop 1
    v_max_f32 v1, v1, v2
    v_mul_f32 v1, 0x3e0293ee, v1
    v_max_f32 v1, v1, v30
    v_sub_f32 v2, v30, v1
    v_exp_f32 v2, v2
    v_mov_b32 v30, v1
    s_mov_b32 s4, 0x3e0293ee
    v_fma_f32 v72, v72, s4, -v1
    v_fma_f32 v73, v73, s4, -v1
    v_fma_f32 v74, v74, s4, -v1
    v_fma_f32 v75, v75, s4, -v1
    v_fma_f32 v76, v76, s4, -v1
    v_fma_f32 v77, v77, s4, -v1
    v_fma_f32 v78, v78, s4, -v1
    v_fma_f32 v79, v79, s4, -v1
    v_fma_f32 v80, v80, s4, -v1
    v_fma_f32 v81, v81, s4, -v1
    v_fma_f32 v82, v82, s4, -v1
    v_fma_f32 v83, v83, s4, -v1
    v_fma_f32 v84, v84, s4, -v1
    v_fma_f32 v85, v85, s4, -v1
    v_fma_f32 v86, v86, s4, -v1
    v_fma_f32 v87, v87, s4, -v1
    v_fma_f32 v88, v88, s4, -v1
    v_fma_f32 v89, v89, s4, -v1
    v_fma_f32 v90, v90, s4, -v1
    v_fma_f32 v91, v91, s4, -v1
    v_fma_f32 v92, v92, s4, -v1
    v_fma_f32 v93, v93, s4, -v1
    v_fma_f32 v94, v94, s4, -v1
    v_fma_f32 v95, v95, s4, -v1
    v_fma_f32 v96, v96, s4, -v1
    v_fma_f32 v97, v97, s4, -v1
    v_fma_f32 v98, v98, s4, -v1
    v_fma_f32 v99, v99, s4, -v1
    v_fma_f32 v100, v100, s4, -v1
    v_fma_f32 v101, v101, s4, -v1
    v_fma_f32 v102, v102, s4, -v1
    v_fma_f32 v103, v103, s4, -v1
    v_exp_f32 v72, v72
    v_exp_f32 v73, v73
    v_exp_f32 v74, v74
    v_exp_f32 v75, v75
    v_exp_f32 v76, v76
    v_exp_f32 v77, v77
    v_exp_f32 v78, v78
    v_exp_f32 v79, v79
    v_exp_f32 v80, v80
    v_exp_f32 v81, v81
    v_exp_f32 v82, v82
    v_exp_f32 v83, v83
    v_exp_f32 v84, v84
    v_exp_f32 v85, v85
    v_exp_f32 v86, v86
    v_exp_f32 v87, v87
    v_exp_f32 v88, v88
    v_exp_f32 v89, v89
    v_exp_f32 v90, v90
    v_exp_f32 v91, v91
    v_exp_f32 v92, v92
    v_exp_f32 v93, v93
    v_exp_f32 v94, v94
    v_exp_f32 v95, v95
    v_exp_f32 v96, v96
    v_exp_f32 v97, v97
    v_exp_f32 v98, v98
    v_exp_f32 v99, v99
    v_exp_f32 v100, v100
    v_exp_f32 v101, v101
    v_exp_f32 v102, v102
    v_exp_f32 v103, v103
    v_mul_f32 v31, v31, v2
    v_mul_f32 v184, v184, v2
    v_mul_f32 v185, v185, v2
    v_mul_f32 v186, v186, v2
    v_mul_f32 v187, v187, v2
    v_mul_f32 v188, v188, v2
    v_mul_f32 v189, v189, v2
    v_mul_f32 v190, v190, v2
    v_mul_f32 v191, v191, v2
    v_mul_f32 v192, v192, v2
    v_mul_f32 v193, v193, v2
    v_mul_f32 v194, v194, v2
    v_mul_f32 v195, v195, v2
    v_mul_f32 v196, v196, v2
    v_mul_f32 v197, v197, v2
    v_mul_f32 v198, v198, v2
    v_mul_f32 v199, v199, v2
    v_mul_f32 v200, v200, v2
    v_mul_f32 v201, v201, v2
    v_mul_f32 v202, v202, v2
    v_mul_f32 v203, v203, v2
    v_mul_f32 v204, v204, v2
    v_mul_f32 v205, v205, v2
    v_mul_f32 v206, v206, v2
    v_mul_f32 v207, v207, v2
    v_mul_f32 v208, v208, v2
    v_mul_f32 v209, v209, v2
    v_mul_f32 v210, v210, v2
    v_mul_f32 v211, v211, v2
    v_mul_f32 v212, v212, v2
    v_mul_f32 v213, v213, v2
    v_mul_f32 v214, v214, v2
    v_mul_f32 v215, v215, v2
    v_mul_f32 v216, v216, v2
    v_mul_f32 v217, v217, v2
    v_mul_f32 v218, v218, v2
    v_mul_f32 v219, v219, v2
    v_mul_f32 v220, v220, v2
    v_mul_f32 v221, v221, v2
    v_mul_f32 v222, v222, v2
    v_mul_f32 v223, v223, v2
    v_mul_f32 v224, v224, v2
    v_mul_f32 v225, v225, v2
    v_mul_f32 v226, v226, v2
    v_mul_f32 v227, v227, v2
    v_mul_f32 v228, v228, v2
    v_mul_f32 v229, v229, v2
    v_mul_f32 v230, v230, v2
    v_mul_f32 v231, v231, v2
    v_mul_f32 v232, v232, v2
    v_mul_f32 v233, v233, v2
    v_mul_f32 v234, v234, v2
    v_mul_f32 v235, v235, v2
    v_mul_f32 v236, v236, v2
    v_mul_f32 v237, v237, v2
    v_mul_f32 v238, v238, v2
    v_mul_f32 v239, v239, v2
    v_mul_f32 v240, v240, v2
    v_mul_f32 v241, v241, v2
    v_mul_f32 v242, v242, v2
    v_mul_f32 v243, v243, v2
    v_mul_f32 v244, v244, v2
    v_mul_f32 v245, v245, v2
    v_mul_f32 v246, v246, v2
    v_mul_f32 v247, v247, v2
    v_add_f32 v31, v31, v72
    v_add_f32 v31, v31, v73
    v_add_f32 v31, v31, v74
    v_add_f32 v31, v31, v75
    v_add_f32 v31, v31, v76
    v_add_f32 v31, v31, v77
    v_add_f32 v31, v31, v78
    v_add_f32 v31, v31, v79
    v_add_f32 v31, v31, v80
    v_add_f32 v31, v31, v81
    v_add_f32 v31, v31, v82
    v_add_f32 v31, v31, v83
    v_add_f32 v31, v31, v84
    v_add_f32 v31, v31, v85
    v_add_f32 v31, v31, v86
    v_add_f32 v31, v31, v87
    v_add_f32 v31, v31, v88
    v_add_f32 v31, v31, v89
    v_add_f32 v31, v31, v90
    v_add_f32 v31, v31, v91
    v_add_f32 v31, v31, v92
    v_add_f32 v31, v31, v93
    v_add_f32 v31, v31, v94
    v_add_f32 v31, v31, v95
    v_add_f32 v31, v31, v96
    v_add_f32 v31, v31, v97
    v_add_f32 v31, v31, v98
    v_add_f32 v31, v31, v99
    v_add_f32 v31, v31, v100
    v_add_f32 v31, v31, v101
    v_add_f32 v31, v31, v102
    v_add_f32 v31, v31, v103
    v_cvt_pk_bf16_f32 v104, v72, v73
    v_cvt_pk_bf16_f32 v105, v74, v75
    v_cvt_pk_bf16_f32 v106, v76, v77
    v_cvt_pk_bf16_f32 v107, v78, v79
    v_cvt_pk_bf16_f32 v108, v80, v81
    v_cvt_pk_bf16_f32 v109, v82, v83
    v_cvt_pk_bf16_f32 v110, v84, v85
    v_cvt_pk_bf16_f32 v111, v86, v87
    v_cvt_pk_bf16_f32 v112, v88, v89
    v_cvt_pk_bf16_f32 v113, v90, v91
    v_cvt_pk_bf16_f32 v114, v92, v93
    v_cvt_pk_bf16_f32 v115, v94, v95
    v_cvt_pk_bf16_f32 v116, v96, v97
    v_cvt_pk_bf16_f32 v117, v98, v99
    v_cvt_pk_bf16_f32 v118, v100, v101
    v_cvt_pk_bf16_f32 v119, v102, v103
    ds_read_b128 v[168:171], v18 offset:4096
    ds_read_b128 v[172:175], v19 offset:4096
    ds_read_b128 v[176:179], v20 offset:4096
    ds_read_b128 v[180:183], v21 offset:4096
    s_waitcnt lgkmcnt(4)
    v_mfma_f32_32x32x16_bf16 v[184:199], v[152:155], v[104:107], v[184:199]
    v_mfma_f32_32x32x16_bf16 v[184:199], v[156:159], v[108:111], v[184:199]
    v_mfma_f32_32x32x16_bf16 v[184:199], v[160:163], v[112:115], v[184:199]
    v_mfma_f32_32x32x16_bf16 v[184:199], v[164:167], v[116:119], v[184:199]
    ds_read_b128 v[152:155], v18 offset:8192
    ds_read_b128 v[156:159], v19 offset:8192
    ds_read_b128 v[160:163], v20 offset:8192
    ds_read_b128 v[164:167], v21 offset:8192
    s_waitcnt lgkmcnt(4)
    v_mfma_f32_32x32x16_bf16 v[200:215], v[168:171], v[104:107], v[200:215]
    v_mfma_f32_32x32x16_bf16 v[200:215], v[172:175], v[108:111], v[200:215]
    v_mfma_f32_32x32x16_bf16 v[200:215], v[176:179], v[112:115], v[200:215]
    v_mfma_f32_32x32x16_bf16 v[200:215], v[180:183], v[116:119], v[200:215]
    ds_read_b128 v[168:171], v18 offset:12288
    ds_read_b128 v[172:175], v19 offset:12288
    ds_read_b128 v[176:179], v20 offset:12288
    ds_read_b128 v[180:183], v21 offset:12288
    s_waitcnt lgkmcnt(4)
    v_mfma_f32_32x32x16_bf16 v[216:231], v[152:155], v[104:107], v[216:231]
    v_mfma_f32_32x32x16_bf16 v[216:231], v[156:159], v[108:111], v[216:231]
    v_mfma_f32_32x32x16_bf16 v[216:231], v[160:163], v[112:115], v[216:231]
    v_mfma_f32_32x32x16_bf16 v[216:231], v[164:167], v[116:119], v[216:231]
    s_waitcnt lgkmcnt(0)
    v_mfma_f32_32x32x16_bf16 v[232:247], v[168:171], v[104:107], v[232:247]
    v_mfma_f32_32x32x16_bf16 v[232:247], v[172:175], v[108:111], v[232:247]
    v_mfma_f32_32x32x16_bf16 v[232:247], v[176:179], v[112:115], v[232:247]
    v_mfma_f32_32x32x16_bf16 v[232:247], v[180:183], v[116:119], v[232:247]
    v_xor_b32 v32, 32768, v32
    v_xor_b32 v33, 32768, v33
    v_xor_b32 v34, 32768, v34
    v_xor_b32 v35, 32768, v35
    v_xor_b32 v36, 32768, v36
    v_xor_b32 v37, 32768, v37
    v_xor_b32 v38, 32768, v38
    v_xor_b32 v39, 32768, v39
    v_xor_b32 v18, 32768, v18
    v_xor_b32 v19, 32768, v19
    v_xor_b32 v20, 32768, v20
    v_xor_b32 v21, 32768, v21
    s_and_b32 s4, s44, 1
    s_cmp_eq_u32 s4, 1
    s_cbranch_scc1 attn_fix_7
    v_xor_b32 v32, 32768, v32
    v_xor_b32 v33, 32768, v33
    v_xor_b32 v34, 32768, v34
    v_xor_b32 v35, 32768, v35
    v_xor_b32 v36, 32768, v36
    v_xor_b32 v37, 32768, v37
    v_xor_b32 v38, 32768, v38
    v_xor_b32 v39, 32768, v39
    v_xor_b32 v18, 32768, v18
    v_xor_b32 v19, 32768, v19
    v_xor_b32 v20, 32768, v20
    v_xor_b32 v21, 32768, v21
attn_fix_7:
    s_nop 7
    s_nop 4
    s_barrier
    s_lshr_b32 s4, s41, 5
    s_mul_i32 s4, s4, 17408
    v_lshlrev_b32 v1, 4, v26
    v_add_u32 v1, s4, v1
    s_cmp_eq_u32 s48, 0
    s_cbranch_scc1 attn_g0

    ds_write_b128 v1, v[184:187] offset:0
    ds_write_b128 v1, v[188:191] offset:1024
    ds_write_b128 v1, v[192:195] offset:2048
    ds_write_b128 v1, v[196:199] offset:3072
    ds_write_b128 v1, v[200:203] offset:4096
    ds_write_b128 v1, v[204:207] offset:5120
    ds_write_b128 v1, v[208:211] offset:6144
    ds_write_b128 v1, v[212:215] offset:7168
    ds_write_b128 v1, v[216:219] offset:8192
    ds_write_b128 v1, v[220:223] offset:9216
    ds_write_b128 v1, v[224:227] offset:10240
    ds_write_b128 v1, v[228:231] offset:11264
    ds_write_b128 v1, v[232:235] offset:12288
    ds_write_b128 v1, v[236:239] offset:13312
    ds_write_b128 v1, v[240:243] offset:14336
    ds_write_b128 v1, v[244:247] offset:15360
    ds_write_b64 v1, v[30:31] offset:16384
    s_waitcnt lgkmcnt(0)
    s_barrier
    s_barrier
    s_branch attn_next
attn_g0:
    s_barrier
    ds_read_b128 v[120:123], v1 offset:0
    ds_read_b128 v[124:127], v1 offset:1024
    ds_read_b128 v[128:131], v1 offset:2048
    ds_read_b128 v[132:135], v1 offset:3072
    ds_read_b128 v[136:139], v1 offset:4096
    ds_read_b128 v[140:143], v1 offset:5120
    ds_read_b128 v[144:147], v1 offset:6144
    ds_read_b128 v[148:151], v1 offset:7168
    ds_read_b128 v[152:155], v1 offset:8192
    ds_read_b128 v[156:159], v1 offset:9216
    ds_read_b128 v[160:163], v1 offset:10240
    ds_read_b128 v[164:167], v1 offset:11264
    ds_read_b128 v[168:171], v1 offset:12288
    ds_read_b128 v[172:175], v1 offset:13312
    ds_read_b128 v[176:179], v1 offset:14336
    ds_read_b128 v[180:183], v1 offset:15360
    ds_read_b64 v[2:3], v1 offset:16384
    s_waitcnt lgkmcnt(0)
    s_barrier
    v_max_f32 v4, v30, v2
    v_sub_f32 v5, v30, v4
    v_sub_f32 v6, v2, v4
    v_exp_f32 v5, v5
    v_exp_f32 v6, v6
    s_nop 0
    v_mul_f32 v31, v31, v5
    v_fmac_f32 v31, v3, v6

    v_mul_f32 v184, v184, v5
    v_fmac_f32 v184, v120, v6
    v_mul_f32 v185, v185, v5
    v_fmac_f32 v185, v121, v6
    v_mul_f32 v186, v186, v5
    v_fmac_f32 v186, v122, v6
    v_mul_f32 v187, v187, v5
    v_fmac_f32 v187, v123, v6
    v_mul_f32 v188, v188, v5
    v_fmac_f32 v188, v124, v6
    v_mul_f32 v189, v189, v5
    v_fmac_f32 v189, v125, v6
    v_mul_f32 v190, v190, v5
    v_fmac_f32 v190, v126, v6
    v_mul_f32 v191, v191, v5
    v_fmac_f32 v191, v127, v6
    v_mul_f32 v192, v192, v5
    v_fmac_f32 v192, v128, v6
    v_mul_f32 v193, v193, v5
    v_fmac_f32 v193, v129, v6
    v_mul_f32 v194, v194, v5
    v_fmac_f32 v194, v130, v6
    v_mul_f32 v195, v195, v5
    v_fmac_f32 v195, v131, v6
    v_mul_f32 v196, v196, v5
    v_fmac_f32 v196, v132, v6
    v_mul_f32 v197, v197, v5
    v_fmac_f32 v197, v133, v6
    v_mul_f32 v198, v198, v5
    v_fmac_f32 v198, v134, v6
    v_mul_f32 v199, v199, v5
    v_fmac_f32 v199, v135, v6
    v_mul_f32 v200, v200, v5
    v_fmac_f32 v200, v136, v6
    v_mul_f32 v201, v201, v5
    v_fmac_f32 v201, v137, v6
    v_mul_f32 v202, v202, v5
    v_fmac_f32 v202, v138, v6
    v_mul_f32 v203, v203, v5
    v_fmac_f32 v203, v139, v6
    v_mul_f32 v204, v204, v5
    v_fmac_f32 v204, v140, v6
    v_mul_f32 v205, v205, v5
    v_fmac_f32 v205, v141, v6
    v_mul_f32 v206, v206, v5
    v_fmac_f32 v206, v142, v6
    v_mul_f32 v207, v207, v5
    v_fmac_f32 v207, v143, v6
    v_mul_f32 v208, v208, v5
    v_fmac_f32 v208, v144, v6
    v_mul_f32 v209, v209, v5
    v_fmac_f32 v209, v145, v6
    v_mul_f32 v210, v210, v5
    v_fmac_f32 v210, v146, v6
    v_mul_f32 v211, v211, v5
    v_fmac_f32 v211, v147, v6
    v_mul_f32 v212, v212, v5
    v_fmac_f32 v212, v148, v6
    v_mul_f32 v213, v213, v5
    v_fmac_f32 v213, v149, v6
    v_mul_f32 v214, v214, v5
    v_fmac_f32 v214, v150, v6
    v_mul_f32 v215, v215, v5
    v_fmac_f32 v215, v151, v6
    v_mul_f32 v216, v216, v5
    v_fmac_f32 v216, v152, v6
    v_mul_f32 v217, v217, v5
    v_fmac_f32 v217, v153, v6
    v_mul_f32 v218, v218, v5
    v_fmac_f32 v218, v154, v6
    v_mul_f32 v219, v219, v5
    v_fmac_f32 v219, v155, v6
    v_mul_f32 v220, v220, v5
    v_fmac_f32 v220, v156, v6
    v_mul_f32 v221, v221, v5
    v_fmac_f32 v221, v157, v6
    v_mul_f32 v222, v222, v5
    v_fmac_f32 v222, v158, v6
    v_mul_f32 v223, v223, v5
    v_fmac_f32 v223, v159, v6
    v_mul_f32 v224, v224, v5
    v_fmac_f32 v224, v160, v6
    v_mul_f32 v225, v225, v5
    v_fmac_f32 v225, v161, v6
    v_mul_f32 v226, v226, v5
    v_fmac_f32 v226, v162, v6
    v_mul_f32 v227, v227, v5
    v_fmac_f32 v227, v163, v6
    v_mul_f32 v228, v228, v5
    v_fmac_f32 v228, v164, v6
    v_mul_f32 v229, v229, v5
    v_fmac_f32 v229, v165, v6
    v_mul_f32 v230, v230, v5
    v_fmac_f32 v230, v166, v6
    v_mul_f32 v231, v231, v5
    v_fmac_f32 v231, v167, v6
    v_mul_f32 v232, v232, v5
    v_fmac_f32 v232, v168, v6
    v_mul_f32 v233, v233, v5
    v_fmac_f32 v233, v169, v6
    v_mul_f32 v234, v234, v5
    v_fmac_f32 v234, v170, v6
    v_mul_f32 v235, v235, v5
    v_fmac_f32 v235, v171, v6
    v_mul_f32 v236, v236, v5
    v_fmac_f32 v236, v172, v6
    v_mul_f32 v237, v237, v5
    v_fmac_f32 v237, v173, v6
    v_mul_f32 v238, v238, v5
    v_fmac_f32 v238, v174, v6
    v_mul_f32 v239, v239, v5
    v_fmac_f32 v239, v175, v6
    v_mul_f32 v240, v240, v5
    v_fmac_f32 v240, v176, v6
    v_mul_f32 v241, v241, v5
    v_fmac_f32 v241, v177, v6
    v_mul_f32 v242, v242, v5
    v_fmac_f32 v242, v178, v6
    v_mul_f32 v243, v243, v5
    v_fmac_f32 v243, v179, v6
    v_mul_f32 v244, v244, v5
    v_fmac_f32 v244, v180, v6
    v_mul_f32 v245, v245, v5
    v_fmac_f32 v245, v181, v6
    v_mul_f32 v246, v246, v5
    v_fmac_f32 v246, v182, v6
    v_mul_f32 v247, v247, v5
    v_fmac_f32 v247, v183, v6
    v_mov_b32 v2, v31
    s_nop 1
    v_permlane32_swap_b32 v31, v2
    s_nop 1
    v_add_f32 v31, v31, v2
    v_rcp_f32 v31, v31
    s_nop 0
    s_lshl_b32 s5, s44, 7
    s_add_u32 s5, s5, s41
    v_add_u32 v1, s5, v24
    v_lshlrev_b32 v1, 13, v1
    s_lshl_b32 s4, s33, 8
    v_add_u32 v1, s4, v1
    v_lshl_add_u32 v1, v25, 4, v1

    v_mul_f32 v184, v184, v31
    v_mul_f32 v185, v185, v31
    v_mul_f32 v186, v186, v31
    v_mul_f32 v187, v187, v31
    v_mul_f32 v188, v188, v31
    v_mul_f32 v189, v189, v31
    v_mul_f32 v190, v190, v31
    v_mul_f32 v191, v191, v31
    v_mul_f32 v192, v192, v31
    v_mul_f32 v193, v193, v31
    v_mul_f32 v194, v194, v31
    v_mul_f32 v195, v195, v31
    v_mul_f32 v196, v196, v31
    v_mul_f32 v197, v197, v31
    v_mul_f32 v198, v198, v31
    v_mul_f32 v199, v199, v31
    v_mul_f32 v200, v200, v31
    v_mul_f32 v201, v201, v31
    v_mul_f32 v202, v202, v31
    v_mul_f32 v203, v203, v31
    v_mul_f32 v204, v204, v31
    v_mul_f32 v205, v205, v31
    v_mul_f32 v206, v206, v31
    v_mul_f32 v207, v207, v31
    v_mul_f32 v208, v208, v31
    v_mul_f32 v209, v209, v31
    v_mul_f32 v210, v210, v31
    v_mul_f32 v211, v211, v31
    v_mul_f32 v212, v212, v31
    v_mul_f32 v213, v213, v31
    v_mul_f32 v214, v214, v31
    v_mul_f32 v215, v215, v31
    v_mul_f32 v216, v216, v31
    v_mul_f32 v217, v217, v31
    v_mul_f32 v218, v218, v31
    v_mul_f32 v219, v219, v31
    v_mul_f32 v220, v220, v31
    v_mul_f32 v221, v221, v31
    v_mul_f32 v222, v222, v31
    v_mul_f32 v223, v223, v31
    v_mul_f32 v224, v224, v31
    v_mul_f32 v225, v225, v31
    v_mul_f32 v226, v226, v31
    v_mul_f32 v227, v227, v31
    v_mul_f32 v228, v228, v31
    v_mul_f32 v229, v229, v31
    v_mul_f32 v230, v230, v31
    v_mul_f32 v231, v231, v31
    v_mul_f32 v232, v232, v31
    v_mul_f32 v233, v233, v31
    v_mul_f32 v234, v234, v31
    v_mul_f32 v235, v235, v31
    v_mul_f32 v236, v236, v31
    v_mul_f32 v237, v237, v31
    v_mul_f32 v238, v238, v31
    v_mul_f32 v239, v239, v31
    v_mul_f32 v240, v240, v31
    v_mul_f32 v241, v241, v31
    v_mul_f32 v242, v242, v31
    v_mul_f32 v243, v243, v31
    v_mul_f32 v244, v244, v31
    v_mul_f32 v245, v245, v31
    v_mul_f32 v246, v246, v31
    v_mul_f32 v247, v247, v31
    v_cvt_pk_bf16_f32 v120, v184, v185
    v_cvt_pk_bf16_f32 v121, v186, v187
    v_cvt_pk_bf16_f32 v122, v188, v189
    v_cvt_pk_bf16_f32 v123, v190, v191
    v_cvt_pk_bf16_f32 v124, v192, v193
    v_cvt_pk_bf16_f32 v125, v194, v195
    v_cvt_pk_bf16_f32 v126, v196, v197
    v_cvt_pk_bf16_f32 v127, v198, v199
    v_cvt_pk_bf16_f32 v128, v200, v201
    v_cvt_pk_bf16_f32 v129, v202, v203
    v_cvt_pk_bf16_f32 v130, v204, v205
    v_cvt_pk_bf16_f32 v131, v206, v207
    v_cvt_pk_bf16_f32 v132, v208, v209
    v_cvt_pk_bf16_f32 v133, v210, v211
    v_cvt_pk_bf16_f32 v134, v212, v213
    v_cvt_pk_bf16_f32 v135, v214, v215
    v_cvt_pk_bf16_f32 v136, v216, v217
    v_cvt_pk_bf16_f32 v137, v218, v219
    v_cvt_pk_bf16_f32 v138, v220, v221
    v_cvt_pk_bf16_f32 v139, v222, v223
    v_cvt_pk_bf16_f32 v140, v224, v225
    v_cvt_pk_bf16_f32 v141, v226, v227
    v_cvt_pk_bf16_f32 v142, v228, v229
    v_cvt_pk_bf16_f32 v143, v230, v231
    v_cvt_pk_bf16_f32 v144, v232, v233
    v_cvt_pk_bf16_f32 v145, v234, v235
    v_cvt_pk_bf16_f32 v146, v236, v237
    v_cvt_pk_bf16_f32 v147, v238, v239
    v_cvt_pk_bf16_f32 v148, v240, v241
    v_cvt_pk_bf16_f32 v149, v242, v243
    v_cvt_pk_bf16_f32 v150, v244, v245
    v_cvt_pk_bf16_f32 v151, v246, v247
    buffer_store_dwordx4 v[120:123], v1, s[20:23], 0 offen offset:0
    buffer_store_dwordx4 v[124:127], v1, s[20:23], 0 offen offset:32
    buffer_store_dwordx4 v[128:131], v1, s[20:23], 0 offen offset:64
    buffer_store_dwordx4 v[132:135], v1, s[20:23], 0 offen offset:96
    buffer_store_dwordx4 v[136:139], v1, s[20:23], 0 offen offset:128
    buffer_store_dwordx4 v[140:143], v1, s[20:23], 0 offen offset:160
    buffer_store_dwordx4 v[144:147], v1, s[20:23], 0 offen offset:192
    buffer_store_dwordx4 v[148:151], v1, s[20:23], 0 offen offset:224
attn_next:
    s_add_u32 s35, s35, 1
    s_cmp_lt_u32 s35, 2
    s_cbranch_scc1 attn_outer

attn_done:
    s_endpgm
.globl oproj_kernel
.p2align 8
.type oproj_kernel,@function
oproj_kernel:
    s_cmp_ge_u32 s2, 256
    s_cbranch_scc1 g_done_8
    v_and_b32 v26, 63, v0
    v_and_b32 v24, 31, v0
    v_bfe_u32 v25, v0, 5, 1
    v_lshrrev_b32 v1, 6, v0
    s_nop 0
    v_readfirstlane_b32 s40, v1
    s_nop 3
    s_lshr_b32 s41, s40, 1
    s_and_b32 s42, s40, 1

    s_and_b32 s33, s2, 7
    s_lshl_b32 s33, s33, 1
    s_bfe_u32 s4, s2, 0x10003
    s_add_u32 s33, s33, s4
    s_lshl_b32 s33, s33, 7
    s_bfe_u32 s34, s2, 0x20004
    s_lshl_b32 s34, s34, 7
    s_lshr_b32 s37, s2, 6
    s_lshl_b32 s31, s37, 11
    s_lshl_b32 s32, s37, 20

    s_load_dwordx2 s[8:9], s[0:1], 104
    s_mov_b32 s10, 16777216
    s_mov_b32 s11, 0x00020000
    s_load_dwordx2 s[12:13], s[0:1], 40
    s_mov_b32 s14, 4194304
    s_mov_b32 s15, 0x00020000
    s_load_dwordx2 s[16:17], s[0:1], 104
    s_mov_b32 s18, 16777216
    s_mov_b32 s19, 0x00020000
    s_waitcnt lgkmcnt(0)
    s_add_u32 s8, s8, 67108864
    s_addc_u32 s9, s9, 0
    s_add_u32 s16, s16, 100663296
    s_addc_u32 s17, s17, 0
    v_lshrrev_b32 v1, 3, v26
    v_lshrrev_b32 v2, 4, v26
    v_and_b32 v3, 7, v26
    s_mul_i32 s4, s40, 4
    s_mov_b32 s5, 8192

    s_add_u32 s6, s4, 0
    s_lshl_b32 s7, s6, 2
    v_add_u32 v4, s7, v2
    v_and_b32 v4, 7, v4
    v_xor_b32 v4, v4, v3
    s_lshl_b32 s7, s6, 3
    s_add_u32 s7, s7, s33
    v_add_u32 v5, s7, v1
    v_mul_lo_u32 v5, v5, s5
    v_lshl_add_u32 v32, v4, 4, v5

    s_add_u32 s6, s4, 1
    s_lshl_b32 s7, s6, 2
    v_add_u32 v4, s7, v2
    v_and_b32 v4, 7, v4
    v_xor_b32 v4, v4, v3
    s_lshl_b32 s7, s6, 3
    s_add_u32 s7, s7, s33
    v_add_u32 v5, s7, v1
    v_mul_lo_u32 v5, v5, s5
    v_lshl_add_u32 v33, v4, 4, v5

    s_add_u32 s6, s4, 2
    s_lshl_b32 s7, s6, 2
    v_add_u32 v4, s7, v2
    v_and_b32 v4, 7, v4
    v_xor_b32 v4, v4, v3
    s_lshl_b32 s7, s6, 3
    s_add_u32 s7, s7, s33
    v_add_u32 v5, s7, v1
    v_mul_lo_u32 v5, v5, s5
    v_lshl_add_u32 v34, v4, 4, v5

    s_add_u32 s6, s4, 3
    s_lshl_b32 s7, s6, 2
    v_add_u32 v4, s7, v2
    v_and_b32 v4, 7, v4
    v_xor_b32 v4, v4, v3
    s_lshl_b32 s7, s6, 3
    s_add_u32 s7, s7, s33
    v_add_u32 v5, s7, v1
    v_mul_lo_u32 v5, v5, s5
    v_lshl_add_u32 v35, v4, 4, v5

    s_mul_i32 s4, s40, 4
    s_mov_b32 s5, 1024
    s_lshl_b32 s44, s34, 1
    v_lshlrev_b32 v1, 4, v26

    s_add_u32 s6, s4, 0
    s_lshl_b32 s6, s6, 10
    v_add_u32 v2, s6, v1
    v_lshrrev_b32 v3, 8, v2
    v_and_b32 v4, 255, v2

    v_and_b32 v5, 3, v3
    v_lshlrev_b32 v5, 6, v5
    v_xor_b32 v4, v4, v5
    v_and_b32 v5, 4, v3
    v_and_b32 v6, 8, v3
    v_and_b32 v3, 0xfffffff3, v3
    v_lshl_add_u32 v3, v5, 1, v3
    v_lshrrev_b32 v6, 1, v6
    v_add_u32 v3, v3, v6

    v_mul_lo_u32 v3, v3, s5
    v_add_u32 v3, v3, v4
    v_add_u32 v36, s44, v3
    s_add_u32 s6, s4, 1
    s_lshl_b32 s6, s6, 10
    v_add_u32 v2, s6, v1
    v_lshrrev_b32 v3, 8, v2
    v_and_b32 v4, 255, v2

    v_and_b32 v5, 3, v3
    v_lshlrev_b32 v5, 6, v5
    v_xor_b32 v4, v4, v5
    v_and_b32 v5, 4, v3
    v_and_b32 v6, 8, v3
    v_and_b32 v3, 0xfffffff3, v3
    v_lshl_add_u32 v3, v5, 1, v3
    v_lshrrev_b32 v6, 1, v6
    v_add_u32 v3, v3, v6

    v_mul_lo_u32 v3, v3, s5
    v_add_u32 v3, v3, v4
    v_add_u32 v37, s44, v3
    s_add_u32 s6, s4, 2
    s_lshl_b32 s6, s6, 10
    v_add_u32 v2, s6, v1
    v_lshrrev_b32 v3, 8, v2
    v_and_b32 v4, 255, v2

    v_and_b32 v5, 3, v3
    v_lshlrev_b32 v5, 6, v5
    v_xor_b32 v4, v4, v5
    v_and_b32 v5, 4, v3
    v_and_b32 v6, 8, v3
    v_and_b32 v3, 0xfffffff3, v3
    v_lshl_add_u32 v3, v5, 1, v3
    v_lshrrev_b32 v6, 1, v6
    v_add_u32 v3, v3, v6

    v_mul_lo_u32 v3, v3, s5
    v_add_u32 v3, v3, v4
    v_add_u32 v38, s44, v3
    s_add_u32 s6, s4, 3
    s_lshl_b32 s6, s6, 10
    v_add_u32 v2, s6, v1
    v_lshrrev_b32 v3, 8, v2
    v_and_b32 v4, 255, v2

    v_and_b32 v5, 3, v3
    v_lshlrev_b32 v5, 6, v5
    v_xor_b32 v4, v4, v5
    v_and_b32 v5, 4, v3
    v_and_b32 v6, 8, v3
    v_and_b32 v3, 0xfffffff3, v3
    v_lshl_add_u32 v3, v5, 1, v3
    v_lshrrev_b32 v6, 1, v6
    v_add_u32 v3, v3, v6

    v_mul_lo_u32 v3, v3, s5
    v_add_u32 v3, v3, v4
    v_add_u32 v39, s44, v3
    s_mul_i32 s4, s41, 64
    v_add_u32 v1, s4, v24
    v_bfe_u32 v2, v1, 1, 3
    v_lshlrev_b32 v1, 7, v1

    v_add_u32 v3, 0, v25
    v_xor_b32 v3, v3, v2
    v_lshl_add_u32 v40, v3, 4, v1
    v_add_u32 v3, 2, v25
    v_xor_b32 v3, v3, v2
    v_lshl_add_u32 v41, v3, 4, v1
    v_add_u32 v3, 4, v25
    v_xor_b32 v3, v3, v2
    v_lshl_add_u32 v42, v3, 4, v1
    v_add_u32 v3, 6, v25
    v_xor_b32 v3, v3, v2
    v_lshl_add_u32 v43, v3, 4, v1
    v_bfe_u32 v1, v26, 2, 2
    v_lshrrev_b32 v2, 5, v26
    v_lshlrev_b32 v2, 11, v2
    v_lshl_add_u32 v2, v1, 8, v2
    v_bfe_u32 v3, v26, 4, 1
    v_lshl_add_u32 v2, v3, 5, v2
    v_and_b32 v3, 3, v26
    v_lshl_add_u32 v2, v3, 3, v2
    v_add_u32 v2, 16384, v2
    s_mul_i32 s4, s42, 2

    s_add_u32 s5, s4, 0
    v_xor_b32 v3, s5, v1
    v_lshl_add_u32 v52, v3, 6, v2
    s_add_u32 s5, s4, 1
    v_xor_b32 v3, s5, v1
    v_lshl_add_u32 v53, v3, 6, v2
    v_add_u32 v44, 65536, v40
    v_add_u32 v45, 65536, v41
    v_add_u32 v46, 65536, v42
    v_add_u32 v47, 65536, v43
    v_add_u32 v54, 65536, v52
    v_add_u32 v55, 65536, v53
    v_add_u32 v48, 131072, v40
    v_add_u32 v49, 131072, v41
    v_add_u32 v50, 131072, v42
    v_add_u32 v51, 131072, v43
    v_add_u32 v56, 131072, v52
    v_add_u32 v57, 131072, v53
    v_mov_b32 v124, 0
    v_mov_b32 v125, 0
    v_mov_b32 v126, 0
    v_mov_b32 v127, 0
    v_mov_b32 v128, 0
    v_mov_b32 v129, 0
    v_mov_b32 v130, 0
    v_mov_b32 v131, 0
    v_mov_b32 v132, 0
    v_mov_b32 v133, 0
    v_mov_b32 v134, 0
    v_mov_b32 v135, 0
    v_mov_b32 v136, 0
    v_mov_b32 v137, 0
    v_mov_b32 v138, 0
    v_mov_b32 v139, 0
    v_mov_b32 v140, 0
    v_mov_b32 v141, 0
    v_mov_b32 v142, 0
    v_mov_b32 v143, 0
    v_mov_b32 v144, 0
    v_mov_b32 v145, 0
    v_mov_b32 v146, 0
    v_mov_b32 v147, 0
    v_mov_b32 v148, 0
    v_mov_b32 v149, 0
    v_mov_b32 v150, 0
    v_mov_b32 v151, 0
    v_mov_b32 v152, 0
    v_mov_b32 v153, 0
    v_mov_b32 v154, 0
    v_mov_b32 v155, 0
    v_mov_b32 v156, 0
    v_mov_b32 v157, 0
    v_mov_b32 v158, 0
    v_mov_b32 v159, 0
    v_mov_b32 v160, 0
    v_mov_b32 v161, 0
    v_mov_b32 v162, 0
    v_mov_b32 v163, 0
    v_mov_b32 v164, 0
    v_mov_b32 v165, 0
    v_mov_b32 v166, 0
    v_mov_b32 v167, 0
    v_mov_b32 v168, 0
    v_mov_b32 v169, 0
    v_mov_b32 v170, 0
    v_mov_b32 v171, 0
    v_mov_b32 v172, 0
    v_mov_b32 v173, 0
    v_mov_b32 v174, 0
    v_mov_b32 v175, 0
    v_mov_b32 v176, 0
    v_mov_b32 v177, 0
    v_mov_b32 v178, 0
    v_mov_b32 v179, 0
    v_mov_b32 v180, 0
    v_mov_b32 v181, 0
    v_mov_b32 v182, 0
    v_mov_b32 v183, 0
    v_mov_b32 v184, 0
    v_mov_b32 v185, 0
    v_mov_b32 v186, 0
    v_mov_b32 v187, 0
    s_lshl_b32 s45, s40, 10
    s_mul_i32 s46, s45, 4
    s_mul_i32 s45, s45, 4
    s_mov_b32 s53, s31
    s_mov_b32 s54, s32
    s_lshr_b32 s52, s2, 3
    s_and_b32 s52, s52, 31

    s_sub_u32 s4, s52, 16
    s_cmp_ge_u32 s52, 16
    s_cselect_b32 s52, s4, s52
    s_sub_u32 s4, s52, 16
    s_cmp_ge_u32 s52, 16
    s_cselect_b32 s52, s4, s52
    s_lshl_b32 s31, s52, 7
    s_add_u32 s31, s31, s53
    s_mul_i32 s32, s52, 65536
    s_add_u32 s32, s32, s54
    s_add_u32 s52, s52, 1
    s_cmp_eq_u32 s52, 16
    s_cselect_b32 s52, 0, s52
    s_add_u32 m0, s45, 0
    s_nop 0
    buffer_load_dwordx4 v32, s[8:11], s31 offen lds
    s_add_u32 m0, s45, 1024
    s_nop 0
    buffer_load_dwordx4 v33, s[8:11], s31 offen lds
    s_add_u32 m0, s45, 2048
    s_nop 0
    buffer_load_dwordx4 v34, s[8:11], s31 offen lds
    s_add_u32 m0, s45, 3072
    s_nop 0
    buffer_load_dwordx4 v35, s[8:11], s31 offen lds
    s_add_u32 m0, s46, 16384
    s_nop 0
    buffer_load_dwordx4 v36, s[12:15], s32 offen lds
    s_add_u32 m0, s46, 17408
    s_nop 0
    buffer_load_dwordx4 v37, s[12:15], s32 offen lds
    s_add_u32 m0, s46, 18432
    s_nop 0
    buffer_load_dwordx4 v38, s[12:15], s32 offen lds
    s_add_u32 m0, s46, 19456
    s_nop 0
    buffer_load_dwordx4 v39, s[12:15], s32 offen lds
    s_lshl_b32 s31, s52, 7
    s_add_u32 s31, s31, s53
    s_mul_i32 s32, s52, 65536
    s_add_u32 s32, s32, s54
    s_add_u32 s52, s52, 1
    s_cmp_eq_u32 s52, 16
    s_cselect_b32 s52, 0, s52
    s_add_u32 m0, s45, 32768
    s_nop 0
    buffer_load_dwordx4 v32, s[8:11], s31 offen lds
    s_add_u32 m0, s45, 33792
    s_nop 0
    buffer_load_dwordx4 v33, s[8:11], s31 offen lds
    s_add_u32 m0, s45, 34816
    s_nop 0
    buffer_load_dwordx4 v34, s[8:11], s31 offen lds
    s_add_u32 m0, s45, 35840
    s_nop 0
    buffer_load_dwordx4 v35, s[8:11], s31 offen lds
    s_add_u32 m0, s46, 49152
    s_nop 0
    buffer_load_dwordx4 v36, s[12:15], s32 offen lds
    s_add_u32 m0, s46, 50176
    s_nop 0
    buffer_load_dwordx4 v37, s[12:15], s32 offen lds
    s_add_u32 m0, s46, 51200
    s_nop 0
    buffer_load_dwordx4 v38, s[12:15], s32 offen lds
    s_add_u32 m0, s46, 52224
    s_nop 0
    buffer_load_dwordx4 v39, s[12:15], s32 offen lds
    s_lshl_b32 s31, s52, 7
    s_add_u32 s31, s31, s53
    s_mul_i32 s32, s52, 65536
    s_add_u32 s32, s32, s54
    s_add_u32 s52, s52, 1
    s_cmp_eq_u32 s52, 16
    s_cselect_b32 s52, 0, s52
    s_add_u32 m0, s45, 65536
    s_nop 0
    buffer_load_dwordx4 v32, s[8:11], s31 offen lds
    s_add_u32 m0, s45, 66560
    s_nop 0
    buffer_load_dwordx4 v33, s[8:11], s31 offen lds
    s_add_u32 m0, s45, 67584
    s_nop 0
    buffer_load_dwordx4 v34, s[8:11], s31 offen lds
    s_add_u32 m0, s45, 68608
    s_nop 0
    buffer_load_dwordx4 v35, s[8:11], s31 offen lds
    s_add_u32 m0, s46, 81920
    s_nop 0
    buffer_load_dwordx4 v36, s[12:15], s32 offen lds
    s_add_u32 m0, s46, 82944
    s_nop 0
    buffer_load_dwordx4 v37, s[12:15], s32 offen lds
    s_add_u32 m0, s46, 83968
    s_nop 0
    buffer_load_dwordx4 v38, s[12:15], s32 offen lds
    s_add_u32 m0, s46, 84992
    s_nop 0
    buffer_load_dwordx4 v39, s[12:15], s32 offen lds
    s_lshl_b32 s31, s52, 7
    s_add_u32 s31, s31, s53
    s_mul_i32 s32, s52, 65536
    s_add_u32 s32, s32, s54
    s_add_u32 s52, s52, 1
    s_cmp_eq_u32 s52, 16
    s_cselect_b32 s52, 0, s52
    s_add_u32 m0, s45, 98304
    s_nop 0
    buffer_load_dwordx4 v32, s[8:11], s31 offen lds
    s_add_u32 m0, s45, 99328
    s_nop 0
    buffer_load_dwordx4 v33, s[8:11], s31 offen lds
    s_add_u32 m0, s45, 100352
    s_nop 0
    buffer_load_dwordx4 v34, s[8:11], s31 offen lds
    s_add_u32 m0, s45, 101376
    s_nop 0
    buffer_load_dwordx4 v35, s[8:11], s31 offen lds
    s_add_u32 m0, s46, 114688
    s_nop 0
    buffer_load_dwordx4 v36, s[12:15], s32 offen lds
    s_add_u32 m0, s46, 115712
    s_nop 0
    buffer_load_dwordx4 v37, s[12:15], s32 offen lds
    s_add_u32 m0, s46, 116736
    s_nop 0
    buffer_load_dwordx4 v38, s[12:15], s32 offen lds
    s_add_u32 m0, s46, 117760
    s_nop 0
    buffer_load_dwordx4 v39, s[12:15], s32 offen lds
    s_mov_b32 s30, 2
gloop_9:
    s_waitcnt vmcnt(24)
    s_barrier
    ds_read_b128 v[60:63], v40 offset:0
    ds_read_b128 v[64:67], v40 offset:4096
    ds_read_b64_tr_b16 v[68:69], v52 offset:0
    ds_read_b64_tr_b16 v[70:71], v52 offset:1024
    ds_read_b64_tr_b16 v[72:73], v53 offset:0
    ds_read_b64_tr_b16 v[74:75], v53 offset:1024
    ds_read_b128 v[76:79], v41 offset:0
    ds_read_b128 v[80:83], v41 offset:4096
    ds_read_b64_tr_b16 v[84:85], v52 offset:4096
    ds_read_b64_tr_b16 v[86:87], v52 offset:5120
    ds_read_b64_tr_b16 v[88:89], v53 offset:4096
    ds_read_b64_tr_b16 v[90:91], v53 offset:5120
    s_lshl_b32 s31, s52, 7
    s_add_u32 s31, s31, s53
    s_mul_i32 s32, s52, 65536
    s_add_u32 s32, s32, s54
    s_add_u32 s52, s52, 1
    s_cmp_eq_u32 s52, 16
    s_cselect_b32 s52, 0, s52
    s_add_u32 m0, s45, 131072
    s_nop 0
    buffer_load_dwordx4 v32, s[8:11], s31 offen lds
    s_add_u32 m0, s45, 132096
    s_nop 0
    buffer_load_dwordx4 v33, s[8:11], s31 offen lds
    s_add_u32 m0, s45, 133120
    s_nop 0
    buffer_load_dwordx4 v34, s[8:11], s31 offen lds
    s_add_u32 m0, s45, 134144
    s_nop 0
    buffer_load_dwordx4 v35, s[8:11], s31 offen lds
    s_add_u32 m0, s46, 147456
    s_nop 0
    buffer_load_dwordx4 v36, s[12:15], s32 offen lds
    s_add_u32 m0, s46, 148480
    s_nop 0
    buffer_load_dwordx4 v37, s[12:15], s32 offen lds
    s_add_u32 m0, s46, 149504
    s_nop 0
    buffer_load_dwordx4 v38, s[12:15], s32 offen lds
    s_add_u32 m0, s46, 150528
    s_nop 0
    buffer_load_dwordx4 v39, s[12:15], s32 offen lds
    s_waitcnt lgkmcnt(6)
    v_mfma_f32_32x32x16_bf16 v[124:139], v[68:71], v[60:63], v[124:139]
    v_mfma_f32_32x32x16_bf16 v[140:155], v[72:75], v[60:63], v[140:155]
    v_mfma_f32_32x32x16_bf16 v[156:171], v[68:71], v[64:67], v[156:171]
    v_mfma_f32_32x32x16_bf16 v[172:187], v[72:75], v[64:67], v[172:187]
    ds_read_b128 v[92:95], v42 offset:0
    ds_read_b128 v[96:99], v42 offset:4096
    ds_read_b64_tr_b16 v[100:101], v52 offset:8192
    ds_read_b64_tr_b16 v[102:103], v52 offset:9216
    ds_read_b64_tr_b16 v[104:105], v53 offset:8192
    ds_read_b64_tr_b16 v[106:107], v53 offset:9216
    s_waitcnt lgkmcnt(6)
    v_mfma_f32_32x32x16_bf16 v[124:139], v[84:87], v[76:79], v[124:139]
    v_mfma_f32_32x32x16_bf16 v[140:155], v[88:91], v[76:79], v[140:155]
    v_mfma_f32_32x32x16_bf16 v[156:171], v[84:87], v[80:83], v[156:171]
    v_mfma_f32_32x32x16_bf16 v[172:187], v[88:91], v[80:83], v[172:187]
    ds_read_b128 v[108:111], v43 offset:0
    ds_read_b128 v[112:115], v43 offset:4096
    ds_read_b64_tr_b16 v[116:117], v52 offset:12288
    ds_read_b64_tr_b16 v[118:119], v52 offset:13312
    ds_read_b64_tr_b16 v[120:121], v53 offset:12288
    ds_read_b64_tr_b16 v[122:123], v53 offset:13312
    s_waitcnt lgkmcnt(6)
    v_mfma_f32_32x32x16_bf16 v[124:139], v[100:103], v[92:95], v[124:139]
    v_mfma_f32_32x32x16_bf16 v[140:155], v[104:107], v[92:95], v[140:155]
    v_mfma_f32_32x32x16_bf16 v[156:171], v[100:103], v[96:99], v[156:171]
    v_mfma_f32_32x32x16_bf16 v[172:187], v[104:107], v[96:99], v[172:187]
    s_waitcnt lgkmcnt(0)
    v_mfma_f32_32x32x16_bf16 v[124:139], v[116:119], v[108:111], v[124:139]
    v_mfma_f32_32x32x16_bf16 v[140:155], v[120:123], v[108:111], v[140:155]
    v_mfma_f32_32x32x16_bf16 v[156:171], v[116:119], v[112:115], v[156:171]
    v_mfma_f32_32x32x16_bf16 v[172:187], v[120:123], v[112:115], v[172:187]
    s_waitcnt vmcnt(24)
    s_barrier
    ds_read_b128 v[60:63], v40 offset:32768
    ds_read_b128 v[64:67], v40 offset:36864
    ds_read_b64_tr_b16 v[68:69], v52 offset:32768
    ds_read_b64_tr_b16 v[70:71], v52 offset:33792
    ds_read_b64_tr_b16 v[72:73], v53 offset:32768
    ds_read_b64_tr_b16 v[74:75], v53 offset:33792
    ds_read_b128 v[76:79], v41 offset:32768
    ds_read_b128 v[80:83], v41 offset:36864
    ds_read_b64_tr_b16 v[84:85], v52 offset:36864
    ds_read_b64_tr_b16 v[86:87], v52 offset:37888
    ds_read_b64_tr_b16 v[88:89], v53 offset:36864
    ds_read_b64_tr_b16 v[90:91], v53 offset:37888
    s_lshl_b32 s31, s52, 7
    s_add_u32 s31, s31, s53
    s_mul_i32 s32, s52, 65536
    s_add_u32 s32, s32, s54
    s_add_u32 s52, s52, 1
    s_cmp_eq_u32 s52, 16
    s_cselect_b32 s52, 0, s52
    s_add_u32 m0, s45, 0
    s_nop 0
    buffer_load_dwordx4 v32, s[8:11], s31 offen lds
    s_add_u32 m0, s45, 1024
    s_nop 0
    buffer_load_dwordx4 v33, s[8:11], s31 offen lds
    s_add_u32 m0, s45, 2048
    s_nop 0
    buffer_load_dwordx4 v34, s[8:11], s31 offen lds
    s_add_u32 m0, s45, 3072
    s_nop 0
    buffer_load_dwordx4 v35, s[8:11], s31 offen lds
    s_add_u32 m0, s46, 16384
    s_nop 0
    buffer_load_dwordx4 v36, s[12:15], s32 offen lds
    s_add_u32 m0, s46, 17408
    s_nop 0
    buffer_load_dwordx4 v37, s[12:15], s32 offen lds
    s_add_u32 m0, s46, 18432
    s_nop 0
    buffer_load_dwordx4 v38, s[12:15], s32 offen lds
    s_add_u32 m0, s46, 19456
    s_nop 0
    buffer_load_dwordx4 v39, s[12:15], s32 offen lds
    s_waitcnt lgkmcnt(6)
    v_mfma_f32_32x32x16_bf16 v[124:139], v[68:71], v[60:63], v[124:139]
    v_mfma_f32_32x32x16_bf16 v[140:155], v[72:75], v[60:63], v[140:155]
    v_mfma_f32_32x32x16_bf16 v[156:171], v[68:71], v[64:67], v[156:171]
    v_mfma_f32_32x32x16_bf16 v[172:187], v[72:75], v[64:67], v[172:187]
    ds_read_b128 v[92:95], v42 offset:32768
    ds_read_b128 v[96:99], v42 offset:36864
    ds_read_b64_tr_b16 v[100:101], v52 offset:40960
    ds_read_b64_tr_b16 v[102:103], v52 offset:41984
    ds_read_b64_tr_b16 v[104:105], v53 offset:40960
    ds_read_b64_tr_b16 v[106:107], v53 offset:41984
    s_waitcnt lgkmcnt(6)
    v_mfma_f32_32x32x16_bf16 v[124:139], v[84:87], v[76:79], v[124:139]
    v_mfma_f32_32x32x16_bf16 v[140:155], v[88:91], v[76:79], v[140:155]
    v_mfma_f32_32x32x16_bf16 v[156:171], v[84:87], v[80:83], v[156:171]
    v_mfma_f32_32x32x16_bf16 v[172:187], v[88:91], v[80:83], v[172:187]
    ds_read_b128 v[108:111], v43 offset:32768
    ds_read_b128 v[112:115], v43 offset:36864
    ds_read_b64_tr_b16 v[116:117], v52 offset:45056
    ds_read_b64_tr_b16 v[118:119], v52 offset:46080
    ds_read_b64_tr_b16 v[120:121], v53 offset:45056
    ds_read_b64_tr_b16 v[122:123], v53 offset:46080
    s_waitcnt lgkmcnt(6)
    v_mfma_f32_32x32x16_bf16 v[124:139], v[100:103], v[92:95], v[124:139]
    v_mfma_f32_32x32x16_bf16 v[140:155], v[104:107], v[92:95], v[140:155]
    v_mfma_f32_32x32x16_bf16 v[156:171], v[100:103], v[96:99], v[156:171]
    v_mfma_f32_32x32x16_bf16 v[172:187], v[104:107], v[96:99], v[172:187]
    s_waitcnt lgkmcnt(0)
    v_mfma_f32_32x32x16_bf16 v[124:139], v[116:119], v[108:111], v[124:139]
    v_mfma_f32_32x32x16_bf16 v[140:155], v[120:123], v[108:111], v[140:155]
    v_mfma_f32_32x32x16_bf16 v[156:171], v[116:119], v[112:115], v[156:171]
    v_mfma_f32_32x32x16_bf16 v[172:187], v[120:123], v[112:115], v[172:187]
    s_waitcnt vmcnt(24)
    s_barrier
    ds_read_b128 v[60:63], v44 offset:0
    ds_read_b128 v[64:67], v44 offset:4096
    ds_read_b64_tr_b16 v[68:69], v54 offset:0
    ds_read_b64_tr_b16 v[70:71], v54 offset:1024
    ds_read_b64_tr_b16 v[72:73], v55 offset:0
    ds_read_b64_tr_b16 v[74:75], v55 offset:1024
    ds_read_b128 v[76:79], v45 offset:0
    ds_read_b128 v[80:83], v45 offset:4096
    ds_read_b64_tr_b16 v[84:85], v54 offset:4096
    ds_read_b64_tr_b16 v[86:87], v54 offset:5120
    ds_read_b64_tr_b16 v[88:89], v55 offset:4096
    ds_read_b64_tr_b16 v[90:91], v55 offset:5120
    s_lshl_b32 s31, s52, 7
    s_add_u32 s31, s31, s53
    s_mul_i32 s32, s52, 65536
    s_add_u32 s32, s32, s54
    s_add_u32 s52, s52, 1
    s_cmp_eq_u32 s52, 16
    s_cselect_b32 s52, 0, s52
    s_add_u32 m0, s45, 32768
    s_nop 0
    buffer_load_dwordx4 v32, s[8:11], s31 offen lds
    s_add_u32 m0, s45, 33792
    s_nop 0
    buffer_load_dwordx4 v33, s[8:11], s31 offen lds
    s_add_u32 m0, s45, 34816
    s_nop 0
    buffer_load_dwordx4 v34, s[8:11], s31 offen lds
    s_add_u32 m0, s45, 35840
    s_nop 0
    buffer_load_dwordx4 v35, s[8:11], s31 offen lds
    s_add_u32 m0, s46, 49152
    s_nop 0
    buffer_load_dwordx4 v36, s[12:15], s32 offen lds
    s_add_u32 m0, s46, 50176
    s_nop 0
    buffer_load_dwordx4 v37, s[12:15], s32 offen lds
    s_add_u32 m0, s46, 51200
    s_nop 0
    buffer_load_dwordx4 v38, s[12:15], s32 offen lds
    s_add_u32 m0, s46, 52224
    s_nop 0
    buffer_load_dwordx4 v39, s[12:15], s32 offen lds
    s_waitcnt lgkmcnt(6)
    v_mfma_f32_32x32x16_bf16 v[124:139], v[68:71], v[60:63], v[124:139]
    v_mfma_f32_32x32x16_bf16 v[140:155], v[72:75], v[60:63], v[140:155]
    v_mfma_f32_32x32x16_bf16 v[156:171], v[68:71], v[64:67], v[156:171]
    v_mfma_f32_32x32x16_bf16 v[172:187], v[72:75], v[64:67], v[172:187]
    ds_read_b128 v[92:95], v46 offset:0
    ds_read_b128 v[96:99], v46 offset:4096
    ds_read_b64_tr_b16 v[100:101], v54 offset:8192
    ds_read_b64_tr_b16 v[102:103], v54 offset:9216
    ds_read_b64_tr_b16 v[104:105], v55 offset:8192
    ds_read_b64_tr_b16 v[106:107], v55 offset:9216
    s_waitcnt lgkmcnt(6)
    v_mfma_f32_32x32x16_bf16 v[124:139], v[84:87], v[76:79], v[124:139]
    v_mfma_f32_32x32x16_bf16 v[140:155], v[88:91], v[76:79], v[140:155]
    v_mfma_f32_32x32x16_bf16 v[156:171], v[84:87], v[80:83], v[156:171]
    v_mfma_f32_32x32x16_bf16 v[172:187], v[88:91], v[80:83], v[172:187]
    ds_read_b128 v[108:111], v47 offset:0
    ds_read_b128 v[112:115], v47 offset:4096
    ds_read_b64_tr_b16 v[116:117], v54 offset:12288
    ds_read_b64_tr_b16 v[118:119], v54 offset:13312
    ds_read_b64_tr_b16 v[120:121], v55 offset:12288
    ds_read_b64_tr_b16 v[122:123], v55 offset:13312
    s_waitcnt lgkmcnt(6)
    v_mfma_f32_32x32x16_bf16 v[124:139], v[100:103], v[92:95], v[124:139]
    v_mfma_f32_32x32x16_bf16 v[140:155], v[104:107], v[92:95], v[140:155]
    v_mfma_f32_32x32x16_bf16 v[156:171], v[100:103], v[96:99], v[156:171]
    v_mfma_f32_32x32x16_bf16 v[172:187], v[104:107], v[96:99], v[172:187]
    s_waitcnt lgkmcnt(0)
    v_mfma_f32_32x32x16_bf16 v[124:139], v[116:119], v[108:111], v[124:139]
    v_mfma_f32_32x32x16_bf16 v[140:155], v[120:123], v[108:111], v[140:155]
    v_mfma_f32_32x32x16_bf16 v[156:171], v[116:119], v[112:115], v[156:171]
    v_mfma_f32_32x32x16_bf16 v[172:187], v[120:123], v[112:115], v[172:187]
    s_waitcnt vmcnt(24)
    s_barrier
    ds_read_b128 v[60:63], v44 offset:32768
    ds_read_b128 v[64:67], v44 offset:36864
    ds_read_b64_tr_b16 v[68:69], v54 offset:32768
    ds_read_b64_tr_b16 v[70:71], v54 offset:33792
    ds_read_b64_tr_b16 v[72:73], v55 offset:32768
    ds_read_b64_tr_b16 v[74:75], v55 offset:33792
    ds_read_b128 v[76:79], v45 offset:32768
    ds_read_b128 v[80:83], v45 offset:36864
    ds_read_b64_tr_b16 v[84:85], v54 offset:36864
    ds_read_b64_tr_b16 v[86:87], v54 offset:37888
    ds_read_b64_tr_b16 v[88:89], v55 offset:36864
    ds_read_b64_tr_b16 v[90:91], v55 offset:37888
    s_lshl_b32 s31, s52, 7
    s_add_u32 s31, s31, s53
    s_mul_i32 s32, s52, 65536
    s_add_u32 s32, s32, s54
    s_add_u32 s52, s52, 1
    s_cmp_eq_u32 s52, 16
    s_cselect_b32 s52, 0, s52
    s_add_u32 m0, s45, 65536
    s_nop 0
    buffer_load_dwordx4 v32, s[8:11], s31 offen lds
    s_add_u32 m0, s45, 66560
    s_nop 0
    buffer_load_dwordx4 v33, s[8:11], s31 offen lds
    s_add_u32 m0, s45, 67584
    s_nop 0
    buffer_load_dwordx4 v34, s[8:11], s31 offen lds
    s_add_u32 m0, s45, 68608
    s_nop 0
    buffer_load_dwordx4 v35, s[8:11], s31 offen lds
    s_add_u32 m0, s46, 81920
    s_nop 0
    buffer_load_dwordx4 v36, s[12:15], s32 offen lds
    s_add_u32 m0, s46, 82944
    s_nop 0
    buffer_load_dwordx4 v37, s[12:15], s32 offen lds
    s_add_u32 m0, s46, 83968
    s_nop 0
    buffer_load_dwordx4 v38, s[12:15], s32 offen lds
    s_add_u32 m0, s46, 84992
    s_nop 0
    buffer_load_dwordx4 v39, s[12:15], s32 offen lds
    s_waitcnt lgkmcnt(6)
    v_mfma_f32_32x32x16_bf16 v[124:139], v[68:71], v[60:63], v[124:139]
    v_mfma_f32_32x32x16_bf16 v[140:155], v[72:75], v[60:63], v[140:155]
    v_mfma_f32_32x32x16_bf16 v[156:171], v[68:71], v[64:67], v[156:171]
    v_mfma_f32_32x32x16_bf16 v[172:187], v[72:75], v[64:67], v[172:187]
    ds_read_b128 v[92:95], v46 offset:32768
    ds_read_b128 v[96:99], v46 offset:36864
    ds_read_b64_tr_b16 v[100:101], v54 offset:40960
    ds_read_b64_tr_b16 v[102:103], v54 offset:41984
    ds_read_b64_tr_b16 v[104:105], v55 offset:40960
    ds_read_b64_tr_b16 v[106:107], v55 offset:41984
    s_waitcnt lgkmcnt(6)
    v_mfma_f32_32x32x16_bf16 v[124:139], v[84:87], v[76:79], v[124:139]
    v_mfma_f32_32x32x16_bf16 v[140:155], v[88:91], v[76:79], v[140:155]
    v_mfma_f32_32x32x16_bf16 v[156:171], v[84:87], v[80:83], v[156:171]
    v_mfma_f32_32x32x16_bf16 v[172:187], v[88:91], v[80:83], v[172:187]
    ds_read_b128 v[108:111], v47 offset:32768
    ds_read_b128 v[112:115], v47 offset:36864
    ds_read_b64_tr_b16 v[116:117], v54 offset:45056
    ds_read_b64_tr_b16 v[118:119], v54 offset:46080
    ds_read_b64_tr_b16 v[120:121], v55 offset:45056
    ds_read_b64_tr_b16 v[122:123], v55 offset:46080
    s_waitcnt lgkmcnt(6)
    v_mfma_f32_32x32x16_bf16 v[124:139], v[100:103], v[92:95], v[124:139]
    v_mfma_f32_32x32x16_bf16 v[140:155], v[104:107], v[92:95], v[140:155]
    v_mfma_f32_32x32x16_bf16 v[156:171], v[100:103], v[96:99], v[156:171]
    v_mfma_f32_32x32x16_bf16 v[172:187], v[104:107], v[96:99], v[172:187]
    s_waitcnt lgkmcnt(0)
    v_mfma_f32_32x32x16_bf16 v[124:139], v[116:119], v[108:111], v[124:139]
    v_mfma_f32_32x32x16_bf16 v[140:155], v[120:123], v[108:111], v[140:155]
    v_mfma_f32_32x32x16_bf16 v[156:171], v[116:119], v[112:115], v[156:171]
    v_mfma_f32_32x32x16_bf16 v[172:187], v[120:123], v[112:115], v[172:187]
    s_waitcnt vmcnt(24)
    s_barrier
    ds_read_b128 v[60:63], v48 offset:0
    ds_read_b128 v[64:67], v48 offset:4096
    ds_read_b64_tr_b16 v[68:69], v56 offset:0
    ds_read_b64_tr_b16 v[70:71], v56 offset:1024
    ds_read_b64_tr_b16 v[72:73], v57 offset:0
    ds_read_b64_tr_b16 v[74:75], v57 offset:1024
    ds_read_b128 v[76:79], v49 offset:0
    ds_read_b128 v[80:83], v49 offset:4096
    ds_read_b64_tr_b16 v[84:85], v56 offset:4096
    ds_read_b64_tr_b16 v[86:87], v56 offset:5120
    ds_read_b64_tr_b16 v[88:89], v57 offset:4096
    ds_read_b64_tr_b16 v[90:91], v57 offset:5120
    s_lshl_b32 s31, s52, 7
    s_add_u32 s31, s31, s53
    s_mul_i32 s32, s52, 65536
    s_add_u32 s32, s32, s54
    s_add_u32 s52, s52, 1
    s_cmp_eq_u32 s52, 16
    s_cselect_b32 s52, 0, s52
    s_add_u32 m0, s45, 98304
    s_nop 0
    buffer_load_dwordx4 v32, s[8:11], s31 offen lds
    s_add_u32 m0, s45, 99328
    s_nop 0
    buffer_load_dwordx4 v33, s[8:11], s31 offen lds
    s_add_u32 m0, s45, 100352
    s_nop 0
    buffer_load_dwordx4 v34, s[8:11], s31 offen lds
    s_add_u32 m0, s45, 101376
    s_nop 0
    buffer_load_dwordx4 v35, s[8:11], s31 offen lds
    s_add_u32 m0, s46, 114688
    s_nop 0
    buffer_load_dwordx4 v36, s[12:15], s32 offen lds
    s_add_u32 m0, s46, 115712
    s_nop 0
    buffer_load_dwordx4 v37, s[12:15], s32 offen lds
    s_add_u32 m0, s46, 116736
    s_nop 0
    buffer_load_dwordx4 v38, s[12:15], s32 offen lds
    s_add_u32 m0, s46, 117760
    s_nop 0
    buffer_load_dwordx4 v39, s[12:15], s32 offen lds
    s_waitcnt lgkmcnt(6)
    v_mfma_f32_32x32x16_bf16 v[124:139], v[68:71], v[60:63], v[124:139]
    v_mfma_f32_32x32x16_bf16 v[140:155], v[72:75], v[60:63], v[140:155]
    v_mfma_f32_32x32x16_bf16 v[156:171], v[68:71], v[64:67], v[156:171]
    v_mfma_f32_32x32x16_bf16 v[172:187], v[72:75], v[64:67], v[172:187]
    ds_read_b128 v[92:95], v50 offset:0
    ds_read_b128 v[96:99], v50 offset:4096
    ds_read_b64_tr_b16 v[100:101], v56 offset:8192
    ds_read_b64_tr_b16 v[102:103], v56 offset:9216
    ds_read_b64_tr_b16 v[104:105], v57 offset:8192
    ds_read_b64_tr_b16 v[106:107], v57 offset:9216
    s_waitcnt lgkmcnt(6)
    v_mfma_f32_32x32x16_bf16 v[124:139], v[84:87], v[76:79], v[124:139]
    v_mfma_f32_32x32x16_bf16 v[140:155], v[88:91], v[76:79], v[140:155]
    v_mfma_f32_32x32x16_bf16 v[156:171], v[84:87], v[80:83], v[156:171]
    v_mfma_f32_32x32x16_bf16 v[172:187], v[88:91], v[80:83], v[172:187]
    ds_read_b128 v[108:111], v51 offset:0
    ds_read_b128 v[112:115], v51 offset:4096
    ds_read_b64_tr_b16 v[116:117], v56 offset:12288
    ds_read_b64_tr_b16 v[118:119], v56 offset:13312
    ds_read_b64_tr_b16 v[120:121], v57 offset:12288
    ds_read_b64_tr_b16 v[122:123], v57 offset:13312
    s_waitcnt lgkmcnt(6)
    v_mfma_f32_32x32x16_bf16 v[124:139], v[100:103], v[92:95], v[124:139]
    v_mfma_f32_32x32x16_bf16 v[140:155], v[104:107], v[92:95], v[140:155]
    v_mfma_f32_32x32x16_bf16 v[156:171], v[100:103], v[96:99], v[156:171]
    v_mfma_f32_32x32x16_bf16 v[172:187], v[104:107], v[96:99], v[172:187]
    s_waitcnt lgkmcnt(0)
    v_mfma_f32_32x32x16_bf16 v[124:139], v[116:119], v[108:111], v[124:139]
    v_mfma_f32_32x32x16_bf16 v[140:155], v[120:123], v[108:111], v[140:155]
    v_mfma_f32_32x32x16_bf16 v[156:171], v[116:119], v[112:115], v[156:171]
    v_mfma_f32_32x32x16_bf16 v[172:187], v[120:123], v[112:115], v[172:187]
    s_sub_u32 s30, s30, 1
    s_cmp_lg_u32 s30, 0
    s_cbranch_scc1 gloop_9
    s_waitcnt vmcnt(24)
    s_barrier
    ds_read_b128 v[60:63], v40 offset:0
    ds_read_b128 v[64:67], v40 offset:4096
    ds_read_b64_tr_b16 v[68:69], v52 offset:0
    ds_read_b64_tr_b16 v[70:71], v52 offset:1024
    ds_read_b64_tr_b16 v[72:73], v53 offset:0
    ds_read_b64_tr_b16 v[74:75], v53 offset:1024
    ds_read_b128 v[76:79], v41 offset:0
    ds_read_b128 v[80:83], v41 offset:4096
    ds_read_b64_tr_b16 v[84:85], v52 offset:4096
    ds_read_b64_tr_b16 v[86:87], v52 offset:5120
    ds_read_b64_tr_b16 v[88:89], v53 offset:4096
    ds_read_b64_tr_b16 v[90:91], v53 offset:5120
    s_lshl_b32 s31, s52, 7
    s_add_u32 s31, s31, s53
    s_mul_i32 s32, s52, 65536
    s_add_u32 s32, s32, s54
    s_add_u32 s52, s52, 1
    s_cmp_eq_u32 s52, 16
    s_cselect_b32 s52, 0, s52
    s_add_u32 m0, s45, 131072
    s_nop 0
    buffer_load_dwordx4 v32, s[8:11], s31 offen lds
    s_add_u32 m0, s45, 132096
    s_nop 0
    buffer_load_dwordx4 v33, s[8:11], s31 offen lds
    s_add_u32 m0, s45, 133120
    s_nop 0
    buffer_load_dwordx4 v34, s[8:11], s31 offen lds
    s_add_u32 m0, s45, 134144
    s_nop 0
    buffer_load_dwordx4 v35, s[8:11], s31 offen lds
    s_add_u32 m0, s46, 147456
    s_nop 0
    buffer_load_dwordx4 v36, s[12:15], s32 offen lds
    s_add_u32 m0, s46, 148480
    s_nop 0
    buffer_load_dwordx4 v37, s[12:15], s32 offen lds
    s_add_u32 m0, s46, 149504
    s_nop 0
    buffer_load_dwordx4 v38, s[12:15], s32 offen lds
    s_add_u32 m0, s46, 150528
    s_nop 0
    buffer_load_dwordx4 v39, s[12:15], s32 offen lds
    s_waitcnt lgkmcnt(6)
    v_mfma_f32_32x32x16_bf16 v[124:139], v[68:71], v[60:63], v[124:139]
    v_mfma_f32_32x32x16_bf16 v[140:155], v[72:75], v[60:63], v[140:155]
    v_mfma_f32_32x32x16_bf16 v[156:171], v[68:71], v[64:67], v[156:171]
    v_mfma_f32_32x32x16_bf16 v[172:187], v[72:75], v[64:67], v[172:187]
    ds_read_b128 v[92:95], v42 offset:0
    ds_read_b128 v[96:99], v42 offset:4096
    ds_read_b64_tr_b16 v[100:101], v52 offset:8192
    ds_read_b64_tr_b16 v[102:103], v52 offset:9216
    ds_read_b64_tr_b16 v[104:105], v53 offset:8192
    ds_read_b64_tr_b16 v[106:107], v53 offset:9216
    s_waitcnt lgkmcnt(6)
    v_mfma_f32_32x32x16_bf16 v[124:139], v[84:87], v[76:79], v[124:139]
    v_mfma_f32_32x32x16_bf16 v[140:155], v[88:91], v[76:79], v[140:155]
    v_mfma_f32_32x32x16_bf16 v[156:171], v[84:87], v[80:83], v[156:171]
    v_mfma_f32_32x32x16_bf16 v[172:187], v[88:91], v[80:83], v[172:187]
    ds_read_b128 v[108:111], v43 offset:0
    ds_read_b128 v[112:115], v43 offset:4096
    ds_read_b64_tr_b16 v[116:117], v52 offset:12288
    ds_read_b64_tr_b16 v[118:119], v52 offset:13312
    ds_read_b64_tr_b16 v[120:121], v53 offset:12288
    ds_read_b64_tr_b16 v[122:123], v53 offset:13312
    s_waitcnt lgkmcnt(6)
    v_mfma_f32_32x32x16_bf16 v[124:139], v[100:103], v[92:95], v[124:139]
    v_mfma_f32_32x32x16_bf16 v[140:155], v[104:107], v[92:95], v[140:155]
    v_mfma_f32_32x32x16_bf16 v[156:171], v[100:103], v[96:99], v[156:171]
    v_mfma_f32_32x32x16_bf16 v[172:187], v[104:107], v[96:99], v[172:187]
    s_waitcnt lgkmcnt(0)
    v_mfma_f32_32x32x16_bf16 v[124:139], v[116:119], v[108:111], v[124:139]
    v_mfma_f32_32x32x16_bf16 v[140:155], v[120:123], v[108:111], v[140:155]
    v_mfma_f32_32x32x16_bf16 v[156:171], v[116:119], v[112:115], v[156:171]
    v_mfma_f32_32x32x16_bf16 v[172:187], v[120:123], v[112:115], v[172:187]
    s_waitcnt vmcnt(24)
    s_barrier
    ds_read_b128 v[60:63], v40 offset:32768
    ds_read_b128 v[64:67], v40 offset:36864
    ds_read_b64_tr_b16 v[68:69], v52 offset:32768
    ds_read_b64_tr_b16 v[70:71], v52 offset:33792
    ds_read_b64_tr_b16 v[72:73], v53 offset:32768
    ds_read_b64_tr_b16 v[74:75], v53 offset:33792
    ds_read_b128 v[76:79], v41 offset:32768
    ds_read_b128 v[80:83], v41 offset:36864
    ds_read_b64_tr_b16 v[84:85], v52 offset:36864
    ds_read_b64_tr_b16 v[86:87], v52 offset:37888
    ds_read_b64_tr_b16 v[88:89], v53 offset:36864
    ds_read_b64_tr_b16 v[90:91], v53 offset:37888
    s_lshl_b32 s31, s52, 7
    s_add_u32 s31, s31, s53
    s_mul_i32 s32, s52, 65536
    s_add_u32 s32, s32, s54
    s_add_u32 s52, s52, 1
    s_cmp_eq_u32 s52, 16
    s_cselect_b32 s52, 0, s52
    s_add_u32 m0, s45, 0
    s_nop 0
    buffer_load_dwordx4 v32, s[8:11], s31 offen lds
    s_add_u32 m0, s45, 1024
    s_nop 0
    buffer_load_dwordx4 v33, s[8:11], s31 offen lds
    s_add_u32 m0, s45, 2048
    s_nop 0
    buffer_load_dwordx4 v34, s[8:11], s31 offen lds
    s_add_u32 m0, s45, 3072
    s_nop 0
    buffer_load_dwordx4 v35, s[8:11], s31 offen lds
    s_add_u32 m0, s46, 16384
    s_nop 0
    buffer_load_dwordx4 v36, s[12:15], s32 offen lds
    s_add_u32 m0, s46, 17408
    s_nop 0
    buffer_load_dwordx4 v37, s[12:15], s32 offen lds
    s_add_u32 m0, s46, 18432
    s_nop 0
    buffer_load_dwordx4 v38, s[12:15], s32 offen lds
    s_add_u32 m0, s46, 19456
    s_nop 0
    buffer_load_dwordx4 v39, s[12:15], s32 offen lds
    s_waitcnt lgkmcnt(6)
    v_mfma_f32_32x32x16_bf16 v[124:139], v[68:71], v[60:63], v[124:139]
    v_mfma_f32_32x32x16_bf16 v[140:155], v[72:75], v[60:63], v[140:155]
    v_mfma_f32_32x32x16_bf16 v[156:171], v[68:71], v[64:67], v[156:171]
    v_mfma_f32_32x32x16_bf16 v[172:187], v[72:75], v[64:67], v[172:187]
    ds_read_b128 v[92:95], v42 offset:32768
    ds_read_b128 v[96:99], v42 offset:36864
    ds_read_b64_tr_b16 v[100:101], v52 offset:40960
    ds_read_b64_tr_b16 v[102:103], v52 offset:41984
    ds_read_b64_tr_b16 v[104:105], v53 offset:40960
    ds_read_b64_tr_b16 v[106:107], v53 offset:41984
    s_waitcnt lgkmcnt(6)
    v_mfma_f32_32x32x16_bf16 v[124:139], v[84:87], v[76:79], v[124:139]
    v_mfma_f32_32x32x16_bf16 v[140:155], v[88:91], v[76:79], v[140:155]
    v_mfma_f32_32x32x16_bf16 v[156:171], v[84:87], v[80:83], v[156:171]
    v_mfma_f32_32x32x16_bf16 v[172:187], v[88:91], v[80:83], v[172:187]
    ds_read_b128 v[108:111], v43 offset:32768
    ds_read_b128 v[112:115], v43 offset:36864
    ds_read_b64_tr_b16 v[116:117], v52 offset:45056
    ds_read_b64_tr_b16 v[118:119], v52 offset:46080
    ds_read_b64_tr_b16 v[120:121], v53 offset:45056
    ds_read_b64_tr_b16 v[122:123], v53 offset:46080
    s_waitcnt lgkmcnt(6)
    v_mfma_f32_32x32x16_bf16 v[124:139], v[100:103], v[92:95], v[124:139]
    v_mfma_f32_32x32x16_bf16 v[140:155], v[104:107], v[92:95], v[140:155]
    v_mfma_f32_32x32x16_bf16 v[156:171], v[100:103], v[96:99], v[156:171]
    v_mfma_f32_32x32x16_bf16 v[172:187], v[104:107], v[96:99], v[172:187]
    s_waitcnt lgkmcnt(0)
    v_mfma_f32_32x32x16_bf16 v[124:139], v[116:119], v[108:111], v[124:139]
    v_mfma_f32_32x32x16_bf16 v[140:155], v[120:123], v[108:111], v[140:155]
    v_mfma_f32_32x32x16_bf16 v[156:171], v[116:119], v[112:115], v[156:171]
    v_mfma_f32_32x32x16_bf16 v[172:187], v[120:123], v[112:115], v[172:187]
    s_waitcnt vmcnt(24)
    s_barrier
    ds_read_b128 v[60:63], v44 offset:0
    ds_read_b128 v[64:67], v44 offset:4096
    ds_read_b64_tr_b16 v[68:69], v54 offset:0
    ds_read_b64_tr_b16 v[70:71], v54 offset:1024
    ds_read_b64_tr_b16 v[72:73], v55 offset:0
    ds_read_b64_tr_b16 v[74:75], v55 offset:1024
    ds_read_b128 v[76:79], v45 offset:0
    ds_read_b128 v[80:83], v45 offset:4096
    ds_read_b64_tr_b16 v[84:85], v54 offset:4096
    ds_read_b64_tr_b16 v[86:87], v54 offset:5120
    ds_read_b64_tr_b16 v[88:89], v55 offset:4096
    ds_read_b64_tr_b16 v[90:91], v55 offset:5120
    s_waitcnt lgkmcnt(6)
    v_mfma_f32_32x32x16_bf16 v[124:139], v[68:71], v[60:63], v[124:139]
    v_mfma_f32_32x32x16_bf16 v[140:155], v[72:75], v[60:63], v[140:155]
    v_mfma_f32_32x32x16_bf16 v[156:171], v[68:71], v[64:67], v[156:171]
    v_mfma_f32_32x32x16_bf16 v[172:187], v[72:75], v[64:67], v[172:187]
    ds_read_b128 v[92:95], v46 offset:0
    ds_read_b128 v[96:99], v46 offset:4096
    ds_read_b64_tr_b16 v[100:101], v54 offset:8192
    ds_read_b64_tr_b16 v[102:103], v54 offset:9216
    ds_read_b64_tr_b16 v[104:105], v55 offset:8192
    ds_read_b64_tr_b16 v[106:107], v55 offset:9216
    s_waitcnt lgkmcnt(6)
    v_mfma_f32_32x32x16_bf16 v[124:139], v[84:87], v[76:79], v[124:139]
    v_mfma_f32_32x32x16_bf16 v[140:155], v[88:91], v[76:79], v[140:155]
    v_mfma_f32_32x32x16_bf16 v[156:171], v[84:87], v[80:83], v[156:171]
    v_mfma_f32_32x32x16_bf16 v[172:187], v[88:91], v[80:83], v[172:187]
    ds_read_b128 v[108:111], v47 offset:0
    ds_read_b128 v[112:115], v47 offset:4096
    ds_read_b64_tr_b16 v[116:117], v54 offset:12288
    ds_read_b64_tr_b16 v[118:119], v54 offset:13312
    ds_read_b64_tr_b16 v[120:121], v55 offset:12288
    ds_read_b64_tr_b16 v[122:123], v55 offset:13312
    s_waitcnt lgkmcnt(6)
    v_mfma_f32_32x32x16_bf16 v[124:139], v[100:103], v[92:95], v[124:139]
    v_mfma_f32_32x32x16_bf16 v[140:155], v[104:107], v[92:95], v[140:155]
    v_mfma_f32_32x32x16_bf16 v[156:171], v[100:103], v[96:99], v[156:171]
    v_mfma_f32_32x32x16_bf16 v[172:187], v[104:107], v[96:99], v[172:187]
    s_waitcnt lgkmcnt(0)
    v_mfma_f32_32x32x16_bf16 v[124:139], v[116:119], v[108:111], v[124:139]
    v_mfma_f32_32x32x16_bf16 v[140:155], v[120:123], v[108:111], v[140:155]
    v_mfma_f32_32x32x16_bf16 v[156:171], v[116:119], v[112:115], v[156:171]
    v_mfma_f32_32x32x16_bf16 v[172:187], v[120:123], v[112:115], v[172:187]
    s_waitcnt vmcnt(16)
    s_barrier
    ds_read_b128 v[60:63], v44 offset:32768
    ds_read_b128 v[64:67], v44 offset:36864
    ds_read_b64_tr_b16 v[68:69], v54 offset:32768
    ds_read_b64_tr_b16 v[70:71], v54 offset:33792
    ds_read_b64_tr_b16 v[72:73], v55 offset:32768
    ds_read_b64_tr_b16 v[74:75], v55 offset:33792
    ds_read_b128 v[76:79], v45 offset:32768
    ds_read_b128 v[80:83], v45 offset:36864
    ds_read_b64_tr_b16 v[84:85], v54 offset:36864
    ds_read_b64_tr_b16 v[86:87], v54 offset:37888
    ds_read_b64_tr_b16 v[88:89], v55 offset:36864
    ds_read_b64_tr_b16 v[90:91], v55 offset:37888
    s_waitcnt lgkmcnt(6)
    v_mfma_f32_32x32x16_bf16 v[124:139], v[68:71], v[60:63], v[124:139]
    v_mfma_f32_32x32x16_bf16 v[140:155], v[72:75], v[60:63], v[140:155]
    v_mfma_f32_32x32x16_bf16 v[156:171], v[68:71], v[64:67], v[156:171]
    v_mfma_f32_32x32x16_bf16 v[172:187], v[72:75], v[64:67], v[172:187]
    ds_read_b128 v[92:95], v46 offset:32768
    ds_read_b128 v[96:99], v46 offset:36864
    ds_read_b64_tr_b16 v[100:101], v54 offset:40960
    ds_read_b64_tr_b16 v[102:103], v54 offset:41984
    ds_read_b64_tr_b16 v[104:105], v55 offset:40960
    ds_read_b64_tr_b16 v[106:107], v55 offset:41984
    s_waitcnt lgkmcnt(6)
    v_mfma_f32_32x32x16_bf16 v[124:139], v[84:87], v[76:79], v[124:139]
    v_mfma_f32_32x32x16_bf16 v[140:155], v[88:91], v[76:79], v[140:155]
    v_mfma_f32_32x32x16_bf16 v[156:171], v[84:87], v[80:83], v[156:171]
    v_mfma_f32_32x32x16_bf16 v[172:187], v[88:91], v[80:83], v[172:187]
    ds_read_b128 v[108:111], v47 offset:32768
    ds_read_b128 v[112:115], v47 offset:36864
    ds_read_b64_tr_b16 v[116:117], v54 offset:45056
    ds_read_b64_tr_b16 v[118:119], v54 offset:46080
    ds_read_b64_tr_b16 v[120:121], v55 offset:45056
    ds_read_b64_tr_b16 v[122:123], v55 offset:46080
    s_waitcnt lgkmcnt(6)
    v_mfma_f32_32x32x16_bf16 v[124:139], v[100:103], v[92:95], v[124:139]
    v_mfma_f32_32x32x16_bf16 v[140:155], v[104:107], v[92:95], v[140:155]
    v_mfma_f32_32x32x16_bf16 v[156:171], v[100:103], v[96:99], v[156:171]
    v_mfma_f32_32x32x16_bf16 v[172:187], v[104:107], v[96:99], v[172:187]
    s_waitcnt lgkmcnt(0)
    v_mfma_f32_32x32x16_bf16 v[124:139], v[116:119], v[108:111], v[124:139]
    v_mfma_f32_32x32x16_bf16 v[140:155], v[120:123], v[108:111], v[140:155]
    v_mfma_f32_32x32x16_bf16 v[156:171], v[116:119], v[112:115], v[156:171]
    v_mfma_f32_32x32x16_bf16 v[172:187], v[120:123], v[112:115], v[172:187]
    s_waitcnt vmcnt(8)
    s_barrier
    ds_read_b128 v[60:63], v48 offset:0
    ds_read_b128 v[64:67], v48 offset:4096
    ds_read_b64_tr_b16 v[68:69], v56 offset:0
    ds_read_b64_tr_b16 v[70:71], v56 offset:1024
    ds_read_b64_tr_b16 v[72:73], v57 offset:0
    ds_read_b64_tr_b16 v[74:75], v57 offset:1024
    ds_read_b128 v[76:79], v49 offset:0
    ds_read_b128 v[80:83], v49 offset:4096
    ds_read_b64_tr_b16 v[84:85], v56 offset:4096
    ds_read_b64_tr_b16 v[86:87], v56 offset:5120
    ds_read_b64_tr_b16 v[88:89], v57 offset:4096
    ds_read_b64_tr_b16 v[90:91], v57 offset:5120
    s_waitcnt lgkmcnt(6)
    v_mfma_f32_32x32x16_bf16 v[124:139], v[68:71], v[60:63], v[124:139]
    v_mfma_f32_32x32x16_bf16 v[140:155], v[72:75], v[60:63], v[140:155]
    v_mfma_f32_32x32x16_bf16 v[156:171], v[68:71], v[64:67], v[156:171]
    v_mfma_f32_32x32x16_bf16 v[172:187], v[72:75], v[64:67], v[172:187]
    ds_read_b128 v[92:95], v50 offset:0
    ds_read_b128 v[96:99], v50 offset:4096
    ds_read_b64_tr_b16 v[100:101], v56 offset:8192
    ds_read_b64_tr_b16 v[102:103], v56 offset:9216
    ds_read_b64_tr_b16 v[104:105], v57 offset:8192
    ds_read_b64_tr_b16 v[106:107], v57 offset:9216
    s_waitcnt lgkmcnt(6)
    v_mfma_f32_32x32x16_bf16 v[124:139], v[84:87], v[76:79], v[124:139]
    v_mfma_f32_32x32x16_bf16 v[140:155], v[88:91], v[76:79], v[140:155]
    v_mfma_f32_32x32x16_bf16 v[156:171], v[84:87], v[80:83], v[156:171]
    v_mfma_f32_32x32x16_bf16 v[172:187], v[88:91], v[80:83], v[172:187]
    ds_read_b128 v[108:111], v51 offset:0
    ds_read_b128 v[112:115], v51 offset:4096
    ds_read_b64_tr_b16 v[116:117], v56 offset:12288
    ds_read_b64_tr_b16 v[118:119], v56 offset:13312
    ds_read_b64_tr_b16 v[120:121], v57 offset:12288
    ds_read_b64_tr_b16 v[122:123], v57 offset:13312
    s_waitcnt lgkmcnt(6)
    v_mfma_f32_32x32x16_bf16 v[124:139], v[100:103], v[92:95], v[124:139]
    v_mfma_f32_32x32x16_bf16 v[140:155], v[104:107], v[92:95], v[140:155]
    v_mfma_f32_32x32x16_bf16 v[156:171], v[100:103], v[96:99], v[156:171]
    v_mfma_f32_32x32x16_bf16 v[172:187], v[104:107], v[96:99], v[172:187]
    s_waitcnt lgkmcnt(0)
    v_mfma_f32_32x32x16_bf16 v[124:139], v[116:119], v[108:111], v[124:139]
    v_mfma_f32_32x32x16_bf16 v[140:155], v[120:123], v[108:111], v[140:155]
    v_mfma_f32_32x32x16_bf16 v[156:171], v[116:119], v[112:115], v[156:171]
    v_mfma_f32_32x32x16_bf16 v[172:187], v[120:123], v[112:115], v[172:187]
    s_waitcnt vmcnt(0)
    s_barrier
    ds_read_b128 v[60:63], v40 offset:0
    ds_read_b128 v[64:67], v40 offset:4096
    ds_read_b64_tr_b16 v[68:69], v52 offset:0
    ds_read_b64_tr_b16 v[70:71], v52 offset:1024
    ds_read_b64_tr_b16 v[72:73], v53 offset:0
    ds_read_b64_tr_b16 v[74:75], v53 offset:1024
    ds_read_b128 v[76:79], v41 offset:0
    ds_read_b128 v[80:83], v41 offset:4096
    ds_read_b64_tr_b16 v[84:85], v52 offset:4096
    ds_read_b64_tr_b16 v[86:87], v52 offset:5120
    ds_read_b64_tr_b16 v[88:89], v53 offset:4096
    ds_read_b64_tr_b16 v[90:91], v53 offset:5120
    s_waitcnt lgkmcnt(6)
    v_mfma_f32_32x32x16_bf16 v[124:139], v[68:71], v[60:63], v[124:139]
    v_mfma_f32_32x32x16_bf16 v[140:155], v[72:75], v[60:63], v[140:155]
    v_mfma_f32_32x32x16_bf16 v[156:171], v[68:71], v[64:67], v[156:171]
    v_mfma_f32_32x32x16_bf16 v[172:187], v[72:75], v[64:67], v[172:187]
    ds_read_b128 v[92:95], v42 offset:0
    ds_read_b128 v[96:99], v42 offset:4096
    ds_read_b64_tr_b16 v[100:101], v52 offset:8192
    ds_read_b64_tr_b16 v[102:103], v52 offset:9216
    ds_read_b64_tr_b16 v[104:105], v53 offset:8192
    ds_read_b64_tr_b16 v[106:107], v53 offset:9216
    s_waitcnt lgkmcnt(6)
    v_mfma_f32_32x32x16_bf16 v[124:139], v[84:87], v[76:79], v[124:139]
    v_mfma_f32_32x32x16_bf16 v[140:155], v[88:91], v[76:79], v[140:155]
    v_mfma_f32_32x32x16_bf16 v[156:171], v[84:87], v[80:83], v[156:171]
    v_mfma_f32_32x32x16_bf16 v[172:187], v[88:91], v[80:83], v[172:187]
    ds_read_b128 v[108:111], v43 offset:0
    ds_read_b128 v[112:115], v43 offset:4096
    ds_read_b64_tr_b16 v[116:117], v52 offset:12288
    ds_read_b64_tr_b16 v[118:119], v52 offset:13312
    ds_read_b64_tr_b16 v[120:121], v53 offset:12288
    ds_read_b64_tr_b16 v[122:123], v53 offset:13312
    s_waitcnt lgkmcnt(6)
    v_mfma_f32_32x32x16_bf16 v[124:139], v[100:103], v[92:95], v[124:139]
    v_mfma_f32_32x32x16_bf16 v[140:155], v[104:107], v[92:95], v[140:155]
    v_mfma_f32_32x32x16_bf16 v[156:171], v[100:103], v[96:99], v[156:171]
    v_mfma_f32_32x32x16_bf16 v[172:187], v[104:107], v[96:99], v[172:187]
    s_waitcnt lgkmcnt(0)
    v_mfma_f32_32x32x16_bf16 v[124:139], v[116:119], v[108:111], v[124:139]
    v_mfma_f32_32x32x16_bf16 v[140:155], v[120:123], v[108:111], v[140:155]
    v_mfma_f32_32x32x16_bf16 v[156:171], v[116:119], v[112:115], v[156:171]
    v_mfma_f32_32x32x16_bf16 v[172:187], v[120:123], v[112:115], v[172:187]
    s_nop 7
    s_nop 7
    s_mul_i32 s5, s41, 64
    s_add_u32 s4, s33, s5
    v_add_u32 v28, s4, v24
    s_mov_b32 s5, 512
    v_mul_lo_u32 v28, v28, s5
    s_mul_i32 s5, s42, 64
    s_add_u32 s5, s5, s34
    v_add_u32 v28, s5, v28

    v_lshl_add_u32 v28, v25, 2, v28
    v_lshlrev_b32 v28, 2, v28
    s_lshl_b32 s5, s37, 22
    v_add_u32 v28, s5, v28
    s_mov_b32 s4, 0
    buffer_store_dwordx4 v[124:127], v28, s[16:19], s4 offen offset:0
    buffer_store_dwordx4 v[128:131], v28, s[16:19], s4 offen offset:32
    buffer_store_dwordx4 v[132:135], v28, s[16:19], s4 offen offset:64
    buffer_store_dwordx4 v[136:139], v28, s[16:19], s4 offen offset:96
    buffer_store_dwordx4 v[140:143], v28, s[16:19], s4 offen offset:128
    buffer_store_dwordx4 v[144:147], v28, s[16:19], s4 offen offset:160
    buffer_store_dwordx4 v[148:151], v28, s[16:19], s4 offen offset:192
    buffer_store_dwordx4 v[152:155], v28, s[16:19], s4 offen offset:224
    s_mov_b32 s4, 65536
    buffer_store_dwordx4 v[156:159], v28, s[16:19], s4 offen offset:0
    buffer_store_dwordx4 v[160:163], v28, s[16:19], s4 offen offset:32
    buffer_store_dwordx4 v[164:167], v28, s[16:19], s4 offen offset:64
    buffer_store_dwordx4 v[168:171], v28, s[16:19], s4 offen offset:96
    buffer_store_dwordx4 v[172:175], v28, s[16:19], s4 offen offset:128
    buffer_store_dwordx4 v[176:179], v28, s[16:19], s4 offen offset:160
    buffer_store_dwordx4 v[180:183], v28, s[16:19], s4 offen offset:192
    buffer_store_dwordx4 v[184:187], v28, s[16:19], s4 offen offset:224
g_done_8:
    s_endpgm
.globl ln2_kernel
.p2align 8
.type ln2_kernel,@function
ln2_kernel:
    s_cmp_ge_u32 s2, 512
    s_cbranch_scc1 ln_done_10
    s_load_dwordx2 s[8:9], s[0:1], 0
    s_mov_b32 s10, 2097152
    s_mov_b32 s11, 0x00020000
    s_load_dwordx2 s[12:13], s[0:1], 104
    s_mov_b32 s14, 12288
    s_mov_b32 s15, 0x00020000
    s_load_dwordx2 s[16:17], s[0:1], 104
    s_mov_b32 s18, 2097152
    s_mov_b32 s19, 0x00020000
    s_load_dwordx2 s[20:21], s[0:1], 104
    s_mov_b32 s22, 16777216
    s_mov_b32 s23, 0x00020000
    s_load_dwordx2 s[24:25], s[0:1], 104
    s_mov_b32 s26, 4194304
    s_mov_b32 s27, 0x00020000
    v_lshrrev_b32 v1, 6, v0
    v_and_b32 v2, 63, v0
    s_lshl_b32 s3, s2, 2
    v_add_u32 v1, s3, v1
    v_lshlrev_b32 v3, 11, v1
    v_lshl_add_u32 v3, v2, 5, v3
    v_lshlrev_b32 v4, 5, v2
    v_lshlrev_b32 v5, 10, v1
    v_lshl_add_u32 v5, v2, 4, v5
    v_lshlrev_b32 v6, 2, v2
    s_waitcnt lgkmcnt(0)

    s_add_u32 s16, s16, 88080384
    s_addc_u32 s17, s17, 0
    s_add_u32 s20, s20, 100663296
    s_addc_u32 s21, s21, 0
    s_add_u32 s24, s24, 83886080
    s_addc_u32 s25, s25, 0
    buffer_load_dwordx4 v[24:27], v5, s[8:11], 0 offen
    s_mov_b32 s4, 0
    buffer_load_dwordx4 v[48:51], v3, s[20:23], s4 offen
    buffer_load_dwordx4 v[52:55], v3, s[20:23], s4 offen offset:16
    s_mov_b32 s4, 4194304
    buffer_load_dwordx4 v[56:59], v3, s[20:23], s4 offen
    buffer_load_dwordx4 v[60:63], v3, s[20:23], s4 offen offset:16
    s_mov_b32 s4, 8388608
    buffer_load_dwordx4 v[64:67], v3, s[20:23], s4 offen
    buffer_load_dwordx4 v[68:71], v3, s[20:23], s4 offen offset:16
    s_mov_b32 s4, 12582912
    buffer_load_dwordx4 v[72:75], v3, s[20:23], s4 offen
    buffer_load_dwordx4 v[76:79], v3, s[20:23], s4 offen offset:16
    s_mov_b32 s4, 4096
    buffer_load_dwordx4 v[80:83], v4, s[12:15], s4 offen
    buffer_load_dwordx4 v[84:87], v4, s[12:15], s4 offen offset:16
    s_mov_b32 s4, 8192
    s_mov_b32 s5, 6144
    buffer_load_dwordx4 v[32:35], v4, s[12:15], s4 offen
    buffer_load_dwordx4 v[36:39], v4, s[12:15], s4 offen offset:16
    buffer_load_dwordx4 v[40:43], v4, s[12:15], s5 offen
    buffer_load_dwordx4 v[44:47], v4, s[12:15], s5 offen offset:16
    s_waitcnt vmcnt(4)
    v_add_f32 v48, v48, v56
    v_add_f32 v64, v64, v72
    v_add_f32 v48, v48, v64
    v_add_f32 v49, v49, v57
    v_add_f32 v65, v65, v73
    v_add_f32 v49, v49, v65
    v_add_f32 v50, v50, v58
    v_add_f32 v66, v66, v74
    v_add_f32 v50, v50, v66
    v_add_f32 v51, v51, v59
    v_add_f32 v67, v67, v75
    v_add_f32 v51, v51, v67
    v_add_f32 v52, v52, v60
    v_add_f32 v68, v68, v76
    v_add_f32 v52, v52, v68
    v_add_f32 v53, v53, v61
    v_add_f32 v69, v69, v77
    v_add_f32 v53, v53, v69
    v_add_f32 v54, v54, v62
    v_add_f32 v70, v70, v78
    v_add_f32 v54, v54, v70
    v_add_f32 v55, v55, v63
    v_add_f32 v71, v71, v79
    v_add_f32 v55, v55, v71
    v_lshlrev_b32 v8, 16, v24
    v_and_b32 v9, 0xffff0000, v24
    v_lshlrev_b32 v10, 16, v25
    v_and_b32 v11, 0xffff0000, v25
    v_lshlrev_b32 v12, 16, v26
    v_and_b32 v13, 0xffff0000, v26
    v_lshlrev_b32 v14, 16, v27
    v_and_b32 v15, 0xffff0000, v27
    v_fmac_f32 v8, v48, v80
    v_fmac_f32 v9, v49, v81
    v_fmac_f32 v10, v50, v82
    v_fmac_f32 v11, v51, v83
    v_fmac_f32 v12, v52, v84
    v_fmac_f32 v13, v53, v85
    v_fmac_f32 v14, v54, v86
    v_fmac_f32 v15, v55, v87
    buffer_store_dwordx4 v[8:11], v3, s[24:27], 0 offen
    buffer_store_dwordx4 v[12:15], v3, s[24:27], 0 offen offset:16
    v_add_f32 v16, v8, v9
    v_add_f32 v16, v16, v10
    v_add_f32 v16, v16, v11
    v_add_f32 v16, v16, v12
    v_add_f32 v16, v16, v13
    v_add_f32 v16, v16, v14
    v_add_f32 v16, v16, v15
    v_xor_b32 v17, 4, v6
    ds_bpermute_b32 v17, v17, v16
    s_waitcnt lgkmcnt(0)
    v_add_f32 v16, v16, v17
    v_xor_b32 v17, 8, v6
    ds_bpermute_b32 v17, v17, v16
    s_waitcnt lgkmcnt(0)
    v_add_f32 v16, v16, v17
    v_xor_b32 v17, 16, v6
    ds_bpermute_b32 v17, v17, v16
    s_waitcnt lgkmcnt(0)
    v_add_f32 v16, v16, v17
    v_xor_b32 v17, 32, v6
    ds_bpermute_b32 v17, v17, v16
    s_waitcnt lgkmcnt(0)
    v_add_f32 v16, v16, v17
    v_xor_b32 v17, 64, v6
    ds_bpermute_b32 v17, v17, v16
    s_waitcnt lgkmcnt(0)
    v_add_f32 v16, v16, v17
    v_xor_b32 v17, 128, v6
    ds_bpermute_b32 v17, v17, v16
    s_waitcnt lgkmcnt(0)
    v_add_f32 v16, v16, v17
    v_mul_f32 v16, 0x3b000000, v16
    v_sub_f32 v48, v8, v16
    v_sub_f32 v49, v9, v16
    v_sub_f32 v50, v10, v16
    v_sub_f32 v51, v11, v16
    v_sub_f32 v52, v12, v16
    v_sub_f32 v53, v13, v16
    v_sub_f32 v54, v14, v16
    v_sub_f32 v55, v15, v16
    v_mul_f32 v18, v48, v48
    v_fmac_f32 v18, v49, v49
    v_fmac_f32 v18, v50, v50
    v_fmac_f32 v18, v51, v51
    v_fmac_f32 v18, v52, v52
    v_fmac_f32 v18, v53, v53
    v_fmac_f32 v18, v54, v54
    v_fmac_f32 v18, v55, v55
    v_xor_b32 v17, 4, v6
    ds_bpermute_b32 v17, v17, v18
    s_waitcnt lgkmcnt(0)
    v_add_f32 v18, v18, v17
    v_xor_b32 v17, 8, v6
    ds_bpermute_b32 v17, v17, v18
    s_waitcnt lgkmcnt(0)
    v_add_f32 v18, v18, v17
    v_xor_b32 v17, 16, v6
    ds_bpermute_b32 v17, v17, v18
    s_waitcnt lgkmcnt(0)
    v_add_f32 v18, v18, v17
    v_xor_b32 v17, 32, v6
    ds_bpermute_b32 v17, v17, v18
    s_waitcnt lgkmcnt(0)
    v_add_f32 v18, v18, v17
    v_xor_b32 v17, 64, v6
    ds_bpermute_b32 v17, v17, v18
    s_waitcnt lgkmcnt(0)
    v_add_f32 v18, v18, v17
    v_xor_b32 v17, 128, v6
    ds_bpermute_b32 v17, v17, v18
    s_waitcnt lgkmcnt(0)
    v_add_f32 v18, v18, v17
    v_mov_b32 v19, 0x3727c5ac
    v_fmac_f32 v19, 0x3b000000, v18
    v_rsq_f32 v19, v19
    s_waitcnt vmcnt(2)

    v_add_f32 v32, 1.0, v32
    v_mul_f32 v48, v48, v19
    v_fma_f32 v48, v48, v32, v40
    v_add_f32 v33, 1.0, v33
    v_mul_f32 v49, v49, v19
    v_fma_f32 v49, v49, v33, v41
    v_add_f32 v34, 1.0, v34
    v_mul_f32 v50, v50, v19
    v_fma_f32 v50, v50, v34, v42
    v_add_f32 v35, 1.0, v35
    v_mul_f32 v51, v51, v19
    v_fma_f32 v51, v51, v35, v43
    v_add_f32 v36, 1.0, v36
    v_mul_f32 v52, v52, v19
    v_fma_f32 v52, v52, v36, v44
    v_add_f32 v37, 1.0, v37
    v_mul_f32 v53, v53, v19
    v_fma_f32 v53, v53, v37, v45
    v_add_f32 v38, 1.0, v38
    v_mul_f32 v54, v54, v19
    v_fma_f32 v54, v54, v38, v46
    v_add_f32 v39, 1.0, v39
    v_mul_f32 v55, v55, v19
    v_fma_f32 v55, v55, v39, v47
    v_cvt_pk_bf16_f32 v20, v48, v49
    v_cvt_pk_bf16_f32 v21, v50, v51
    v_cvt_pk_bf16_f32 v22, v52, v53
    v_cvt_pk_bf16_f32 v23, v54, v55
    buffer_store_dwordx4 v[20:23], v5, s[16:19], 0 offen
ln_done_10:
    s_endpgm
.globl ffn1_kernel
.p2align 8
.type ffn1_kernel,@function
ffn1_kernel:
    s_cmp_ge_u32 s2, 224
    s_cbranch_scc1 g_done_11
    v_and_b32 v26, 63, v0
    v_and_b32 v24, 31, v0
    v_bfe_u32 v25, v0, 5, 1
    v_lshrrev_b32 v1, 6, v0
    s_nop 0
    v_readfirstlane_b32 s40, v1
    s_nop 3
    s_lshr_b32 s41, s40, 1
    s_and_b32 s42, s40, 1

    s_and_b32 s33, s2, 7
    s_lshl_b32 s33, s33, 1
    s_lshr_b32 s4, s2, 3
    s_and_b32 s4, s4, 1
    s_add_u32 s33, s33, s4
    s_mul_i32 s33, s33, 128
    s_lshr_b32 s37, s2, 4
    s_mul_i32 s34, s37, 128
    s_mov_b32 s31, 0
    s_mov_b32 s32, 0

    s_load_dwordx2 s[8:9], s[0:1], 104
    s_mov_b32 s10, 2097152
    s_mov_b32 s11, 0x00020000
    s_load_dwordx2 s[12:13], s[0:1], 56
    s_mov_b32 s14, 1835008
    s_mov_b32 s15, 0x00020000
    s_load_dwordx2 s[16:17], s[0:1], 104
    s_mov_b32 s18, 7340032
    s_mov_b32 s19, 0x00020000
    s_waitcnt lgkmcnt(0)
    s_add_u32 s8, s8, 88080384
    s_addc_u32 s9, s9, 0
    s_add_u32 s16, s16, 92274688
    s_addc_u32 s17, s17, 0
    v_lshrrev_b32 v1, 3, v26
    v_lshrrev_b32 v2, 4, v26
    v_and_b32 v3, 7, v26
    s_mul_i32 s4, s40, 4
    s_mov_b32 s5, 1024

    s_add_u32 s6, s4, 0
    s_lshl_b32 s7, s6, 2
    v_add_u32 v4, s7, v2
    v_and_b32 v4, 7, v4
    v_xor_b32 v4, v4, v3
    s_lshl_b32 s7, s6, 3
    s_add_u32 s7, s7, s33
    v_add_u32 v5, s7, v1
    v_mul_lo_u32 v5, v5, s5
    v_lshl_add_u32 v32, v4, 4, v5

    s_add_u32 s6, s4, 1
    s_lshl_b32 s7, s6, 2
    v_add_u32 v4, s7, v2
    v_and_b32 v4, 7, v4
    v_xor_b32 v4, v4, v3
    s_lshl_b32 s7, s6, 3
    s_add_u32 s7, s7, s33
    v_add_u32 v5, s7, v1
    v_mul_lo_u32 v5, v5, s5
    v_lshl_add_u32 v33, v4, 4, v5

    s_add_u32 s6, s4, 2
    s_lshl_b32 s7, s6, 2
    v_add_u32 v4, s7, v2
    v_and_b32 v4, 7, v4
    v_xor_b32 v4, v4, v3
    s_lshl_b32 s7, s6, 3
    s_add_u32 s7, s7, s33
    v_add_u32 v5, s7, v1
    v_mul_lo_u32 v5, v5, s5
    v_lshl_add_u32 v34, v4, 4, v5

    s_add_u32 s6, s4, 3
    s_lshl_b32 s7, s6, 2
    v_add_u32 v4, s7, v2
    v_and_b32 v4, 7, v4
    v_xor_b32 v4, v4, v3
    s_lshl_b32 s7, s6, 3
    s_add_u32 s7, s7, s33
    v_add_u32 v5, s7, v1
    v_mul_lo_u32 v5, v5, s5
    v_lshl_add_u32 v35, v4, 4, v5

    s_mul_i32 s4, s40, 4
    s_mov_b32 s5, 3584
    s_lshl_b32 s44, s34, 1
    v_lshlrev_b32 v1, 4, v26

    s_add_u32 s6, s4, 0
    s_lshl_b32 s6, s6, 10
    v_add_u32 v2, s6, v1
    v_lshrrev_b32 v3, 8, v2
    v_and_b32 v4, 255, v2

    v_and_b32 v5, 3, v3
    v_lshlrev_b32 v5, 6, v5
    v_xor_b32 v4, v4, v5
    v_mul_lo_u32 v3, v3, s5
    v_add_u32 v3, v3, v4
    v_add_u32 v36, s44, v3
    s_add_u32 s6, s4, 1
    s_lshl_b32 s6, s6, 10
    v_add_u32 v2, s6, v1
    v_lshrrev_b32 v3, 8, v2
    v_and_b32 v4, 255, v2

    v_and_b32 v5, 3, v3
    v_lshlrev_b32 v5, 6, v5
    v_xor_b32 v4, v4, v5
    v_mul_lo_u32 v3, v3, s5
    v_add_u32 v3, v3, v4
    v_add_u32 v37, s44, v3
    s_add_u32 s6, s4, 2
    s_lshl_b32 s6, s6, 10
    v_add_u32 v2, s6, v1
    v_lshrrev_b32 v3, 8, v2
    v_and_b32 v4, 255, v2

    v_and_b32 v5, 3, v3
    v_lshlrev_b32 v5, 6, v5
    v_xor_b32 v4, v4, v5
    v_mul_lo_u32 v3, v3, s5
    v_add_u32 v3, v3, v4
    v_add_u32 v38, s44, v3
    s_add_u32 s6, s4, 3
    s_lshl_b32 s6, s6, 10
    v_add_u32 v2, s6, v1
    v_lshrrev_b32 v3, 8, v2
    v_and_b32 v4, 255, v2

    v_and_b32 v5, 3, v3
    v_lshlrev_b32 v5, 6, v5
    v_xor_b32 v4, v4, v5
    v_mul_lo_u32 v3, v3, s5
    v_add_u32 v3, v3, v4
    v_add_u32 v39, s44, v3
    s_mul_i32 s4, s41, 64
    v_add_u32 v1, s4, v24
    v_bfe_u32 v2, v1, 1, 3
    v_lshlrev_b32 v1, 7, v1

    v_add_u32 v3, 0, v25
    v_xor_b32 v3, v3, v2
    v_lshl_add_u32 v40, v3, 4, v1
    v_add_u32 v3, 2, v25
    v_xor_b32 v3, v3, v2
    v_lshl_add_u32 v41, v3, 4, v1
    v_add_u32 v3, 4, v25
    v_xor_b32 v3, v3, v2
    v_lshl_add_u32 v42, v3, 4, v1
    v_add_u32 v3, 6, v25
    v_xor_b32 v3, v3, v2
    v_lshl_add_u32 v43, v3, 4, v1
    v_bfe_u32 v1, v26, 2, 2
    v_lshrrev_b32 v2, 5, v26
    v_lshlrev_b32 v2, 11, v2
    v_lshl_add_u32 v2, v1, 8, v2
    v_bfe_u32 v3, v26, 4, 1
    v_lshl_add_u32 v2, v3, 5, v2
    v_and_b32 v3, 3, v26
    v_lshl_add_u32 v2, v3, 3, v2
    v_add_u32 v2, 16384, v2
    s_mul_i32 s4, s42, 2

    s_add_u32 s5, s4, 0
    v_xor_b32 v3, s5, v1
    v_lshl_add_u32 v52, v3, 6, v2
    s_add_u32 s5, s4, 1
    v_xor_b32 v3, s5, v1
    v_lshl_add_u32 v53, v3, 6, v2
    v_add_u32 v44, 65536, v40
    v_add_u32 v45, 65536, v41
    v_add_u32 v46, 65536, v42
    v_add_u32 v47, 65536, v43
    v_add_u32 v54, 65536, v52
    v_add_u32 v55, 65536, v53
    v_add_u32 v48, 131072, v40
    v_add_u32 v49, 131072, v41
    v_add_u32 v50, 131072, v42
    v_add_u32 v51, 131072, v43
    v_add_u32 v56, 131072, v52
    v_add_u32 v57, 131072, v53
    v_mov_b32 v124, 0
    v_mov_b32 v125, 0
    v_mov_b32 v126, 0
    v_mov_b32 v127, 0
    v_mov_b32 v128, 0
    v_mov_b32 v129, 0
    v_mov_b32 v130, 0
    v_mov_b32 v131, 0
    v_mov_b32 v132, 0
    v_mov_b32 v133, 0
    v_mov_b32 v134, 0
    v_mov_b32 v135, 0
    v_mov_b32 v136, 0
    v_mov_b32 v137, 0
    v_mov_b32 v138, 0
    v_mov_b32 v139, 0
    v_mov_b32 v140, 0
    v_mov_b32 v141, 0
    v_mov_b32 v142, 0
    v_mov_b32 v143, 0
    v_mov_b32 v144, 0
    v_mov_b32 v145, 0
    v_mov_b32 v146, 0
    v_mov_b32 v147, 0
    v_mov_b32 v148, 0
    v_mov_b32 v149, 0
    v_mov_b32 v150, 0
    v_mov_b32 v151, 0
    v_mov_b32 v152, 0
    v_mov_b32 v153, 0
    v_mov_b32 v154, 0
    v_mov_b32 v155, 0
    v_mov_b32 v156, 0
    v_mov_b32 v157, 0
    v_mov_b32 v158, 0
    v_mov_b32 v159, 0
    v_mov_b32 v160, 0
    v_mov_b32 v161, 0
    v_mov_b32 v162, 0
    v_mov_b32 v163, 0
    v_mov_b32 v164, 0
    v_mov_b32 v165, 0
    v_mov_b32 v166, 0
    v_mov_b32 v167, 0
    v_mov_b32 v168, 0
    v_mov_b32 v169, 0
    v_mov_b32 v170, 0
    v_mov_b32 v171, 0
    v_mov_b32 v172, 0
    v_mov_b32 v173, 0
    v_mov_b32 v174, 0
    v_mov_b32 v175, 0
    v_mov_b32 v176, 0
    v_mov_b32 v177, 0
    v_mov_b32 v178, 0
    v_mov_b32 v179, 0
    v_mov_b32 v180, 0
    v_mov_b32 v181, 0
    v_mov_b32 v182, 0
    v_mov_b32 v183, 0
    v_mov_b32 v184, 0
    v_mov_b32 v185, 0
    v_mov_b32 v186, 0
    v_mov_b32 v187, 0
    s_lshl_b32 s45, s40, 10
    s_mul_i32 s46, s45, 4
    s_mul_i32 s45, s45, 4
    s_mov_b32 s53, s31
    s_mov_b32 s54, s32
    s_lshr_b32 s52, s2, 3
    s_and_b32 s52, s52, 31

    s_sub_u32 s4, s52, 8
    s_cmp_ge_u32 s52, 8
    s_cselect_b32 s52, s4, s52
    s_sub_u32 s4, s52, 8
    s_cmp_ge_u32 s52, 8
    s_cselect_b32 s52, s4, s52
    s_sub_u32 s4, s52, 8
    s_cmp_ge_u32 s52, 8
    s_cselect_b32 s52, s4, s52
    s_sub_u32 s4, s52, 8
    s_cmp_ge_u32 s52, 8
    s_cselect_b32 s52, s4, s52
    s_lshl_b32 s31, s52, 7
    s_add_u32 s31, s31, s53
    s_mul_i32 s32, s52, 229376
    s_add_u32 s32, s32, s54
    s_add_u32 s52, s52, 1
    s_cmp_eq_u32 s52, 8
    s_cselect_b32 s52, 0, s52
    s_add_u32 m0, s45, 0
    s_nop 0
    buffer_load_dwordx4 v32, s[8:11], s31 offen lds
    s_add_u32 m0, s45, 1024
    s_nop 0
    buffer_load_dwordx4 v33, s[8:11], s31 offen lds
    s_add_u32 m0, s45, 2048
    s_nop 0
    buffer_load_dwordx4 v34, s[8:11], s31 offen lds
    s_add_u32 m0, s45, 3072
    s_nop 0
    buffer_load_dwordx4 v35, s[8:11], s31 offen lds
    s_add_u32 m0, s46, 16384
    s_nop 0
    buffer_load_dwordx4 v36, s[12:15], s32 offen lds
    s_add_u32 m0, s46, 17408
    s_nop 0
    buffer_load_dwordx4 v37, s[12:15], s32 offen lds
    s_add_u32 m0, s46, 18432
    s_nop 0
    buffer_load_dwordx4 v38, s[12:15], s32 offen lds
    s_add_u32 m0, s46, 19456
    s_nop 0
    buffer_load_dwordx4 v39, s[12:15], s32 offen lds
    s_lshl_b32 s31, s52, 7
    s_add_u32 s31, s31, s53
    s_mul_i32 s32, s52, 229376
    s_add_u32 s32, s32, s54
    s_add_u32 s52, s52, 1
    s_cmp_eq_u32 s52, 8
    s_cselect_b32 s52, 0, s52
    s_add_u32 m0, s45, 32768
    s_nop 0
    buffer_load_dwordx4 v32, s[8:11], s31 offen lds
    s_add_u32 m0, s45, 33792
    s_nop 0
    buffer_load_dwordx4 v33, s[8:11], s31 offen lds
    s_add_u32 m0, s45, 34816
    s_nop 0
    buffer_load_dwordx4 v34, s[8:11], s31 offen lds
    s_add_u32 m0, s45, 35840
    s_nop 0
    buffer_load_dwordx4 v35, s[8:11], s31 offen lds
    s_add_u32 m0, s46, 49152
    s_nop 0
    buffer_load_dwordx4 v36, s[12:15], s32 offen lds
    s_add_u32 m0, s46, 50176
    s_nop 0
    buffer_load_dwordx4 v37, s[12:15], s32 offen lds
    s_add_u32 m0, s46, 51200
    s_nop 0
    buffer_load_dwordx4 v38, s[12:15], s32 offen lds
    s_add_u32 m0, s46, 52224
    s_nop 0
    buffer_load_dwordx4 v39, s[12:15], s32 offen lds
    s_lshl_b32 s31, s52, 7
    s_add_u32 s31, s31, s53
    s_mul_i32 s32, s52, 229376
    s_add_u32 s32, s32, s54
    s_add_u32 s52, s52, 1
    s_cmp_eq_u32 s52, 8
    s_cselect_b32 s52, 0, s52
    s_add_u32 m0, s45, 65536
    s_nop 0
    buffer_load_dwordx4 v32, s[8:11], s31 offen lds
    s_add_u32 m0, s45, 66560
    s_nop 0
    buffer_load_dwordx4 v33, s[8:11], s31 offen lds
    s_add_u32 m0, s45, 67584
    s_nop 0
    buffer_load_dwordx4 v34, s[8:11], s31 offen lds
    s_add_u32 m0, s45, 68608
    s_nop 0
    buffer_load_dwordx4 v35, s[8:11], s31 offen lds
    s_add_u32 m0, s46, 81920
    s_nop 0
    buffer_load_dwordx4 v36, s[12:15], s32 offen lds
    s_add_u32 m0, s46, 82944
    s_nop 0
    buffer_load_dwordx4 v37, s[12:15], s32 offen lds
    s_add_u32 m0, s46, 83968
    s_nop 0
    buffer_load_dwordx4 v38, s[12:15], s32 offen lds
    s_add_u32 m0, s46, 84992
    s_nop 0
    buffer_load_dwordx4 v39, s[12:15], s32 offen lds
    s_lshl_b32 s31, s52, 7
    s_add_u32 s31, s31, s53
    s_mul_i32 s32, s52, 229376
    s_add_u32 s32, s32, s54
    s_add_u32 s52, s52, 1
    s_cmp_eq_u32 s52, 8
    s_cselect_b32 s52, 0, s52
    s_add_u32 m0, s45, 98304
    s_nop 0
    buffer_load_dwordx4 v32, s[8:11], s31 offen lds
    s_add_u32 m0, s45, 99328
    s_nop 0
    buffer_load_dwordx4 v33, s[8:11], s31 offen lds
    s_add_u32 m0, s45, 100352
    s_nop 0
    buffer_load_dwordx4 v34, s[8:11], s31 offen lds
    s_add_u32 m0, s45, 101376
    s_nop 0
    buffer_load_dwordx4 v35, s[8:11], s31 offen lds
    s_add_u32 m0, s46, 114688
    s_nop 0
    buffer_load_dwordx4 v36, s[12:15], s32 offen lds
    s_add_u32 m0, s46, 115712
    s_nop 0
    buffer_load_dwordx4 v37, s[12:15], s32 offen lds
    s_add_u32 m0, s46, 116736
    s_nop 0
    buffer_load_dwordx4 v38, s[12:15], s32 offen lds
    s_add_u32 m0, s46, 117760
    s_nop 0
    buffer_load_dwordx4 v39, s[12:15], s32 offen lds
    s_waitcnt vmcnt(24)
    s_barrier
    ds_read_b128 v[60:63], v40 offset:0
    ds_read_b128 v[64:67], v40 offset:4096
    ds_read_b64_tr_b16 v[68:69], v52 offset:0
    ds_read_b64_tr_b16 v[70:71], v52 offset:1024
    ds_read_b64_tr_b16 v[72:73], v53 offset:0
    ds_read_b64_tr_b16 v[74:75], v53 offset:1024
    ds_read_b128 v[76:79], v41 offset:0
    ds_read_b128 v[80:83], v41 offset:4096
    ds_read_b64_tr_b16 v[84:85], v52 offset:4096
    ds_read_b64_tr_b16 v[86:87], v52 offset:5120
    ds_read_b64_tr_b16 v[88:89], v53 offset:4096
    ds_read_b64_tr_b16 v[90:91], v53 offset:5120
    s_lshl_b32 s31, s52, 7
    s_add_u32 s31, s31, s53
    s_mul_i32 s32, s52, 229376
    s_add_u32 s32, s32, s54
    s_add_u32 s52, s52, 1
    s_cmp_eq_u32 s52, 8
    s_cselect_b32 s52, 0, s52
    s_add_u32 m0, s45, 131072
    s_nop 0
    buffer_load_dwordx4 v32, s[8:11], s31 offen lds
    s_add_u32 m0, s45, 132096
    s_nop 0
    buffer_load_dwordx4 v33, s[8:11], s31 offen lds
    s_add_u32 m0, s45, 133120
    s_nop 0
    buffer_load_dwordx4 v34, s[8:11], s31 offen lds
    s_add_u32 m0, s45, 134144
    s_nop 0
    buffer_load_dwordx4 v35, s[8:11], s31 offen lds
    s_add_u32 m0, s46, 147456
    s_nop 0
    buffer_load_dwordx4 v36, s[12:15], s32 offen lds
    s_add_u32 m0, s46, 148480
    s_nop 0
    buffer_load_dwordx4 v37, s[12:15], s32 offen lds
    s_add_u32 m0, s46, 149504
    s_nop 0
    buffer_load_dwordx4 v38, s[12:15], s32 offen lds
    s_add_u32 m0, s46, 150528
    s_nop 0
    buffer_load_dwordx4 v39, s[12:15], s32 offen lds
    s_waitcnt lgkmcnt(6)
    v_mfma_f32_32x32x16_bf16 v[124:139], v[68:71], v[60:63], v[124:139]
    v_mfma_f32_32x32x16_bf16 v[140:155], v[72:75], v[60:63], v[140:155]
    v_mfma_f32_32x32x16_bf16 v[156:171], v[68:71], v[64:67], v[156:171]
    v_mfma_f32_32x32x16_bf16 v[172:187], v[72:75], v[64:67], v[172:187]
    ds_read_b128 v[92:95], v42 offset:0
    ds_read_b128 v[96:99], v42 offset:4096
    ds_read_b64_tr_b16 v[100:101], v52 offset:8192
    ds_read_b64_tr_b16 v[102:103], v52 offset:9216
    ds_read_b64_tr_b16 v[104:105], v53 offset:8192
    ds_read_b64_tr_b16 v[106:107], v53 offset:9216
    s_waitcnt lgkmcnt(6)
    v_mfma_f32_32x32x16_bf16 v[124:139], v[84:87], v[76:79], v[124:139]
    v_mfma_f32_32x32x16_bf16 v[140:155], v[88:91], v[76:79], v[140:155]
    v_mfma_f32_32x32x16_bf16 v[156:171], v[84:87], v[80:83], v[156:171]
    v_mfma_f32_32x32x16_bf16 v[172:187], v[88:91], v[80:83], v[172:187]
    ds_read_b128 v[108:111], v43 offset:0
    ds_read_b128 v[112:115], v43 offset:4096
    ds_read_b64_tr_b16 v[116:117], v52 offset:12288
    ds_read_b64_tr_b16 v[118:119], v52 offset:13312
    ds_read_b64_tr_b16 v[120:121], v53 offset:12288
    ds_read_b64_tr_b16 v[122:123], v53 offset:13312
    s_waitcnt lgkmcnt(6)
    v_mfma_f32_32x32x16_bf16 v[124:139], v[100:103], v[92:95], v[124:139]
    v_mfma_f32_32x32x16_bf16 v[140:155], v[104:107], v[92:95], v[140:155]
    v_mfma_f32_32x32x16_bf16 v[156:171], v[100:103], v[96:99], v[156:171]
    v_mfma_f32_32x32x16_bf16 v[172:187], v[104:107], v[96:99], v[172:187]
    s_waitcnt lgkmcnt(0)
    v_mfma_f32_32x32x16_bf16 v[124:139], v[116:119], v[108:111], v[124:139]
    v_mfma_f32_32x32x16_bf16 v[140:155], v[120:123], v[108:111], v[140:155]
    v_mfma_f32_32x32x16_bf16 v[156:171], v[116:119], v[112:115], v[156:171]
    v_mfma_f32_32x32x16_bf16 v[172:187], v[120:123], v[112:115], v[172:187]
    s_waitcnt vmcnt(24)
    s_barrier
    ds_read_b128 v[60:63], v40 offset:32768
    ds_read_b128 v[64:67], v40 offset:36864
    ds_read_b64_tr_b16 v[68:69], v52 offset:32768
    ds_read_b64_tr_b16 v[70:71], v52 offset:33792
    ds_read_b64_tr_b16 v[72:73], v53 offset:32768
    ds_read_b64_tr_b16 v[74:75], v53 offset:33792
    ds_read_b128 v[76:79], v41 offset:32768
    ds_read_b128 v[80:83], v41 offset:36864
    ds_read_b64_tr_b16 v[84:85], v52 offset:36864
    ds_read_b64_tr_b16 v[86:87], v52 offset:37888
    ds_read_b64_tr_b16 v[88:89], v53 offset:36864
    ds_read_b64_tr_b16 v[90:91], v53 offset:37888
    s_lshl_b32 s31, s52, 7
    s_add_u32 s31, s31, s53
    s_mul_i32 s32, s52, 229376
    s_add_u32 s32, s32, s54
    s_add_u32 s52, s52, 1
    s_cmp_eq_u32 s52, 8
    s_cselect_b32 s52, 0, s52
    s_add_u32 m0, s45, 0
    s_nop 0
    buffer_load_dwordx4 v32, s[8:11], s31 offen lds
    s_add_u32 m0, s45, 1024
    s_nop 0
    buffer_load_dwordx4 v33, s[8:11], s31 offen lds
    s_add_u32 m0, s45, 2048
    s_nop 0
    buffer_load_dwordx4 v34, s[8:11], s31 offen lds
    s_add_u32 m0, s45, 3072
    s_nop 0
    buffer_load_dwordx4 v35, s[8:11], s31 offen lds
    s_add_u32 m0, s46, 16384
    s_nop 0
    buffer_load_dwordx4 v36, s[12:15], s32 offen lds
    s_add_u32 m0, s46, 17408
    s_nop 0
    buffer_load_dwordx4 v37, s[12:15], s32 offen lds
    s_add_u32 m0, s46, 18432
    s_nop 0
    buffer_load_dwordx4 v38, s[12:15], s32 offen lds
    s_add_u32 m0, s46, 19456
    s_nop 0
    buffer_load_dwordx4 v39, s[12:15], s32 offen lds
    s_waitcnt lgkmcnt(6)
    v_mfma_f32_32x32x16_bf16 v[124:139], v[68:71], v[60:63], v[124:139]
    v_mfma_f32_32x32x16_bf16 v[140:155], v[72:75], v[60:63], v[140:155]
    v_mfma_f32_32x32x16_bf16 v[156:171], v[68:71], v[64:67], v[156:171]
    v_mfma_f32_32x32x16_bf16 v[172:187], v[72:75], v[64:67], v[172:187]
    ds_read_b128 v[92:95], v42 offset:32768
    ds_read_b128 v[96:99], v42 offset:36864
    ds_read_b64_tr_b16 v[100:101], v52 offset:40960
    ds_read_b64_tr_b16 v[102:103], v52 offset:41984
    ds_read_b64_tr_b16 v[104:105], v53 offset:40960
    ds_read_b64_tr_b16 v[106:107], v53 offset:41984
    s_waitcnt lgkmcnt(6)
    v_mfma_f32_32x32x16_bf16 v[124:139], v[84:87], v[76:79], v[124:139]
    v_mfma_f32_32x32x16_bf16 v[140:155], v[88:91], v[76:79], v[140:155]
    v_mfma_f32_32x32x16_bf16 v[156:171], v[84:87], v[80:83], v[156:171]
    v_mfma_f32_32x32x16_bf16 v[172:187], v[88:91], v[80:83], v[172:187]
    ds_read_b128 v[108:111], v43 offset:32768
    ds_read_b128 v[112:115], v43 offset:36864
    ds_read_b64_tr_b16 v[116:117], v52 offset:45056
    ds_read_b64_tr_b16 v[118:119], v52 offset:46080
    ds_read_b64_tr_b16 v[120:121], v53 offset:45056
    ds_read_b64_tr_b16 v[122:123], v53 offset:46080
    s_waitcnt lgkmcnt(6)
    v_mfma_f32_32x32x16_bf16 v[124:139], v[100:103], v[92:95], v[124:139]
    v_mfma_f32_32x32x16_bf16 v[140:155], v[104:107], v[92:95], v[140:155]
    v_mfma_f32_32x32x16_bf16 v[156:171], v[100:103], v[96:99], v[156:171]
    v_mfma_f32_32x32x16_bf16 v[172:187], v[104:107], v[96:99], v[172:187]
    s_waitcnt lgkmcnt(0)
    v_mfma_f32_32x32x16_bf16 v[124:139], v[116:119], v[108:111], v[124:139]
    v_mfma_f32_32x32x16_bf16 v[140:155], v[120:123], v[108:111], v[140:155]
    v_mfma_f32_32x32x16_bf16 v[156:171], v[116:119], v[112:115], v[156:171]
    v_mfma_f32_32x32x16_bf16 v[172:187], v[120:123], v[112:115], v[172:187]
    s_waitcnt vmcnt(24)
    s_barrier
    ds_read_b128 v[60:63], v44 offset:0
    ds_read_b128 v[64:67], v44 offset:4096
    ds_read_b64_tr_b16 v[68:69], v54 offset:0
    ds_read_b64_tr_b16 v[70:71], v54 offset:1024
    ds_read_b64_tr_b16 v[72:73], v55 offset:0
    ds_read_b64_tr_b16 v[74:75], v55 offset:1024
    ds_read_b128 v[76:79], v45 offset:0
    ds_read_b128 v[80:83], v45 offset:4096
    ds_read_b64_tr_b16 v[84:85], v54 offset:4096
    ds_read_b64_tr_b16 v[86:87], v54 offset:5120
    ds_read_b64_tr_b16 v[88:89], v55 offset:4096
    ds_read_b64_tr_b16 v[90:91], v55 offset:5120
    s_lshl_b32 s31, s52, 7
    s_add_u32 s31, s31, s53
    s_mul_i32 s32, s52, 229376
    s_add_u32 s32, s32, s54
    s_add_u32 s52, s52, 1
    s_cmp_eq_u32 s52, 8
    s_cselect_b32 s52, 0, s52
    s_add_u32 m0, s45, 32768
    s_nop 0
    buffer_load_dwordx4 v32, s[8:11], s31 offen lds
    s_add_u32 m0, s45, 33792
    s_nop 0
    buffer_load_dwordx4 v33, s[8:11], s31 offen lds
    s_add_u32 m0, s45, 34816
    s_nop 0
    buffer_load_dwordx4 v34, s[8:11], s31 offen lds
    s_add_u32 m0, s45, 35840
    s_nop 0
    buffer_load_dwordx4 v35, s[8:11], s31 offen lds
    s_add_u32 m0, s46, 49152
    s_nop 0
    buffer_load_dwordx4 v36, s[12:15], s32 offen lds
    s_add_u32 m0, s46, 50176
    s_nop 0
    buffer_load_dwordx4 v37, s[12:15], s32 offen lds
    s_add_u32 m0, s46, 51200
    s_nop 0
    buffer_load_dwordx4 v38, s[12:15], s32 offen lds
    s_add_u32 m0, s46, 52224
    s_nop 0
    buffer_load_dwordx4 v39, s[12:15], s32 offen lds
    s_waitcnt lgkmcnt(6)
    v_mfma_f32_32x32x16_bf16 v[124:139], v[68:71], v[60:63], v[124:139]
    v_mfma_f32_32x32x16_bf16 v[140:155], v[72:75], v[60:63], v[140:155]
    v_mfma_f32_32x32x16_bf16 v[156:171], v[68:71], v[64:67], v[156:171]
    v_mfma_f32_32x32x16_bf16 v[172:187], v[72:75], v[64:67], v[172:187]
    ds_read_b128 v[92:95], v46 offset:0
    ds_read_b128 v[96:99], v46 offset:4096
    ds_read_b64_tr_b16 v[100:101], v54 offset:8192
    ds_read_b64_tr_b16 v[102:103], v54 offset:9216
    ds_read_b64_tr_b16 v[104:105], v55 offset:8192
    ds_read_b64_tr_b16 v[106:107], v55 offset:9216
    s_waitcnt lgkmcnt(6)
    v_mfma_f32_32x32x16_bf16 v[124:139], v[84:87], v[76:79], v[124:139]
    v_mfma_f32_32x32x16_bf16 v[140:155], v[88:91], v[76:79], v[140:155]
    v_mfma_f32_32x32x16_bf16 v[156:171], v[84:87], v[80:83], v[156:171]
    v_mfma_f32_32x32x16_bf16 v[172:187], v[88:91], v[80:83], v[172:187]
    ds_read_b128 v[108:111], v47 offset:0
    ds_read_b128 v[112:115], v47 offset:4096
    ds_read_b64_tr_b16 v[116:117], v54 offset:12288
    ds_read_b64_tr_b16 v[118:119], v54 offset:13312
    ds_read_b64_tr_b16 v[120:121], v55 offset:12288
    ds_read_b64_tr_b16 v[122:123], v55 offset:13312
    s_waitcnt lgkmcnt(6)
    v_mfma_f32_32x32x16_bf16 v[124:139], v[100:103], v[92:95], v[124:139]
    v_mfma_f32_32x32x16_bf16 v[140:155], v[104:107], v[92:95], v[140:155]
    v_mfma_f32_32x32x16_bf16 v[156:171], v[100:103], v[96:99], v[156:171]
    v_mfma_f32_32x32x16_bf16 v[172:187], v[104:107], v[96:99], v[172:187]
    s_waitcnt lgkmcnt(0)
    v_mfma_f32_32x32x16_bf16 v[124:139], v[116:119], v[108:111], v[124:139]
    v_mfma_f32_32x32x16_bf16 v[140:155], v[120:123], v[108:111], v[140:155]
    v_mfma_f32_32x32x16_bf16 v[156:171], v[116:119], v[112:115], v[156:171]
    v_mfma_f32_32x32x16_bf16 v[172:187], v[120:123], v[112:115], v[172:187]
    s_waitcnt vmcnt(24)
    s_barrier
    ds_read_b128 v[60:63], v44 offset:32768
    ds_read_b128 v[64:67], v44 offset:36864
    ds_read_b64_tr_b16 v[68:69], v54 offset:32768
    ds_read_b64_tr_b16 v[70:71], v54 offset:33792
    ds_read_b64_tr_b16 v[72:73], v55 offset:32768
    ds_read_b64_tr_b16 v[74:75], v55 offset:33792
    ds_read_b128 v[76:79], v45 offset:32768
    ds_read_b128 v[80:83], v45 offset:36864
    ds_read_b64_tr_b16 v[84:85], v54 offset:36864
    ds_read_b64_tr_b16 v[86:87], v54 offset:37888
    ds_read_b64_tr_b16 v[88:89], v55 offset:36864
    ds_read_b64_tr_b16 v[90:91], v55 offset:37888
    s_lshl_b32 s31, s52, 7
    s_add_u32 s31, s31, s53
    s_mul_i32 s32, s52, 229376
    s_add_u32 s32, s32, s54
    s_add_u32 s52, s52, 1
    s_cmp_eq_u32 s52, 8
    s_cselect_b32 s52, 0, s52
    s_add_u32 m0, s45, 65536
    s_nop 0
    buffer_load_dwordx4 v32, s[8:11], s31 offen lds
    s_add_u32 m0, s45, 66560
    s_nop 0
    buffer_load_dwordx4 v33, s[8:11], s31 offen lds
    s_add_u32 m0, s45, 67584
    s_nop 0
    buffer_load_dwordx4 v34, s[8:11], s31 offen lds
    s_add_u32 m0, s45, 68608
    s_nop 0
    buffer_load_dwordx4 v35, s[8:11], s31 offen lds
    s_add_u32 m0, s46, 81920
    s_nop 0
    buffer_load_dwordx4 v36, s[12:15], s32 offen lds
    s_add_u32 m0, s46, 82944
    s_nop 0
    buffer_load_dwordx4 v37, s[12:15], s32 offen lds
    s_add_u32 m0, s46, 83968
    s_nop 0
    buffer_load_dwordx4 v38, s[12:15], s32 offen lds
    s_add_u32 m0, s46, 84992
    s_nop 0
    buffer_load_dwordx4 v39, s[12:15], s32 offen lds
    s_waitcnt lgkmcnt(6)
    v_mfma_f32_32x32x16_bf16 v[124:139], v[68:71], v[60:63], v[124:139]
    v_mfma_f32_32x32x16_bf16 v[140:155], v[72:75], v[60:63], v[140:155]
    v_mfma_f32_32x32x16_bf16 v[156:171], v[68:71], v[64:67], v[156:171]
    v_mfma_f32_32x32x16_bf16 v[172:187], v[72:75], v[64:67], v[172:187]
    ds_read_b128 v[92:95], v46 offset:32768
    ds_read_b128 v[96:99], v46 offset:36864
    ds_read_b64_tr_b16 v[100:101], v54 offset:40960
    ds_read_b64_tr_b16 v[102:103], v54 offset:41984
    ds_read_b64_tr_b16 v[104:105], v55 offset:40960
    ds_read_b64_tr_b16 v[106:107], v55 offset:41984
    s_waitcnt lgkmcnt(6)
    v_mfma_f32_32x32x16_bf16 v[124:139], v[84:87], v[76:79], v[124:139]
    v_mfma_f32_32x32x16_bf16 v[140:155], v[88:91], v[76:79], v[140:155]
    v_mfma_f32_32x32x16_bf16 v[156:171], v[84:87], v[80:83], v[156:171]
    v_mfma_f32_32x32x16_bf16 v[172:187], v[88:91], v[80:83], v[172:187]
    ds_read_b128 v[108:111], v47 offset:32768
    ds_read_b128 v[112:115], v47 offset:36864
    ds_read_b64_tr_b16 v[116:117], v54 offset:45056
    ds_read_b64_tr_b16 v[118:119], v54 offset:46080
    ds_read_b64_tr_b16 v[120:121], v55 offset:45056
    ds_read_b64_tr_b16 v[122:123], v55 offset:46080
    s_waitcnt lgkmcnt(6)
    v_mfma_f32_32x32x16_bf16 v[124:139], v[100:103], v[92:95], v[124:139]
    v_mfma_f32_32x32x16_bf16 v[140:155], v[104:107], v[92:95], v[140:155]
    v_mfma_f32_32x32x16_bf16 v[156:171], v[100:103], v[96:99], v[156:171]
    v_mfma_f32_32x32x16_bf16 v[172:187], v[104:107], v[96:99], v[172:187]
    s_waitcnt lgkmcnt(0)
    v_mfma_f32_32x32x16_bf16 v[124:139], v[116:119], v[108:111], v[124:139]
    v_mfma_f32_32x32x16_bf16 v[140:155], v[120:123], v[108:111], v[140:155]
    v_mfma_f32_32x32x16_bf16 v[156:171], v[116:119], v[112:115], v[156:171]
    v_mfma_f32_32x32x16_bf16 v[172:187], v[120:123], v[112:115], v[172:187]
    s_waitcnt vmcnt(24)
    s_barrier
    ds_read_b128 v[60:63], v48 offset:0
    ds_read_b128 v[64:67], v48 offset:4096
    ds_read_b64_tr_b16 v[68:69], v56 offset:0
    ds_read_b64_tr_b16 v[70:71], v56 offset:1024
    ds_read_b64_tr_b16 v[72:73], v57 offset:0
    ds_read_b64_tr_b16 v[74:75], v57 offset:1024
    ds_read_b128 v[76:79], v49 offset:0
    ds_read_b128 v[80:83], v49 offset:4096
    ds_read_b64_tr_b16 v[84:85], v56 offset:4096
    ds_read_b64_tr_b16 v[86:87], v56 offset:5120
    ds_read_b64_tr_b16 v[88:89], v57 offset:4096
    ds_read_b64_tr_b16 v[90:91], v57 offset:5120
    s_waitcnt lgkmcnt(6)
    v_mfma_f32_32x32x16_bf16 v[124:139], v[68:71], v[60:63], v[124:139]
    v_mfma_f32_32x32x16_bf16 v[140:155], v[72:75], v[60:63], v[140:155]
    v_mfma_f32_32x32x16_bf16 v[156:171], v[68:71], v[64:67], v[156:171]
    v_mfma_f32_32x32x16_bf16 v[172:187], v[72:75], v[64:67], v[172:187]
    ds_read_b128 v[92:95], v50 offset:0
    ds_read_b128 v[96:99], v50 offset:4096
    ds_read_b64_tr_b16 v[100:101], v56 offset:8192
    ds_read_b64_tr_b16 v[102:103], v56 offset:9216
    ds_read_b64_tr_b16 v[104:105], v57 offset:8192
    ds_read_b64_tr_b16 v[106:107], v57 offset:9216
    s_waitcnt lgkmcnt(6)
    v_mfma_f32_32x32x16_bf16 v[124:139], v[84:87], v[76:79], v[124:139]
    v_mfma_f32_32x32x16_bf16 v[140:155], v[88:91], v[76:79], v[140:155]
    v_mfma_f32_32x32x16_bf16 v[156:171], v[84:87], v[80:83], v[156:171]
    v_mfma_f32_32x32x16_bf16 v[172:187], v[88:91], v[80:83], v[172:187]
    ds_read_b128 v[108:111], v51 offset:0
    ds_read_b128 v[112:115], v51 offset:4096
    ds_read_b64_tr_b16 v[116:117], v56 offset:12288
    ds_read_b64_tr_b16 v[118:119], v56 offset:13312
    ds_read_b64_tr_b16 v[120:121], v57 offset:12288
    ds_read_b64_tr_b16 v[122:123], v57 offset:13312
    s_waitcnt lgkmcnt(6)
    v_mfma_f32_32x32x16_bf16 v[124:139], v[100:103], v[92:95], v[124:139]
    v_mfma_f32_32x32x16_bf16 v[140:155], v[104:107], v[92:95], v[140:155]
    v_mfma_f32_32x32x16_bf16 v[156:171], v[100:103], v[96:99], v[156:171]
    v_mfma_f32_32x32x16_bf16 v[172:187], v[104:107], v[96:99], v[172:187]
    s_waitcnt lgkmcnt(0)
    v_mfma_f32_32x32x16_bf16 v[124:139], v[116:119], v[108:111], v[124:139]
    v_mfma_f32_32x32x16_bf16 v[140:155], v[120:123], v[108:111], v[140:155]
    v_mfma_f32_32x32x16_bf16 v[156:171], v[116:119], v[112:115], v[156:171]
    v_mfma_f32_32x32x16_bf16 v[172:187], v[120:123], v[112:115], v[172:187]
    s_waitcnt vmcnt(16)
    s_barrier
    ds_read_b128 v[60:63], v40 offset:0
    ds_read_b128 v[64:67], v40 offset:4096
    ds_read_b64_tr_b16 v[68:69], v52 offset:0
    ds_read_b64_tr_b16 v[70:71], v52 offset:1024
    ds_read_b64_tr_b16 v[72:73], v53 offset:0
    ds_read_b64_tr_b16 v[74:75], v53 offset:1024
    ds_read_b128 v[76:79], v41 offset:0
    ds_read_b128 v[80:83], v41 offset:4096
    ds_read_b64_tr_b16 v[84:85], v52 offset:4096
    ds_read_b64_tr_b16 v[86:87], v52 offset:5120
    ds_read_b64_tr_b16 v[88:89], v53 offset:4096
    ds_read_b64_tr_b16 v[90:91], v53 offset:5120
    s_waitcnt lgkmcnt(6)
    v_mfma_f32_32x32x16_bf16 v[124:139], v[68:71], v[60:63], v[124:139]
    v_mfma_f32_32x32x16_bf16 v[140:155], v[72:75], v[60:63], v[140:155]
    v_mfma_f32_32x32x16_bf16 v[156:171], v[68:71], v[64:67], v[156:171]
    v_mfma_f32_32x32x16_bf16 v[172:187], v[72:75], v[64:67], v[172:187]
    ds_read_b128 v[92:95], v42 offset:0
    ds_read_b128 v[96:99], v42 offset:4096
    ds_read_b64_tr_b16 v[100:101], v52 offset:8192
    ds_read_b64_tr_b16 v[102:103], v52 offset:9216
    ds_read_b64_tr_b16 v[104:105], v53 offset:8192
    ds_read_b64_tr_b16 v[106:107], v53 offset:9216
    s_waitcnt lgkmcnt(6)
    v_mfma_f32_32x32x16_bf16 v[124:139], v[84:87], v[76:79], v[124:139]
    v_mfma_f32_32x32x16_bf16 v[140:155], v[88:91], v[76:79], v[140:155]
    v_mfma_f32_32x32x16_bf16 v[156:171], v[84:87], v[80:83], v[156:171]
    v_mfma_f32_32x32x16_bf16 v[172:187], v[88:91], v[80:83], v[172:187]
    ds_read_b128 v[108:111], v43 offset:0
    ds_read_b128 v[112:115], v43 offset:4096
    ds_read_b64_tr_b16 v[116:117], v52 offset:12288
    ds_read_b64_tr_b16 v[118:119], v52 offset:13312
    ds_read_b64_tr_b16 v[120:121], v53 offset:12288
    ds_read_b64_tr_b16 v[122:123], v53 offset:13312
    s_waitcnt lgkmcnt(6)
    v_mfma_f32_32x32x16_bf16 v[124:139], v[100:103], v[92:95], v[124:139]
    v_mfma_f32_32x32x16_bf16 v[140:155], v[104:107], v[92:95], v[140:155]
    v_mfma_f32_32x32x16_bf16 v[156:171], v[100:103], v[96:99], v[156:171]
    v_mfma_f32_32x32x16_bf16 v[172:187], v[104:107], v[96:99], v[172:187]
    s_waitcnt lgkmcnt(0)
    v_mfma_f32_32x32x16_bf16 v[124:139], v[116:119], v[108:111], v[124:139]
    v_mfma_f32_32x32x16_bf16 v[140:155], v[120:123], v[108:111], v[140:155]
    v_mfma_f32_32x32x16_bf16 v[156:171], v[116:119], v[112:115], v[156:171]
    v_mfma_f32_32x32x16_bf16 v[172:187], v[120:123], v[112:115], v[172:187]
    s_waitcnt vmcnt(8)
    s_barrier
    ds_read_b128 v[60:63], v40 offset:32768
    ds_read_b128 v[64:67], v40 offset:36864
    ds_read_b64_tr_b16 v[68:69], v52 offset:32768
    ds_read_b64_tr_b16 v[70:71], v52 offset:33792
    ds_read_b64_tr_b16 v[72:73], v53 offset:32768
    ds_read_b64_tr_b16 v[74:75], v53 offset:33792
    ds_read_b128 v[76:79], v41 offset:32768
    ds_read_b128 v[80:83], v41 offset:36864
    ds_read_b64_tr_b16 v[84:85], v52 offset:36864
    ds_read_b64_tr_b16 v[86:87], v52 offset:37888
    ds_read_b64_tr_b16 v[88:89], v53 offset:36864
    ds_read_b64_tr_b16 v[90:91], v53 offset:37888
    s_waitcnt lgkmcnt(6)
    v_mfma_f32_32x32x16_bf16 v[124:139], v[68:71], v[60:63], v[124:139]
    v_mfma_f32_32x32x16_bf16 v[140:155], v[72:75], v[60:63], v[140:155]
    v_mfma_f32_32x32x16_bf16 v[156:171], v[68:71], v[64:67], v[156:171]
    v_mfma_f32_32x32x16_bf16 v[172:187], v[72:75], v[64:67], v[172:187]
    ds_read_b128 v[92:95], v42 offset:32768
    ds_read_b128 v[96:99], v42 offset:36864
    ds_read_b64_tr_b16 v[100:101], v52 offset:40960
    ds_read_b64_tr_b16 v[102:103], v52 offset:41984
    ds_read_b64_tr_b16 v[104:105], v53 offset:40960
    ds_read_b64_tr_b16 v[106:107], v53 offset:41984
    s_waitcnt lgkmcnt(6)
    v_mfma_f32_32x32x16_bf16 v[124:139], v[84:87], v[76:79], v[124:139]
    v_mfma_f32_32x32x16_bf16 v[140:155], v[88:91], v[76:79], v[140:155]
    v_mfma_f32_32x32x16_bf16 v[156:171], v[84:87], v[80:83], v[156:171]
    v_mfma_f32_32x32x16_bf16 v[172:187], v[88:91], v[80:83], v[172:187]
    ds_read_b128 v[108:111], v43 offset:32768
    ds_read_b128 v[112:115], v43 offset:36864
    ds_read_b64_tr_b16 v[116:117], v52 offset:45056
    ds_read_b64_tr_b16 v[118:119], v52 offset:46080
    ds_read_b64_tr_b16 v[120:121], v53 offset:45056
    ds_read_b64_tr_b16 v[122:123], v53 offset:46080
    s_waitcnt lgkmcnt(6)
    v_mfma_f32_32x32x16_bf16 v[124:139], v[100:103], v[92:95], v[124:139]
    v_mfma_f32_32x32x16_bf16 v[140:155], v[104:107], v[92:95], v[140:155]
    v_mfma_f32_32x32x16_bf16 v[156:171], v[100:103], v[96:99], v[156:171]
    v_mfma_f32_32x32x16_bf16 v[172:187], v[104:107], v[96:99], v[172:187]
    s_waitcnt lgkmcnt(0)
    v_mfma_f32_32x32x16_bf16 v[124:139], v[116:119], v[108:111], v[124:139]
    v_mfma_f32_32x32x16_bf16 v[140:155], v[120:123], v[108:111], v[140:155]
    v_mfma_f32_32x32x16_bf16 v[156:171], v[116:119], v[112:115], v[156:171]
    v_mfma_f32_32x32x16_bf16 v[172:187], v[120:123], v[112:115], v[172:187]
    s_waitcnt vmcnt(0)
    s_barrier
    ds_read_b128 v[60:63], v44 offset:0
    ds_read_b128 v[64:67], v44 offset:4096
    ds_read_b64_tr_b16 v[68:69], v54 offset:0
    ds_read_b64_tr_b16 v[70:71], v54 offset:1024
    ds_read_b64_tr_b16 v[72:73], v55 offset:0
    ds_read_b64_tr_b16 v[74:75], v55 offset:1024
    ds_read_b128 v[76:79], v45 offset:0
    ds_read_b128 v[80:83], v45 offset:4096
    ds_read_b64_tr_b16 v[84:85], v54 offset:4096
    ds_read_b64_tr_b16 v[86:87], v54 offset:5120
    ds_read_b64_tr_b16 v[88:89], v55 offset:4096
    ds_read_b64_tr_b16 v[90:91], v55 offset:5120
    s_waitcnt lgkmcnt(6)
    v_mfma_f32_32x32x16_bf16 v[124:139], v[68:71], v[60:63], v[124:139]
    v_mfma_f32_32x32x16_bf16 v[140:155], v[72:75], v[60:63], v[140:155]
    v_mfma_f32_32x32x16_bf16 v[156:171], v[68:71], v[64:67], v[156:171]
    v_mfma_f32_32x32x16_bf16 v[172:187], v[72:75], v[64:67], v[172:187]
    ds_read_b128 v[92:95], v46 offset:0
    ds_read_b128 v[96:99], v46 offset:4096
    ds_read_b64_tr_b16 v[100:101], v54 offset:8192
    ds_read_b64_tr_b16 v[102:103], v54 offset:9216
    ds_read_b64_tr_b16 v[104:105], v55 offset:8192
    ds_read_b64_tr_b16 v[106:107], v55 offset:9216
    s_waitcnt lgkmcnt(6)
    v_mfma_f32_32x32x16_bf16 v[124:139], v[84:87], v[76:79], v[124:139]
    v_mfma_f32_32x32x16_bf16 v[140:155], v[88:91], v[76:79], v[140:155]
    v_mfma_f32_32x32x16_bf16 v[156:171], v[84:87], v[80:83], v[156:171]
    v_mfma_f32_32x32x16_bf16 v[172:187], v[88:91], v[80:83], v[172:187]
    ds_read_b128 v[108:111], v47 offset:0
    ds_read_b128 v[112:115], v47 offset:4096
    ds_read_b64_tr_b16 v[116:117], v54 offset:12288
    ds_read_b64_tr_b16 v[118:119], v54 offset:13312
    ds_read_b64_tr_b16 v[120:121], v55 offset:12288
    ds_read_b64_tr_b16 v[122:123], v55 offset:13312
    s_waitcnt lgkmcnt(6)
    v_mfma_f32_32x32x16_bf16 v[124:139], v[100:103], v[92:95], v[124:139]
    v_mfma_f32_32x32x16_bf16 v[140:155], v[104:107], v[92:95], v[140:155]
    v_mfma_f32_32x32x16_bf16 v[156:171], v[100:103], v[96:99], v[156:171]
    v_mfma_f32_32x32x16_bf16 v[172:187], v[104:107], v[96:99], v[172:187]
    s_waitcnt lgkmcnt(0)
    v_mfma_f32_32x32x16_bf16 v[124:139], v[116:119], v[108:111], v[124:139]
    v_mfma_f32_32x32x16_bf16 v[140:155], v[120:123], v[108:111], v[140:155]
    v_mfma_f32_32x32x16_bf16 v[156:171], v[116:119], v[112:115], v[156:171]
    v_mfma_f32_32x32x16_bf16 v[172:187], v[120:123], v[112:115], v[172:187]
    s_nop 7
    s_nop 7
    s_mul_i32 s5, s41, 64
    s_add_u32 s4, s33, s5
    v_add_u32 v28, s4, v24
    s_mov_b32 s5, 1792
    v_mul_lo_u32 v28, v28, s5
    s_mul_i32 s5, s42, 64
    s_add_u32 s5, s5, s34
    v_add_u32 v28, s5, v28

    v_lshl_add_u32 v28, v25, 3, v28
    v_lshlrev_b32 v28, 1, v28
    v_max_f32 v124, 0, v124
    v_max_f32 v125, 0, v125
    v_cvt_pk_bf16_f32 v124, v124, v125
    v_max_f32 v126, 0, v126
    v_max_f32 v127, 0, v127
    v_cvt_pk_bf16_f32 v125, v126, v127
    v_max_f32 v128, 0, v128
    v_max_f32 v129, 0, v129
    v_cvt_pk_bf16_f32 v126, v128, v129
    v_max_f32 v130, 0, v130
    v_max_f32 v131, 0, v131
    v_cvt_pk_bf16_f32 v127, v130, v131
    v_max_f32 v132, 0, v132
    v_max_f32 v133, 0, v133
    v_cvt_pk_bf16_f32 v128, v132, v133
    v_max_f32 v134, 0, v134
    v_max_f32 v135, 0, v135
    v_cvt_pk_bf16_f32 v129, v134, v135
    v_max_f32 v136, 0, v136
    v_max_f32 v137, 0, v137
    v_cvt_pk_bf16_f32 v130, v136, v137
    v_max_f32 v138, 0, v138
    v_max_f32 v139, 0, v139
    v_cvt_pk_bf16_f32 v131, v138, v139
    s_mov_b32 s4, 0
    buffer_store_dwordx4 v[124:127], v28, s[16:19], s4 offen offset:0
    buffer_store_dwordx4 v[128:131], v28, s[16:19], s4 offen offset:32
    v_max_f32 v140, 0, v140
    v_max_f32 v141, 0, v141
    v_cvt_pk_bf16_f32 v140, v140, v141
    v_max_f32 v142, 0, v142
    v_max_f32 v143, 0, v143
    v_cvt_pk_bf16_f32 v141, v142, v143
    v_max_f32 v144, 0, v144
    v_max_f32 v145, 0, v145
    v_cvt_pk_bf16_f32 v142, v144, v145
    v_max_f32 v146, 0, v146
    v_max_f32 v147, 0, v147
    v_cvt_pk_bf16_f32 v143, v146, v147
    v_max_f32 v148, 0, v148
    v_max_f32 v149, 0, v149
    v_cvt_pk_bf16_f32 v144, v148, v149
    v_max_f32 v150, 0, v150
    v_max_f32 v151, 0, v151
    v_cvt_pk_bf16_f32 v145, v150, v151
    v_max_f32 v152, 0, v152
    v_max_f32 v153, 0, v153
    v_cvt_pk_bf16_f32 v146, v152, v153
    v_max_f32 v154, 0, v154
    v_max_f32 v155, 0, v155
    v_cvt_pk_bf16_f32 v147, v154, v155
    s_mov_b32 s4, 64
    buffer_store_dwordx4 v[140:143], v28, s[16:19], s4 offen offset:0
    buffer_store_dwordx4 v[144:147], v28, s[16:19], s4 offen offset:32
    v_max_f32 v156, 0, v156
    v_max_f32 v157, 0, v157
    v_cvt_pk_bf16_f32 v156, v156, v157
    v_max_f32 v158, 0, v158
    v_max_f32 v159, 0, v159
    v_cvt_pk_bf16_f32 v157, v158, v159
    v_max_f32 v160, 0, v160
    v_max_f32 v161, 0, v161
    v_cvt_pk_bf16_f32 v158, v160, v161
    v_max_f32 v162, 0, v162
    v_max_f32 v163, 0, v163
    v_cvt_pk_bf16_f32 v159, v162, v163
    v_max_f32 v164, 0, v164
    v_max_f32 v165, 0, v165
    v_cvt_pk_bf16_f32 v160, v164, v165
    v_max_f32 v166, 0, v166
    v_max_f32 v167, 0, v167
    v_cvt_pk_bf16_f32 v161, v166, v167
    v_max_f32 v168, 0, v168
    v_max_f32 v169, 0, v169
    v_cvt_pk_bf16_f32 v162, v168, v169
    v_max_f32 v170, 0, v170
    v_max_f32 v171, 0, v171
    v_cvt_pk_bf16_f32 v163, v170, v171
    s_mov_b32 s4, 114688
    buffer_store_dwordx4 v[156:159], v28, s[16:19], s4 offen offset:0
    buffer_store_dwordx4 v[160:163], v28, s[16:19], s4 offen offset:32
    v_max_f32 v172, 0, v172
    v_max_f32 v173, 0, v173
    v_cvt_pk_bf16_f32 v172, v172, v173
    v_max_f32 v174, 0, v174
    v_max_f32 v175, 0, v175
    v_cvt_pk_bf16_f32 v173, v174, v175
    v_max_f32 v176, 0, v176
    v_max_f32 v177, 0, v177
    v_cvt_pk_bf16_f32 v174, v176, v177
    v_max_f32 v178, 0, v178
    v_max_f32 v179, 0, v179
    v_cvt_pk_bf16_f32 v175, v178, v179
    v_max_f32 v180, 0, v180
    v_max_f32 v181, 0, v181
    v_cvt_pk_bf16_f32 v176, v180, v181
    v_max_f32 v182, 0, v182
    v_max_f32 v183, 0, v183
    v_cvt_pk_bf16_f32 v177, v182, v183
    v_max_f32 v184, 0, v184
    v_max_f32 v185, 0, v185
    v_cvt_pk_bf16_f32 v178, v184, v185
    v_max_f32 v186, 0, v186
    v_max_f32 v187, 0, v187
    v_cvt_pk_bf16_f32 v179, v186, v187
    s_mov_b32 s4, 114752
    buffer_store_dwordx4 v[172:175], v28, s[16:19], s4 offen offset:0
    buffer_store_dwordx4 v[176:179], v28, s[16:19], s4 offen offset:32
g_done_11:
    s_endpgm
.globl ffn2_kernel
.p2align 8
.type ffn2_kernel,@function
ffn2_kernel:
    s_cmp_ge_u32 s2, 256
    s_cbranch_scc1 g_done_12
    v_and_b32 v26, 63, v0
    v_and_b32 v24, 31, v0
    v_bfe_u32 v25, v0, 5, 1
    v_lshrrev_b32 v1, 6, v0
    s_nop 0
    v_readfirstlane_b32 s40, v1
    s_nop 3
    s_lshr_b32 s41, s40, 1
    s_and_b32 s42, s40, 1

    s_and_b32 s33, s2, 7
    s_lshl_b32 s33, s33, 2
    s_lshr_b32 s4, s2, 3
    s_and_b32 s4, s4, 3
    s_add_u32 s33, s33, s4
    s_mul_i32 s33, s33, 64
    s_lshr_b32 s37, s2, 5
    s_mul_i32 s34, s37, 64
    s_mov_b32 s31, 0
    s_mov_b32 s32, 0

    s_load_dwordx2 s[8:9], s[0:1], 104
    s_mov_b32 s10, 7340032
    s_mov_b32 s11, 0x00020000
    s_load_dwordx2 s[12:13], s[0:1], 64
    s_mov_b32 s14, 1835008
    s_mov_b32 s15, 0x00020000
    s_load_dwordx2 s[16:17], s[0:1], 88
    s_mov_b32 s18, 2097152
    s_mov_b32 s19, 0x00020000
    s_load_dwordx2 s[20:21], s[0:1], 104
    s_mov_b32 s22, 4194304
    s_mov_b32 s23, 0x00020000
    s_load_dwordx2 s[24:25], s[0:1], 104
    s_mov_b32 s26, 12288
    s_mov_b32 s27, 0x00020000
    s_waitcnt lgkmcnt(0)
    s_add_u32 s8, s8, 92274688
    s_addc_u32 s9, s9, 0
    s_add_u32 s20, s20, 83886080
    s_addc_u32 s21, s21, 0
    v_lshrrev_b32 v1, 3, v26
    v_lshrrev_b32 v2, 4, v26
    v_and_b32 v3, 7, v26
    s_mul_i32 s4, s40, 2
    s_mov_b32 s5, 3584

    s_add_u32 s6, s4, 0
    s_lshl_b32 s7, s6, 2
    v_add_u32 v4, s7, v2
    v_and_b32 v4, 7, v4
    v_xor_b32 v4, v4, v3
    s_lshl_b32 s7, s6, 3
    s_add_u32 s7, s7, s33
    v_add_u32 v5, s7, v1
    v_mul_lo_u32 v5, v5, s5
    v_lshl_add_u32 v32, v4, 4, v5

    s_add_u32 s6, s4, 1
    s_lshl_b32 s7, s6, 2
    v_add_u32 v4, s7, v2
    v_and_b32 v4, 7, v4
    v_xor_b32 v4, v4, v3
    s_lshl_b32 s7, s6, 3
    s_add_u32 s7, s7, s33
    v_add_u32 v5, s7, v1
    v_mul_lo_u32 v5, v5, s5
    v_lshl_add_u32 v33, v4, 4, v5

    s_mul_i32 s4, s40, 2
    s_mov_b32 s5, 1024
    s_lshl_b32 s44, s34, 1
    v_lshlrev_b32 v1, 4, v26

    s_add_u32 s6, s4, 0
    s_lshl_b32 s6, s6, 10
    v_add_u32 v2, s6, v1
    v_lshrrev_b32 v3, 7, v2
    v_and_b32 v4, 127, v2

    v_bfe_u32 v5, v3, 1, 1
    v_lshlrev_b32 v5, 6, v5
    v_xor_b32 v4, v4, v5
    v_and_b32 v5, 4, v3
    v_and_b32 v6, 8, v3
    v_and_b32 v3, 0xfffffff3, v3
    v_lshl_add_u32 v3, v5, 1, v3
    v_lshrrev_b32 v6, 1, v6
    v_add_u32 v3, v3, v6

    v_mul_lo_u32 v3, v3, s5
    v_add_u32 v3, v3, v4
    v_add_u32 v34, s44, v3
    s_add_u32 s6, s4, 1
    s_lshl_b32 s6, s6, 10
    v_add_u32 v2, s6, v1
    v_lshrrev_b32 v3, 7, v2
    v_and_b32 v4, 127, v2

    v_bfe_u32 v5, v3, 1, 1
    v_lshlrev_b32 v5, 6, v5
    v_xor_b32 v4, v4, v5
    v_and_b32 v5, 4, v3
    v_and_b32 v6, 8, v3
    v_and_b32 v3, 0xfffffff3, v3
    v_lshl_add_u32 v3, v5, 1, v3
    v_lshrrev_b32 v6, 1, v6
    v_add_u32 v3, v3, v6

    v_mul_lo_u32 v3, v3, s5
    v_add_u32 v3, v3, v4
    v_add_u32 v35, s44, v3
    s_mul_i32 s4, s41, 32
    v_add_u32 v1, s4, v24
    v_bfe_u32 v2, v1, 1, 3
    v_lshlrev_b32 v1, 7, v1

    v_add_u32 v3, 0, v25
    v_xor_b32 v3, v3, v2
    v_lshl_add_u32 v36, v3, 4, v1
    v_add_u32 v3, 2, v25
    v_xor_b32 v3, v3, v2
    v_lshl_add_u32 v37, v3, 4, v1
    v_add_u32 v3, 4, v25
    v_xor_b32 v3, v3, v2
    v_lshl_add_u32 v38, v3, 4, v1
    v_add_u32 v3, 6, v25
    v_xor_b32 v3, v3, v2
    v_lshl_add_u32 v39, v3, 4, v1
    v_bfe_u32 v1, v26, 2, 2
    v_lshrrev_b32 v2, 5, v26
    v_lshlrev_b32 v2, 10, v2
    v_lshl_add_u32 v2, v1, 7, v2
    v_bfe_u32 v3, v26, 4, 1
    v_lshl_add_u32 v2, v3, 5, v2
    v_and_b32 v3, 3, v26
    v_lshl_add_u32 v2, v3, 3, v2
    v_add_u32 v2, 8192, v2
    s_mul_i32 s4, s42, 1

    v_lshrrev_b32 v1, 1, v1
    s_add_u32 s5, s4, 0
    v_xor_b32 v3, s5, v1
    v_lshl_add_u32 v48, v3, 6, v2
    v_add_u32 v40, 65536, v36
    v_add_u32 v41, 65536, v37
    v_add_u32 v42, 65536, v38
    v_add_u32 v43, 65536, v39
    v_add_u32 v49, 65536, v48
    v_add_u32 v44, 131072, v36
    v_add_u32 v45, 131072, v37
    v_add_u32 v46, 131072, v38
    v_add_u32 v47, 131072, v39
    v_add_u32 v50, 131072, v48
    v_mov_b32 v116, 0
    v_mov_b32 v117, 0
    v_mov_b32 v118, 0
    v_mov_b32 v119, 0
    v_mov_b32 v120, 0
    v_mov_b32 v121, 0
    v_mov_b32 v122, 0
    v_mov_b32 v123, 0
    v_mov_b32 v124, 0
    v_mov_b32 v125, 0
    v_mov_b32 v126, 0
    v_mov_b32 v127, 0
    v_mov_b32 v128, 0
    v_mov_b32 v129, 0
    v_mov_b32 v130, 0
    v_mov_b32 v131, 0
    s_lshl_b32 s45, s40, 10
    s_mul_i32 s46, s45, 2
    s_mul_i32 s45, s45, 2
    s_mov_b32 s53, s31
    s_mov_b32 s54, s32
    s_lshr_b32 s52, s2, 3
    s_and_b32 s52, s52, 31

    s_sub_u32 s4, s52, 28
    s_cmp_ge_u32 s52, 28
    s_cselect_b32 s52, s4, s52
    s_sub_u32 s4, s52, 28
    s_cmp_ge_u32 s52, 28
    s_cselect_b32 s52, s4, s52
    s_lshl_b32 s31, s52, 7
    s_add_u32 s31, s31, s53
    s_mul_i32 s32, s52, 65536
    s_add_u32 s32, s32, s54
    s_add_u32 s52, s52, 1
    s_cmp_eq_u32 s52, 28
    s_cselect_b32 s52, 0, s52
    s_add_u32 m0, s45, 0
    s_nop 0
    buffer_load_dwordx4 v32, s[8:11], s31 offen lds
    s_add_u32 m0, s45, 1024
    s_nop 0
    buffer_load_dwordx4 v33, s[8:11], s31 offen lds
    s_add_u32 m0, s46, 8192
    s_nop 0
    buffer_load_dwordx4 v34, s[12:15], s32 offen lds
    s_add_u32 m0, s46, 9216
    s_nop 0
    buffer_load_dwordx4 v35, s[12:15], s32 offen lds
    s_lshl_b32 s31, s52, 7
    s_add_u32 s31, s31, s53
    s_mul_i32 s32, s52, 65536
    s_add_u32 s32, s32, s54
    s_add_u32 s52, s52, 1
    s_cmp_eq_u32 s52, 28
    s_cselect_b32 s52, 0, s52
    s_add_u32 m0, s45, 16384
    s_nop 0
    buffer_load_dwordx4 v32, s[8:11], s31 offen lds
    s_add_u32 m0, s45, 17408
    s_nop 0
    buffer_load_dwordx4 v33, s[8:11], s31 offen lds
    s_add_u32 m0, s46, 24576
    s_nop 0
    buffer_load_dwordx4 v34, s[12:15], s32 offen lds
    s_add_u32 m0, s46, 25600
    s_nop 0
    buffer_load_dwordx4 v35, s[12:15], s32 offen lds
    s_lshl_b32 s31, s52, 7
    s_add_u32 s31, s31, s53
    s_mul_i32 s32, s52, 65536
    s_add_u32 s32, s32, s54
    s_add_u32 s52, s52, 1
    s_cmp_eq_u32 s52, 28
    s_cselect_b32 s52, 0, s52
    s_add_u32 m0, s45, 32768
    s_nop 0
    buffer_load_dwordx4 v32, s[8:11], s31 offen lds
    s_add_u32 m0, s45, 33792
    s_nop 0
    buffer_load_dwordx4 v33, s[8:11], s31 offen lds
    s_add_u32 m0, s46, 40960
    s_nop 0
    buffer_load_dwordx4 v34, s[12:15], s32 offen lds
    s_add_u32 m0, s46, 41984
    s_nop 0
    buffer_load_dwordx4 v35, s[12:15], s32 offen lds
    s_lshl_b32 s31, s52, 7
    s_add_u32 s31, s31, s53
    s_mul_i32 s32, s52, 65536
    s_add_u32 s32, s32, s54
    s_add_u32 s52, s52, 1
    s_cmp_eq_u32 s52, 28
    s_cselect_b32 s52, 0, s52
    s_add_u32 m0, s45, 49152
    s_nop 0
    buffer_load_dwordx4 v32, s[8:11], s31 offen lds
    s_add_u32 m0, s45, 50176
    s_nop 0
    buffer_load_dwordx4 v33, s[8:11], s31 offen lds
    s_add_u32 m0, s46, 57344
    s_nop 0
    buffer_load_dwordx4 v34, s[12:15], s32 offen lds
    s_add_u32 m0, s46, 58368
    s_nop 0
    buffer_load_dwordx4 v35, s[12:15], s32 offen lds
    s_lshl_b32 s31, s52, 7
    s_add_u32 s31, s31, s53
    s_mul_i32 s32, s52, 65536
    s_add_u32 s32, s32, s54
    s_add_u32 s52, s52, 1
    s_cmp_eq_u32 s52, 28
    s_cselect_b32 s52, 0, s52
    s_add_u32 m0, s45, 65536
    s_nop 0
    buffer_load_dwordx4 v32, s[8:11], s31 offen lds
    s_add_u32 m0, s45, 66560
    s_nop 0
    buffer_load_dwordx4 v33, s[8:11], s31 offen lds
    s_add_u32 m0, s46, 73728
    s_nop 0
    buffer_load_dwordx4 v34, s[12:15], s32 offen lds
    s_add_u32 m0, s46, 74752
    s_nop 0
    buffer_load_dwordx4 v35, s[12:15], s32 offen lds
    s_lshl_b32 s31, s52, 7
    s_add_u32 s31, s31, s53
    s_mul_i32 s32, s52, 65536
    s_add_u32 s32, s32, s54
    s_add_u32 s52, s52, 1
    s_cmp_eq_u32 s52, 28
    s_cselect_b32 s52, 0, s52
    s_add_u32 m0, s45, 81920
    s_nop 0
    buffer_load_dwordx4 v32, s[8:11], s31 offen lds
    s_add_u32 m0, s45, 82944
    s_nop 0
    buffer_load_dwordx4 v33, s[8:11], s31 offen lds
    s_add_u32 m0, s46, 90112
    s_nop 0
    buffer_load_dwordx4 v34, s[12:15], s32 offen lds
    s_add_u32 m0, s46, 91136
    s_nop 0
    buffer_load_dwordx4 v35, s[12:15], s32 offen lds
    s_lshl_b32 s31, s52, 7
    s_add_u32 s31, s31, s53
    s_mul_i32 s32, s52, 65536
    s_add_u32 s32, s32, s54
    s_add_u32 s52, s52, 1
    s_cmp_eq_u32 s52, 28
    s_cselect_b32 s52, 0, s52
    s_add_u32 m0, s45, 98304
    s_nop 0
    buffer_load_dwordx4 v32, s[8:11], s31 offen lds
    s_add_u32 m0, s45, 99328
    s_nop 0
    buffer_load_dwordx4 v33, s[8:11], s31 offen lds
    s_add_u32 m0, s46, 106496
    s_nop 0
    buffer_load_dwordx4 v34, s[12:15], s32 offen lds
    s_add_u32 m0, s46, 107520
    s_nop 0
    buffer_load_dwordx4 v35, s[12:15], s32 offen lds
    s_lshl_b32 s31, s52, 7
    s_add_u32 s31, s31, s53
    s_mul_i32 s32, s52, 65536
    s_add_u32 s32, s32, s54
    s_add_u32 s52, s52, 1
    s_cmp_eq_u32 s52, 28
    s_cselect_b32 s52, 0, s52
    s_add_u32 m0, s45, 114688
    s_nop 0
    buffer_load_dwordx4 v32, s[8:11], s31 offen lds
    s_add_u32 m0, s45, 115712
    s_nop 0
    buffer_load_dwordx4 v33, s[8:11], s31 offen lds
    s_add_u32 m0, s46, 122880
    s_nop 0
    buffer_load_dwordx4 v34, s[12:15], s32 offen lds
    s_add_u32 m0, s46, 123904
    s_nop 0
    buffer_load_dwordx4 v35, s[12:15], s32 offen lds
    s_mov_b32 s30, 2
gloop_13:
    s_waitcnt vmcnt(28)
    s_barrier
    ds_read_b128 v[52:55], v36 offset:0
    ds_read_b64_tr_b16 v[56:57], v48 offset:0
    ds_read_b64_tr_b16 v[58:59], v48 offset:512
    ds_read_b128 v[60:63], v37 offset:0
    ds_read_b64_tr_b16 v[64:65], v48 offset:2048
    ds_read_b64_tr_b16 v[66:67], v48 offset:2560
    s_lshl_b32 s31, s52, 7
    s_add_u32 s31, s31, s53
    s_mul_i32 s32, s52, 65536
    s_add_u32 s32, s32, s54
    s_add_u32 s52, s52, 1
    s_cmp_eq_u32 s52, 28
    s_cselect_b32 s52, 0, s52
    s_add_u32 m0, s45, 131072
    s_nop 0
    buffer_load_dwordx4 v32, s[8:11], s31 offen lds
    s_add_u32 m0, s45, 132096
    s_nop 0
    buffer_load_dwordx4 v33, s[8:11], s31 offen lds
    s_add_u32 m0, s46, 139264
    s_nop 0
    buffer_load_dwordx4 v34, s[12:15], s32 offen lds
    s_add_u32 m0, s46, 140288
    s_nop 0
    buffer_load_dwordx4 v35, s[12:15], s32 offen lds
    s_waitcnt lgkmcnt(3)
    v_mfma_f32_32x32x16_bf16 v[116:131], v[56:59], v[52:55], v[116:131]
    ds_read_b128 v[68:71], v38 offset:0
    ds_read_b64_tr_b16 v[72:73], v48 offset:4096
    ds_read_b64_tr_b16 v[74:75], v48 offset:4608
    s_waitcnt lgkmcnt(3)
    v_mfma_f32_32x32x16_bf16 v[116:131], v[64:67], v[60:63], v[116:131]
    ds_read_b128 v[76:79], v39 offset:0
    ds_read_b64_tr_b16 v[80:81], v48 offset:6144
    ds_read_b64_tr_b16 v[82:83], v48 offset:6656
    s_waitcnt lgkmcnt(3)
    v_mfma_f32_32x32x16_bf16 v[116:131], v[72:75], v[68:71], v[116:131]
    s_waitcnt lgkmcnt(0)
    v_mfma_f32_32x32x16_bf16 v[116:131], v[80:83], v[76:79], v[116:131]
    s_waitcnt vmcnt(28)
    s_barrier
    ds_read_b128 v[52:55], v36 offset:16384
    ds_read_b64_tr_b16 v[56:57], v48 offset:16384
    ds_read_b64_tr_b16 v[58:59], v48 offset:16896
    ds_read_b128 v[60:63], v37 offset:16384
    ds_read_b64_tr_b16 v[64:65], v48 offset:18432
    ds_read_b64_tr_b16 v[66:67], v48 offset:18944
    s_lshl_b32 s31, s52, 7
    s_add_u32 s31, s31, s53
    s_mul_i32 s32, s52, 65536
    s_add_u32 s32, s32, s54
    s_add_u32 s52, s52, 1
    s_cmp_eq_u32 s52, 28
    s_cselect_b32 s52, 0, s52
    s_add_u32 m0, s45, 0
    s_nop 0
    buffer_load_dwordx4 v32, s[8:11], s31 offen lds
    s_add_u32 m0, s45, 1024
    s_nop 0
    buffer_load_dwordx4 v33, s[8:11], s31 offen lds
    s_add_u32 m0, s46, 8192
    s_nop 0
    buffer_load_dwordx4 v34, s[12:15], s32 offen lds
    s_add_u32 m0, s46, 9216
    s_nop 0
    buffer_load_dwordx4 v35, s[12:15], s32 offen lds
    s_waitcnt lgkmcnt(3)
    v_mfma_f32_32x32x16_bf16 v[116:131], v[56:59], v[52:55], v[116:131]
    ds_read_b128 v[68:71], v38 offset:16384
    ds_read_b64_tr_b16 v[72:73], v48 offset:20480
    ds_read_b64_tr_b16 v[74:75], v48 offset:20992
    s_waitcnt lgkmcnt(3)
    v_mfma_f32_32x32x16_bf16 v[116:131], v[64:67], v[60:63], v[116:131]
    ds_read_b128 v[76:79], v39 offset:16384
    ds_read_b64_tr_b16 v[80:81], v48 offset:22528
    ds_read_b64_tr_b16 v[82:83], v48 offset:23040
    s_waitcnt lgkmcnt(3)
    v_mfma_f32_32x32x16_bf16 v[116:131], v[72:75], v[68:71], v[116:131]
    s_waitcnt lgkmcnt(0)
    v_mfma_f32_32x32x16_bf16 v[116:131], v[80:83], v[76:79], v[116:131]
    s_waitcnt vmcnt(28)
    s_barrier
    ds_read_b128 v[52:55], v36 offset:32768
    ds_read_b64_tr_b16 v[56:57], v48 offset:32768
    ds_read_b64_tr_b16 v[58:59], v48 offset:33280
    ds_read_b128 v[60:63], v37 offset:32768
    ds_read_b64_tr_b16 v[64:65], v48 offset:34816
    ds_read_b64_tr_b16 v[66:67], v48 offset:35328
    s_lshl_b32 s31, s52, 7
    s_add_u32 s31, s31, s53
    s_mul_i32 s32, s52, 65536
    s_add_u32 s32, s32, s54
    s_add_u32 s52, s52, 1
    s_cmp_eq_u32 s52, 28
    s_cselect_b32 s52, 0, s52
    s_add_u32 m0, s45, 16384
    s_nop 0
    buffer_load_dwordx4 v32, s[8:11], s31 offen lds
    s_add_u32 m0, s45, 17408
    s_nop 0
    buffer_load_dwordx4 v33, s[8:11], s31 offen lds
    s_add_u32 m0, s46, 24576
    s_nop 0
    buffer_load_dwordx4 v34, s[12:15], s32 offen lds
    s_add_u32 m0, s46, 25600
    s_nop 0
    buffer_load_dwordx4 v35, s[12:15], s32 offen lds
    s_waitcnt lgkmcnt(3)
    v_mfma_f32_32x32x16_bf16 v[116:131], v[56:59], v[52:55], v[116:131]
    ds_read_b128 v[68:71], v38 offset:32768
    ds_read_b64_tr_b16 v[72:73], v48 offset:36864
    ds_read_b64_tr_b16 v[74:75], v48 offset:37376
    s_waitcnt lgkmcnt(3)
    v_mfma_f32_32x32x16_bf16 v[116:131], v[64:67], v[60:63], v[116:131]
    ds_read_b128 v[76:79], v39 offset:32768
    ds_read_b64_tr_b16 v[80:81], v48 offset:38912
    ds_read_b64_tr_b16 v[82:83], v48 offset:39424
    s_waitcnt lgkmcnt(3)
    v_mfma_f32_32x32x16_bf16 v[116:131], v[72:75], v[68:71], v[116:131]
    s_waitcnt lgkmcnt(0)
    v_mfma_f32_32x32x16_bf16 v[116:131], v[80:83], v[76:79], v[116:131]
    s_waitcnt vmcnt(28)
    s_barrier
    ds_read_b128 v[52:55], v36 offset:49152
    ds_read_b64_tr_b16 v[56:57], v48 offset:49152
    ds_read_b64_tr_b16 v[58:59], v48 offset:49664
    ds_read_b128 v[60:63], v37 offset:49152
    ds_read_b64_tr_b16 v[64:65], v48 offset:51200
    ds_read_b64_tr_b16 v[66:67], v48 offset:51712
    s_lshl_b32 s31, s52, 7
    s_add_u32 s31, s31, s53
    s_mul_i32 s32, s52, 65536
    s_add_u32 s32, s32, s54
    s_add_u32 s52, s52, 1
    s_cmp_eq_u32 s52, 28
    s_cselect_b32 s52, 0, s52
    s_add_u32 m0, s45, 32768
    s_nop 0
    buffer_load_dwordx4 v32, s[8:11], s31 offen lds
    s_add_u32 m0, s45, 33792
    s_nop 0
    buffer_load_dwordx4 v33, s[8:11], s31 offen lds
    s_add_u32 m0, s46, 40960
    s_nop 0
    buffer_load_dwordx4 v34, s[12:15], s32 offen lds
    s_add_u32 m0, s46, 41984
    s_nop 0
    buffer_load_dwordx4 v35, s[12:15], s32 offen lds
    s_waitcnt lgkmcnt(3)
    v_mfma_f32_32x32x16_bf16 v[116:131], v[56:59], v[52:55], v[116:131]
    ds_read_b128 v[68:71], v38 offset:49152
    ds_read_b64_tr_b16 v[72:73], v48 offset:53248
    ds_read_b64_tr_b16 v[74:75], v48 offset:53760
    s_waitcnt lgkmcnt(3)
    v_mfma_f32_32x32x16_bf16 v[116:131], v[64:67], v[60:63], v[116:131]
    ds_read_b128 v[76:79], v39 offset:49152
    ds_read_b64_tr_b16 v[80:81], v48 offset:55296
    ds_read_b64_tr_b16 v[82:83], v48 offset:55808
    s_waitcnt lgkmcnt(3)
    v_mfma_f32_32x32x16_bf16 v[116:131], v[72:75], v[68:71], v[116:131]
    s_waitcnt lgkmcnt(0)
    v_mfma_f32_32x32x16_bf16 v[116:131], v[80:83], v[76:79], v[116:131]
    s_waitcnt vmcnt(28)
    s_barrier
    ds_read_b128 v[52:55], v40 offset:0
    ds_read_b64_tr_b16 v[56:57], v49 offset:0
    ds_read_b64_tr_b16 v[58:59], v49 offset:512
    ds_read_b128 v[60:63], v41 offset:0
    ds_read_b64_tr_b16 v[64:65], v49 offset:2048
    ds_read_b64_tr_b16 v[66:67], v49 offset:2560
    s_lshl_b32 s31, s52, 7
    s_add_u32 s31, s31, s53
    s_mul_i32 s32, s52, 65536
    s_add_u32 s32, s32, s54
    s_add_u32 s52, s52, 1
    s_cmp_eq_u32 s52, 28
    s_cselect_b32 s52, 0, s52
    s_add_u32 m0, s45, 49152
    s_nop 0
    buffer_load_dwordx4 v32, s[8:11], s31 offen lds
    s_add_u32 m0, s45, 50176
    s_nop 0
    buffer_load_dwordx4 v33, s[8:11], s31 offen lds
    s_add_u32 m0, s46, 57344
    s_nop 0
    buffer_load_dwordx4 v34, s[12:15], s32 offen lds
    s_add_u32 m0, s46, 58368
    s_nop 0
    buffer_load_dwordx4 v35, s[12:15], s32 offen lds
    s_waitcnt lgkmcnt(3)
    v_mfma_f32_32x32x16_bf16 v[116:131], v[56:59], v[52:55], v[116:131]
    ds_read_b128 v[68:71], v42 offset:0
    ds_read_b64_tr_b16 v[72:73], v49 offset:4096
    ds_read_b64_tr_b16 v[74:75], v49 offset:4608
    s_waitcnt lgkmcnt(3)
    v_mfma_f32_32x32x16_bf16 v[116:131], v[64:67], v[60:63], v[116:131]
    ds_read_b128 v[76:79], v43 offset:0
    ds_read_b64_tr_b16 v[80:81], v49 offset:6144
    ds_read_b64_tr_b16 v[82:83], v49 offset:6656
    s_waitcnt lgkmcnt(3)
    v_mfma_f32_32x32x16_bf16 v[116:131], v[72:75], v[68:71], v[116:131]
    s_waitcnt lgkmcnt(0)
    v_mfma_f32_32x32x16_bf16 v[116:131], v[80:83], v[76:79], v[116:131]
    s_waitcnt vmcnt(28)
    s_barrier
    ds_read_b128 v[52:55], v40 offset:16384
    ds_read_b64_tr_b16 v[56:57], v49 offset:16384
    ds_read_b64_tr_b16 v[58:59], v49 offset:16896
    ds_read_b128 v[60:63], v41 offset:16384
    ds_read_b64_tr_b16 v[64:65], v49 offset:18432
    ds_read_b64_tr_b16 v[66:67], v49 offset:18944
    s_lshl_b32 s31, s52, 7
    s_add_u32 s31, s31, s53
    s_mul_i32 s32, s52, 65536
    s_add_u32 s32, s32, s54
    s_add_u32 s52, s52, 1
    s_cmp_eq_u32 s52, 28
    s_cselect_b32 s52, 0, s52
    s_add_u32 m0, s45, 65536
    s_nop 0
    buffer_load_dwordx4 v32, s[8:11], s31 offen lds
    s_add_u32 m0, s45, 66560
    s_nop 0
    buffer_load_dwordx4 v33, s[8:11], s31 offen lds
    s_add_u32 m0, s46, 73728
    s_nop 0
    buffer_load_dwordx4 v34, s[12:15], s32 offen lds
    s_add_u32 m0, s46, 74752
    s_nop 0
    buffer_load_dwordx4 v35, s[12:15], s32 offen lds
    s_waitcnt lgkmcnt(3)
    v_mfma_f32_32x32x16_bf16 v[116:131], v[56:59], v[52:55], v[116:131]
    ds_read_b128 v[68:71], v42 offset:16384
    ds_read_b64_tr_b16 v[72:73], v49 offset:20480
    ds_read_b64_tr_b16 v[74:75], v49 offset:20992
    s_waitcnt lgkmcnt(3)
    v_mfma_f32_32x32x16_bf16 v[116:131], v[64:67], v[60:63], v[116:131]
    ds_read_b128 v[76:79], v43 offset:16384
    ds_read_b64_tr_b16 v[80:81], v49 offset:22528
    ds_read_b64_tr_b16 v[82:83], v49 offset:23040
    s_waitcnt lgkmcnt(3)
    v_mfma_f32_32x32x16_bf16 v[116:131], v[72:75], v[68:71], v[116:131]
    s_waitcnt lgkmcnt(0)
    v_mfma_f32_32x32x16_bf16 v[116:131], v[80:83], v[76:79], v[116:131]
    s_waitcnt vmcnt(28)
    s_barrier
    ds_read_b128 v[52:55], v40 offset:32768
    ds_read_b64_tr_b16 v[56:57], v49 offset:32768
    ds_read_b64_tr_b16 v[58:59], v49 offset:33280
    ds_read_b128 v[60:63], v41 offset:32768
    ds_read_b64_tr_b16 v[64:65], v49 offset:34816
    ds_read_b64_tr_b16 v[66:67], v49 offset:35328
    s_lshl_b32 s31, s52, 7
    s_add_u32 s31, s31, s53
    s_mul_i32 s32, s52, 65536
    s_add_u32 s32, s32, s54
    s_add_u32 s52, s52, 1
    s_cmp_eq_u32 s52, 28
    s_cselect_b32 s52, 0, s52
    s_add_u32 m0, s45, 81920
    s_nop 0
    buffer_load_dwordx4 v32, s[8:11], s31 offen lds
    s_add_u32 m0, s45, 82944
    s_nop 0
    buffer_load_dwordx4 v33, s[8:11], s31 offen lds
    s_add_u32 m0, s46, 90112
    s_nop 0
    buffer_load_dwordx4 v34, s[12:15], s32 offen lds
    s_add_u32 m0, s46, 91136
    s_nop 0
    buffer_load_dwordx4 v35, s[12:15], s32 offen lds
    s_waitcnt lgkmcnt(3)
    v_mfma_f32_32x32x16_bf16 v[116:131], v[56:59], v[52:55], v[116:131]
    ds_read_b128 v[68:71], v42 offset:32768
    ds_read_b64_tr_b16 v[72:73], v49 offset:36864
    ds_read_b64_tr_b16 v[74:75], v49 offset:37376
    s_waitcnt lgkmcnt(3)
    v_mfma_f32_32x32x16_bf16 v[116:131], v[64:67], v[60:63], v[116:131]
    ds_read_b128 v[76:79], v43 offset:32768
    ds_read_b64_tr_b16 v[80:81], v49 offset:38912
    ds_read_b64_tr_b16 v[82:83], v49 offset:39424
    s_waitcnt lgkmcnt(3)
    v_mfma_f32_32x32x16_bf16 v[116:131], v[72:75], v[68:71], v[116:131]
    s_waitcnt lgkmcnt(0)
    v_mfma_f32_32x32x16_bf16 v[116:131], v[80:83], v[76:79], v[116:131]
    s_waitcnt vmcnt(28)
    s_barrier
    ds_read_b128 v[52:55], v40 offset:49152
    ds_read_b64_tr_b16 v[56:57], v49 offset:49152
    ds_read_b64_tr_b16 v[58:59], v49 offset:49664
    ds_read_b128 v[60:63], v41 offset:49152
    ds_read_b64_tr_b16 v[64:65], v49 offset:51200
    ds_read_b64_tr_b16 v[66:67], v49 offset:51712
    s_lshl_b32 s31, s52, 7
    s_add_u32 s31, s31, s53
    s_mul_i32 s32, s52, 65536
    s_add_u32 s32, s32, s54
    s_add_u32 s52, s52, 1
    s_cmp_eq_u32 s52, 28
    s_cselect_b32 s52, 0, s52
    s_add_u32 m0, s45, 98304
    s_nop 0
    buffer_load_dwordx4 v32, s[8:11], s31 offen lds
    s_add_u32 m0, s45, 99328
    s_nop 0
    buffer_load_dwordx4 v33, s[8:11], s31 offen lds
    s_add_u32 m0, s46, 106496
    s_nop 0
    buffer_load_dwordx4 v34, s[12:15], s32 offen lds
    s_add_u32 m0, s46, 107520
    s_nop 0
    buffer_load_dwordx4 v35, s[12:15], s32 offen lds
    s_waitcnt lgkmcnt(3)
    v_mfma_f32_32x32x16_bf16 v[116:131], v[56:59], v[52:55], v[116:131]
    ds_read_b128 v[68:71], v42 offset:49152
    ds_read_b64_tr_b16 v[72:73], v49 offset:53248
    ds_read_b64_tr_b16 v[74:75], v49 offset:53760
    s_waitcnt lgkmcnt(3)
    v_mfma_f32_32x32x16_bf16 v[116:131], v[64:67], v[60:63], v[116:131]
    ds_read_b128 v[76:79], v43 offset:49152
    ds_read_b64_tr_b16 v[80:81], v49 offset:55296
    ds_read_b64_tr_b16 v[82:83], v49 offset:55808
    s_waitcnt lgkmcnt(3)
    v_mfma_f32_32x32x16_bf16 v[116:131], v[72:75], v[68:71], v[116:131]
    s_waitcnt lgkmcnt(0)
    v_mfma_f32_32x32x16_bf16 v[116:131], v[80:83], v[76:79], v[116:131]
    s_waitcnt vmcnt(28)
    s_barrier
    ds_read_b128 v[52:55], v44 offset:0
    ds_read_b64_tr_b16 v[56:57], v50 offset:0
    ds_read_b64_tr_b16 v[58:59], v50 offset:512
    ds_read_b128 v[60:63], v45 offset:0
    ds_read_b64_tr_b16 v[64:65], v50 offset:2048
    ds_read_b64_tr_b16 v[66:67], v50 offset:2560
    s_lshl_b32 s31, s52, 7
    s_add_u32 s31, s31, s53
    s_mul_i32 s32, s52, 65536
    s_add_u32 s32, s32, s54
    s_add_u32 s52, s52, 1
    s_cmp_eq_u32 s52, 28
    s_cselect_b32 s52, 0, s52
    s_add_u32 m0, s45, 114688
    s_nop 0
    buffer_load_dwordx4 v32, s[8:11], s31 offen lds
    s_add_u32 m0, s45, 115712
    s_nop 0
    buffer_load_dwordx4 v33, s[8:11], s31 offen lds
    s_add_u32 m0, s46, 122880
    s_nop 0
    buffer_load_dwordx4 v34, s[12:15], s32 offen lds
    s_add_u32 m0, s46, 123904
    s_nop 0
    buffer_load_dwordx4 v35, s[12:15], s32 offen lds
    s_waitcnt lgkmcnt(3)
    v_mfma_f32_32x32x16_bf16 v[116:131], v[56:59], v[52:55], v[116:131]
    ds_read_b128 v[68:71], v46 offset:0
    ds_read_b64_tr_b16 v[72:73], v50 offset:4096
    ds_read_b64_tr_b16 v[74:75], v50 offset:4608
    s_waitcnt lgkmcnt(3)
    v_mfma_f32_32x32x16_bf16 v[116:131], v[64:67], v[60:63], v[116:131]
    ds_read_b128 v[76:79], v47 offset:0
    ds_read_b64_tr_b16 v[80:81], v50 offset:6144
    ds_read_b64_tr_b16 v[82:83], v50 offset:6656
    s_waitcnt lgkmcnt(3)
    v_mfma_f32_32x32x16_bf16 v[116:131], v[72:75], v[68:71], v[116:131]
    s_waitcnt lgkmcnt(0)
    v_mfma_f32_32x32x16_bf16 v[116:131], v[80:83], v[76:79], v[116:131]
    s_sub_u32 s30, s30, 1
    s_cmp_lg_u32 s30, 0
    s_cbranch_scc1 gloop_13
    s_waitcnt vmcnt(28)
    s_barrier
    ds_read_b128 v[52:55], v36 offset:0
    ds_read_b64_tr_b16 v[56:57], v48 offset:0
    ds_read_b64_tr_b16 v[58:59], v48 offset:512
    ds_read_b128 v[60:63], v37 offset:0
    ds_read_b64_tr_b16 v[64:65], v48 offset:2048
    ds_read_b64_tr_b16 v[66:67], v48 offset:2560
    s_lshl_b32 s31, s52, 7
    s_add_u32 s31, s31, s53
    s_mul_i32 s32, s52, 65536
    s_add_u32 s32, s32, s54
    s_add_u32 s52, s52, 1
    s_cmp_eq_u32 s52, 28
    s_cselect_b32 s52, 0, s52
    s_add_u32 m0, s45, 131072
    s_nop 0
    buffer_load_dwordx4 v32, s[8:11], s31 offen lds
    s_add_u32 m0, s45, 132096
    s_nop 0
    buffer_load_dwordx4 v33, s[8:11], s31 offen lds
    s_add_u32 m0, s46, 139264
    s_nop 0
    buffer_load_dwordx4 v34, s[12:15], s32 offen lds
    s_add_u32 m0, s46, 140288
    s_nop 0
    buffer_load_dwordx4 v35, s[12:15], s32 offen lds
    s_waitcnt lgkmcnt(3)
    v_mfma_f32_32x32x16_bf16 v[116:131], v[56:59], v[52:55], v[116:131]
    ds_read_b128 v[68:71], v38 offset:0
    ds_read_b64_tr_b16 v[72:73], v48 offset:4096
    ds_read_b64_tr_b16 v[74:75], v48 offset:4608
    s_waitcnt lgkmcnt(3)
    v_mfma_f32_32x32x16_bf16 v[116:131], v[64:67], v[60:63], v[116:131]
    ds_read_b128 v[76:79], v39 offset:0
    ds_read_b64_tr_b16 v[80:81], v48 offset:6144
    ds_read_b64_tr_b16 v[82:83], v48 offset:6656
    s_waitcnt lgkmcnt(3)
    v_mfma_f32_32x32x16_bf16 v[116:131], v[72:75], v[68:71], v[116:131]
    s_waitcnt lgkmcnt(0)
    v_mfma_f32_32x32x16_bf16 v[116:131], v[80:83], v[76:79], v[116:131]
    s_waitcnt vmcnt(28)
    s_barrier
    ds_read_b128 v[52:55], v36 offset:16384
    ds_read_b64_tr_b16 v[56:57], v48 offset:16384
    ds_read_b64_tr_b16 v[58:59], v48 offset:16896
    ds_read_b128 v[60:63], v37 offset:16384
    ds_read_b64_tr_b16 v[64:65], v48 offset:18432
    ds_read_b64_tr_b16 v[66:67], v48 offset:18944
    s_lshl_b32 s31, s52, 7
    s_add_u32 s31, s31, s53
    s_mul_i32 s32, s52, 65536
    s_add_u32 s32, s32, s54
    s_add_u32 s52, s52, 1
    s_cmp_eq_u32 s52, 28
    s_cselect_b32 s52, 0, s52
    s_add_u32 m0, s45, 0
    s_nop 0
    buffer_load_dwordx4 v32, s[8:11], s31 offen lds
    s_add_u32 m0, s45, 1024
    s_nop 0
    buffer_load_dwordx4 v33, s[8:11], s31 offen lds
    s_add_u32 m0, s46, 8192
    s_nop 0
    buffer_load_dwordx4 v34, s[12:15], s32 offen lds
    s_add_u32 m0, s46, 9216
    s_nop 0
    buffer_load_dwordx4 v35, s[12:15], s32 offen lds
    s_waitcnt lgkmcnt(3)
    v_mfma_f32_32x32x16_bf16 v[116:131], v[56:59], v[52:55], v[116:131]
    ds_read_b128 v[68:71], v38 offset:16384
    ds_read_b64_tr_b16 v[72:73], v48 offset:20480
    ds_read_b64_tr_b16 v[74:75], v48 offset:20992
    s_waitcnt lgkmcnt(3)
    v_mfma_f32_32x32x16_bf16 v[116:131], v[64:67], v[60:63], v[116:131]
    ds_read_b128 v[76:79], v39 offset:16384
    ds_read_b64_tr_b16 v[80:81], v48 offset:22528
    ds_read_b64_tr_b16 v[82:83], v48 offset:23040
    s_waitcnt lgkmcnt(3)
    v_mfma_f32_32x32x16_bf16 v[116:131], v[72:75], v[68:71], v[116:131]
    s_waitcnt lgkmcnt(0)
    v_mfma_f32_32x32x16_bf16 v[116:131], v[80:83], v[76:79], v[116:131]
    s_waitcnt vmcnt(28)
    s_barrier
    ds_read_b128 v[52:55], v36 offset:32768
    ds_read_b64_tr_b16 v[56:57], v48 offset:32768
    ds_read_b64_tr_b16 v[58:59], v48 offset:33280
    ds_read_b128 v[60:63], v37 offset:32768
    ds_read_b64_tr_b16 v[64:65], v48 offset:34816
    ds_read_b64_tr_b16 v[66:67], v48 offset:35328
    s_waitcnt lgkmcnt(3)
    v_mfma_f32_32x32x16_bf16 v[116:131], v[56:59], v[52:55], v[116:131]
    ds_read_b128 v[68:71], v38 offset:32768
    ds_read_b64_tr_b16 v[72:73], v48 offset:36864
    ds_read_b64_tr_b16 v[74:75], v48 offset:37376
    s_waitcnt lgkmcnt(3)
    v_mfma_f32_32x32x16_bf16 v[116:131], v[64:67], v[60:63], v[116:131]
    ds_read_b128 v[76:79], v39 offset:32768
    ds_read_b64_tr_b16 v[80:81], v48 offset:38912
    ds_read_b64_tr_b16 v[82:83], v48 offset:39424
    s_waitcnt lgkmcnt(3)
    v_mfma_f32_32x32x16_bf16 v[116:131], v[72:75], v[68:71], v[116:131]
    s_waitcnt lgkmcnt(0)
    v_mfma_f32_32x32x16_bf16 v[116:131], v[80:83], v[76:79], v[116:131]
    s_waitcnt vmcnt(24)
    s_barrier
    ds_read_b128 v[52:55], v36 offset:49152
    ds_read_b64_tr_b16 v[56:57], v48 offset:49152
    ds_read_b64_tr_b16 v[58:59], v48 offset:49664
    ds_read_b128 v[60:63], v37 offset:49152
    ds_read_b64_tr_b16 v[64:65], v48 offset:51200
    ds_read_b64_tr_b16 v[66:67], v48 offset:51712
    s_waitcnt lgkmcnt(3)
    v_mfma_f32_32x32x16_bf16 v[116:131], v[56:59], v[52:55], v[116:131]
    ds_read_b128 v[68:71], v38 offset:49152
    ds_read_b64_tr_b16 v[72:73], v48 offset:53248
    ds_read_b64_tr_b16 v[74:75], v48 offset:53760
    s_waitcnt lgkmcnt(3)
    v_mfma_f32_32x32x16_bf16 v[116:131], v[64:67], v[60:63], v[116:131]
    ds_read_b128 v[76:79], v39 offset:49152
    ds_read_b64_tr_b16 v[80:81], v48 offset:55296
    ds_read_b64_tr_b16 v[82:83], v48 offset:55808
    s_waitcnt lgkmcnt(3)
    v_mfma_f32_32x32x16_bf16 v[116:131], v[72:75], v[68:71], v[116:131]
    s_waitcnt lgkmcnt(0)
    v_mfma_f32_32x32x16_bf16 v[116:131], v[80:83], v[76:79], v[116:131]
    s_waitcnt vmcnt(20)
    s_barrier
    ds_read_b128 v[52:55], v40 offset:0
    ds_read_b64_tr_b16 v[56:57], v49 offset:0
    ds_read_b64_tr_b16 v[58:59], v49 offset:512
    ds_read_b128 v[60:63], v41 offset:0
    ds_read_b64_tr_b16 v[64:65], v49 offset:2048
    ds_read_b64_tr_b16 v[66:67], v49 offset:2560
    s_waitcnt lgkmcnt(3)
    v_mfma_f32_32x32x16_bf16 v[116:131], v[56:59], v[52:55], v[116:131]
    ds_read_b128 v[68:71], v42 offset:0
    ds_read_b64_tr_b16 v[72:73], v49 offset:4096
    ds_read_b64_tr_b16 v[74:75], v49 offset:4608
    s_waitcnt lgkmcnt(3)
    v_mfma_f32_32x32x16_bf16 v[116:131], v[64:67], v[60:63], v[116:131]
    ds_read_b128 v[76:79], v43 offset:0
    ds_read_b64_tr_b16 v[80:81], v49 offset:6144
    ds_read_b64_tr_b16 v[82:83], v49 offset:6656
    s_waitcnt lgkmcnt(3)
    v_mfma_f32_32x32x16_bf16 v[116:131], v[72:75], v[68:71], v[116:131]
    s_waitcnt lgkmcnt(0)
    v_mfma_f32_32x32x16_bf16 v[116:131], v[80:83], v[76:79], v[116:131]
    s_waitcnt vmcnt(16)
    s_barrier
    ds_read_b128 v[52:55], v40 offset:16384
    ds_read_b64_tr_b16 v[56:57], v49 offset:16384
    ds_read_b64_tr_b16 v[58:59], v49 offset:16896
    ds_read_b128 v[60:63], v41 offset:16384
    ds_read_b64_tr_b16 v[64:65], v49 offset:18432
    ds_read_b64_tr_b16 v[66:67], v49 offset:18944
    s_waitcnt lgkmcnt(3)
    v_mfma_f32_32x32x16_bf16 v[116:131], v[56:59], v[52:55], v[116:131]
    ds_read_b128 v[68:71], v42 offset:16384
    ds_read_b64_tr_b16 v[72:73], v49 offset:20480
    ds_read_b64_tr_b16 v[74:75], v49 offset:20992
    s_waitcnt lgkmcnt(3)
    v_mfma_f32_32x32x16_bf16 v[116:131], v[64:67], v[60:63], v[116:131]
    ds_read_b128 v[76:79], v43 offset:16384
    ds_read_b64_tr_b16 v[80:81], v49 offset:22528
    ds_read_b64_tr_b16 v[82:83], v49 offset:23040
    s_waitcnt lgkmcnt(3)
    v_mfma_f32_32x32x16_bf16 v[116:131], v[72:75], v[68:71], v[116:131]
    s_waitcnt lgkmcnt(0)
    v_mfma_f32_32x32x16_bf16 v[116:131], v[80:83], v[76:79], v[116:131]
    s_waitcnt vmcnt(12)
    s_barrier
    ds_read_b128 v[52:55], v40 offset:32768
    ds_read_b64_tr_b16 v[56:57], v49 offset:32768
    ds_read_b64_tr_b16 v[58:59], v49 offset:33280
    ds_read_b128 v[60:63], v41 offset:32768
    ds_read_b64_tr_b16 v[64:65], v49 offset:34816
    ds_read_b64_tr_b16 v[66:67], v49 offset:35328
    s_waitcnt lgkmcnt(3)
    v_mfma_f32_32x32x16_bf16 v[116:131], v[56:59], v[52:55], v[116:131]
    ds_read_b128 v[68:71], v42 offset:32768
    ds_read_b64_tr_b16 v[72:73], v49 offset:36864
    ds_read_b64_tr_b16 v[74:75], v49 offset:37376
    s_waitcnt lgkmcnt(3)
    v_mfma_f32_32x32x16_bf16 v[116:131], v[64:67], v[60:63], v[116:131]
    ds_read_b128 v[76:79], v43 offset:32768
    ds_read_b64_tr_b16 v[80:81], v49 offset:38912
    ds_read_b64_tr_b16 v[82:83], v49 offset:39424
    s_waitcnt lgkmcnt(3)
    v_mfma_f32_32x32x16_bf16 v[116:131], v[72:75], v[68:71], v[116:131]
    s_waitcnt lgkmcnt(0)
    v_mfma_f32_32x32x16_bf16 v[116:131], v[80:83], v[76:79], v[116:131]
    s_waitcnt vmcnt(8)
    s_barrier
    ds_read_b128 v[52:55], v40 offset:49152
    ds_read_b64_tr_b16 v[56:57], v49 offset:49152
    ds_read_b64_tr_b16 v[58:59], v49 offset:49664
    ds_read_b128 v[60:63], v41 offset:49152
    ds_read_b64_tr_b16 v[64:65], v49 offset:51200
    ds_read_b64_tr_b16 v[66:67], v49 offset:51712
    s_waitcnt lgkmcnt(3)
    v_mfma_f32_32x32x16_bf16 v[116:131], v[56:59], v[52:55], v[116:131]
    ds_read_b128 v[68:71], v42 offset:49152
    ds_read_b64_tr_b16 v[72:73], v49 offset:53248
    ds_read_b64_tr_b16 v[74:75], v49 offset:53760
    s_waitcnt lgkmcnt(3)
    v_mfma_f32_32x32x16_bf16 v[116:131], v[64:67], v[60:63], v[116:131]
    ds_read_b128 v[76:79], v43 offset:49152
    ds_read_b64_tr_b16 v[80:81], v49 offset:55296
    ds_read_b64_tr_b16 v[82:83], v49 offset:55808
    s_waitcnt lgkmcnt(3)
    v_mfma_f32_32x32x16_bf16 v[116:131], v[72:75], v[68:71], v[116:131]
    s_waitcnt lgkmcnt(0)
    v_mfma_f32_32x32x16_bf16 v[116:131], v[80:83], v[76:79], v[116:131]
    s_waitcnt vmcnt(4)
    s_barrier
    ds_read_b128 v[52:55], v44 offset:0
    ds_read_b64_tr_b16 v[56:57], v50 offset:0
    ds_read_b64_tr_b16 v[58:59], v50 offset:512
    ds_read_b128 v[60:63], v45 offset:0
    ds_read_b64_tr_b16 v[64:65], v50 offset:2048
    ds_read_b64_tr_b16 v[66:67], v50 offset:2560
    s_waitcnt lgkmcnt(3)
    v_mfma_f32_32x32x16_bf16 v[116:131], v[56:59], v[52:55], v[116:131]
    ds_read_b128 v[68:71], v46 offset:0
    ds_read_b64_tr_b16 v[72:73], v50 offset:4096
    ds_read_b64_tr_b16 v[74:75], v50 offset:4608
    s_waitcnt lgkmcnt(3)
    v_mfma_f32_32x32x16_bf16 v[116:131], v[64:67], v[60:63], v[116:131]
    ds_read_b128 v[76:79], v47 offset:0
    ds_read_b64_tr_b16 v[80:81], v50 offset:6144
    ds_read_b64_tr_b16 v[82:83], v50 offset:6656
    s_waitcnt lgkmcnt(3)
    v_mfma_f32_32x32x16_bf16 v[116:131], v[72:75], v[68:71], v[116:131]
    s_waitcnt lgkmcnt(0)
    v_mfma_f32_32x32x16_bf16 v[116:131], v[80:83], v[76:79], v[116:131]
    s_waitcnt vmcnt(0)
    s_barrier
    ds_read_b128 v[52:55], v36 offset:0
    ds_read_b64_tr_b16 v[56:57], v48 offset:0
    ds_read_b64_tr_b16 v[58:59], v48 offset:512
    ds_read_b128 v[60:63], v37 offset:0
    ds_read_b64_tr_b16 v[64:65], v48 offset:2048
    ds_read_b64_tr_b16 v[66:67], v48 offset:2560
    s_waitcnt lgkmcnt(3)
    v_mfma_f32_32x32x16_bf16 v[116:131], v[56:59], v[52:55], v[116:131]
    ds_read_b128 v[68:71], v38 offset:0
    ds_read_b64_tr_b16 v[72:73], v48 offset:4096
    ds_read_b64_tr_b16 v[74:75], v48 offset:4608
    s_waitcnt lgkmcnt(3)
    v_mfma_f32_32x32x16_bf16 v[116:131], v[64:67], v[60:63], v[116:131]
    ds_read_b128 v[76:79], v39 offset:0
    ds_read_b64_tr_b16 v[80:81], v48 offset:6144
    ds_read_b64_tr_b16 v[82:83], v48 offset:6656
    s_waitcnt lgkmcnt(3)
    v_mfma_f32_32x32x16_bf16 v[116:131], v[72:75], v[68:71], v[116:131]
    s_waitcnt lgkmcnt(0)
    v_mfma_f32_32x32x16_bf16 v[116:131], v[80:83], v[76:79], v[116:131]
    s_nop 7
    s_nop 7
    s_mul_i32 s5, s41, 32
    s_add_u32 s4, s33, s5
    v_add_u32 v28, s4, v24
    s_mov_b32 s5, 512
    v_mul_lo_u32 v28, v28, s5
    s_mul_i32 s5, s42, 32
    s_add_u32 s5, s5, s34
    v_add_u32 v28, s5, v28

    v_lshl_add_u32 v28, v25, 2, v28
    v_and_b32 v29, 511, v28
    v_lshlrev_b32 v29, 2, v29
    v_lshlrev_b32 v30, 2, v28
    v_lshlrev_b32 v31, 1, v28
    s_mov_b32 s4, 10240
    buffer_load_dwordx4 v[52:55], v29, s[24:27], s4 offen offset:0
    buffer_load_dwordx4 v[56:59], v29, s[24:27], s4 offen offset:32
    buffer_load_dwordx4 v[60:63], v29, s[24:27], s4 offen offset:64
    buffer_load_dwordx4 v[64:67], v29, s[24:27], s4 offen offset:96
    s_mov_b32 s4, 0
    buffer_load_dwordx4 v[68:71], v30, s[20:23], s4 offen offset:0
    buffer_load_dwordx4 v[72:75], v30, s[20:23], s4 offen offset:32
    buffer_load_dwordx4 v[76:79], v30, s[20:23], s4 offen offset:64
    buffer_load_dwordx4 v[80:83], v30, s[20:23], s4 offen offset:96
    s_waitcnt vmcnt(0)
    s_mov_b32 s5, 0
    v_fma_f32 v116, v116, v52, v68
    v_fma_f32 v117, v117, v53, v69
    v_fma_f32 v118, v118, v54, v70
    v_fma_f32 v119, v119, v55, v71
    v_cvt_pk_bf16_f32 v116, v116, v117
    v_cvt_pk_bf16_f32 v117, v118, v119
    buffer_store_dwordx2 v[116:117], v31, s[16:19], s5 offen offset:0
    v_fma_f32 v120, v120, v56, v72
    v_fma_f32 v121, v121, v57, v73
    v_fma_f32 v122, v122, v58, v74
    v_fma_f32 v123, v123, v59, v75
    v_cvt_pk_bf16_f32 v120, v120, v121
    v_cvt_pk_bf16_f32 v121, v122, v123
    buffer_store_dwordx2 v[120:121], v31, s[16:19], s5 offen offset:16
    v_fma_f32 v124, v124, v60, v76
    v_fma_f32 v125, v125, v61, v77
    v_fma_f32 v126, v126, v62, v78
    v_fma_f32 v127, v127, v63, v79
    v_cvt_pk_bf16_f32 v124, v124, v125
    v_cvt_pk_bf16_f32 v125, v126, v127
    buffer_store_dwordx2 v[124:125], v31, s[16:19], s5 offen offset:32
    v_fma_f32 v128, v128, v64, v80
    v_fma_f32 v129, v129, v65, v81
    v_fma_f32 v130, v130, v66, v82
    v_fma_f32 v131, v131, v67, v83
    v_cvt_pk_bf16_f32 v128, v128, v129
    v_cvt_pk_bf16_f32 v129, v130, v131
    buffer_store_dwordx2 v[128:129], v31, s[16:19], s5 offen offset:48
g_done_12:
    s_endpgm
.section .rodata,"a"
.p2align 6
.amdhsa_kernel mod_kernel
  .amdhsa_next_free_vgpr 96
  .amdhsa_next_free_sgpr 100
  .amdhsa_accum_offset 96
  .amdhsa_group_segment_fixed_size 0
  .amdhsa_kernarg_size 112
  .amdhsa_user_sgpr_count 2
  .amdhsa_user_sgpr_kernarg_segment_ptr 1
  .amdhsa_system_sgpr_workgroup_id_x 1
.end_amdhsa_kernel
.p2align 6
.amdhsa_kernel ln1_kernel
  .amdhsa_next_free_vgpr 48
  .amdhsa_next_free_sgpr 100
  .amdhsa_accum_offset 48
  .amdhsa_group_segment_fixed_size 0
  .amdhsa_kernarg_size 112
  .amdhsa_user_sgpr_count 2
  .amdhsa_user_sgpr_kernarg_segment_ptr 1
  .amdhsa_system_sgpr_workgroup_id_x 1
.end_amdhsa_kernel
.p2align 6
.amdhsa_kernel qkv_kernel
  .amdhsa_next_free_vgpr 244
  .amdhsa_next_free_sgpr 100
  .amdhsa_accum_offset 244
  .amdhsa_group_segment_fixed_size 0
  .amdhsa_kernarg_size 112
  .amdhsa_user_sgpr_count 2
  .amdhsa_user_sgpr_kernarg_segment_ptr 1
  .amdhsa_system_sgpr_workgroup_id_x 1
.end_amdhsa_kernel
.p2align 6
.amdhsa_kernel attn_kernel
  .amdhsa_next_free_vgpr 248
  .amdhsa_next_free_sgpr 100
  .amdhsa_accum_offset 248
  .amdhsa_group_segment_fixed_size 0
  .amdhsa_kernarg_size 112
  .amdhsa_user_sgpr_count 2
  .amdhsa_user_sgpr_kernarg_segment_ptr 1
  .amdhsa_system_sgpr_workgroup_id_x 1
.end_amdhsa_kernel
.p2align 6
.amdhsa_kernel oproj_kernel
  .amdhsa_next_free_vgpr 188
  .amdhsa_next_free_sgpr 100
  .amdhsa_accum_offset 188
  .amdhsa_group_segment_fixed_size 0
  .amdhsa_kernarg_size 112
  .amdhsa_user_sgpr_count 2
  .amdhsa_user_sgpr_kernarg_segment_ptr 1
  .amdhsa_system_sgpr_workgroup_id_x 1
.end_amdhsa_kernel
.p2align 6
.amdhsa_kernel ln2_kernel
  .amdhsa_next_free_vgpr 88
  .amdhsa_next_free_sgpr 100
  .amdhsa_accum_offset 88
  .amdhsa_group_segment_fixed_size 0
  .amdhsa_kernarg_size 112
  .amdhsa_user_sgpr_count 2
  .amdhsa_user_sgpr_kernarg_segment_ptr 1
  .amdhsa_system_sgpr_workgroup_id_x 1
.end_amdhsa_kernel
.p2align 6
.amdhsa_kernel ffn1_kernel
  .amdhsa_next_free_vgpr 188
  .amdhsa_next_free_sgpr 100
  .amdhsa_accum_offset 188
  .amdhsa_group_segment_fixed_size 0
  .amdhsa_kernarg_size 112
  .amdhsa_user_sgpr_count 2
  .amdhsa_user_sgpr_kernarg_segment_ptr 1
  .amdhsa_system_sgpr_workgroup_id_x 1
.end_amdhsa_kernel
.p2align 6
.amdhsa_kernel ffn2_kernel
  .amdhsa_next_free_vgpr 132
  .amdhsa_next_free_sgpr 100
  .amdhsa_accum_offset 132
  .amdhsa_group_segment_fixed_size 0
  .amdhsa_kernarg_size 112
  .amdhsa_user_sgpr_count 2
  .amdhsa_user_sgpr_kernarg_segment_ptr 1
  .amdhsa_system_sgpr_workgroup_id_x 1
.end_amdhsa_kernel
```
